```python
import torch

def _softmax(x, axis=-1):
    return torch.softmax(x, dim=axis)
def _gelu(x):
    return torch.nn.functional.gelu(x, approximate="tanh")
def _silu(x):
    return torch.nn.functional.silu(x)
def _sigmoid(x):
    return torch.sigmoid(x)
def _layernorm(x, axis=-1, eps=1e-5):
    m = x.mean(dim=axis, keepdim=True)
    v = x.var(dim=axis, keepdim=True, unbiased=False)
    return (x - m) / torch.sqrt(v + eps)
def _scatter_add(tgt, idx, src, axis=0):
    return tgt.clone().index_add_(axis, idx, src)
def _segment_sum(src, seg, n):
    out = torch.zeros((n,) + src.shape[1:], dtype=src.dtype)
    return out.index_add_(0, seg, src)
def _pad(x, pw):
    flat = tuple(v for pair in reversed(pw) for v in pair)
    return torch.nn.functional.pad(x, flat)

kernel_name = 'interleave_layers__softmax_full_mha__dense_activation_gelu__prompt'

def setup_inputs():

    _w = (lambda a: (lambda t: t.to(torch.bfloat16) if t.is_floating_point() else t)(torch.as_tensor(a)))
    def _A_setup():
        B, S, D = 1, 2048, 512
        return {
            "x": _w((lambda *s: torch.randn(*s, dtype=torch.bfloat16) * 0.05)(B, S, D)),
            "wqkv": _w((lambda *s: torch.randn(*s, dtype=torch.bfloat16) * 0.05)(D, 3 * D)),
            "wo": _w((lambda *s: torch.randn(*s, dtype=torch.bfloat16) * 0.05)(D, D)),
        }
    _A_in = _A_setup()

    def _B_setup():
        B, S, D, F = 1, 2048, 512, 1792
        return {
            "x": _w((lambda *s: torch.randn(*s, dtype=torch.bfloat16) * 0.05)(B, S, D)),
            "w1": _w((lambda *s: torch.randn(*s, dtype=torch.bfloat16) * 0.8)(D, F) * (D ** -0.5)),
            "b1": _w((lambda *s: torch.randn(*s, dtype=torch.bfloat16) * 0.2)(F) * 0.01),
            "w2": _w((lambda *s: torch.randn(*s, dtype=torch.bfloat16) * 0.2)(F, D) * (F ** -0.5)),
            "b2": _w((lambda *s: torch.randn(*s, dtype=torch.bfloat16) * 0.2)(D) * 0.01),
        }
    _B_in = _B_setup()

    return {
        "A_x": _A_in["x"],
        "A_wqkv": _A_in["wqkv"],
        "A_wo": _A_in["wo"],
        "B_x": _B_in["x"],
        "B_w1": _B_in["w1"],
        "B_b1": _B_in["b1"],
        "B_w2": _B_in["w2"],
        "B_b2": _B_in["b2"],
    }

def reference(A_x, A_wqkv, A_wo, B_x, B_w1, B_b1, B_w2, B_b2):
    def _A_ref(x, wqkv, wo):
        B, S, D = x.shape
        H = 32; Dh = D // H
        qkv = (lambda x, *d: x.permute(*d))((x @ wqkv).reshape(B, S, 3, H, Dh), 2, 0, 3, 1, 4)
        q, k, v = qkv[0], qkv[1], qkv[2]
        scale = Dh ** -0.5
        scores = torch.einsum("bhqd,bhkd->bhqk", q, k) * scale
        p = _softmax(scores, axis=-1)
        o = torch.einsum("bhqk,bhkd->bhqd", p, v)
        return (lambda x, *d: x.permute(*d))(o, 0, 2, 1, 3).reshape(B, S, D) @ wo

    def _B_ref(x, w1, b1, w2, b2):
        h = torch.einsum("bsd,df->bsf", x, w1) + b1
        h = _gelu(h)
        return torch.einsum("bsf,fd->bsd", h, w2) + b2

    x = A_x
    x = x + _A_ref(_layernorm(x, axis=-1), A_wqkv, A_wo)
    x = x + _B_ref(_layernorm(x, axis=-1), B_w1, B_b1, B_w2, B_b2)
    x = x + _A_ref(_layernorm(x, axis=-1), A_wqkv, A_wo)
    x = x + _B_ref(_layernorm(x, axis=-1), B_w1, B_b1, B_w2, B_b2)
    return x
```

```asm
; @launch kernel=qkv0_kernel grid=(192,1,1) block=(512,1,1) lds=133120
; @launch kernel=attn_kernel grid=(256,1,1) block=(512,1,1) lds=140608
; @launch kernel=wo0_kernel grid=(256,1,1) block=(512,1,1) lds=131072
; @launch kernel=ffn1_kernel grid=(224,1,1) block=(512,1,1) lds=133120
; @launch kernel=ffn2a_kernel grid=(256,1,1) block=(512,1,1) lds=131072
; @launch kernel=qkv1_kernel grid=(192,1,1) block=(512,1,1) lds=133120
; @launch kernel=attn_kernel grid=(256,1,1) block=(512,1,1) lds=140608
; @launch kernel=wo1_kernel grid=(256,1,1) block=(512,1,1) lds=131072
; @launch kernel=ffn1_kernel grid=(224,1,1) block=(512,1,1) lds=133120
; @launch kernel=ffn2b_kernel grid=(256,1,1) block=(512,1,1) lds=131072
.amdgcn_target "amdgcn-amd-amdhsa--gfx950"
.text
.p2align 8
.globl qkv0_kernel
.type qkv0_kernel,@function
qkv0_kernel:
    s_cmp_ge_u32 s2, 192
    s_cbranch_scc1 L_qkv0_kernel_end
    s_load_dwordx2 s[6:7], s[0:1], 8
    s_load_dwordx2 s[8:9], s[0:1], 80
    s_load_dwordx2 s[4:5], s[0:1], 0
    v_and_b32 v1, 63, v0
    v_and_b32 v2, 15, v0
    v_bfe_u32 v3, v0, 4, 2
    v_lshrrev_b32 v28, 6, v0
    s_nop 0
    v_readfirstlane_b32 s30, v28
    s_and_b32 s34, s2, 7
    s_lshr_b32 s35, s2, 3
    s_lshr_b32 s55, s30, 2
    s_and_b32 s30, s30, 3
    s_mul_i32 s36, s35, 43
    s_lshr_b32 s36, s36, 8
    s_mul_i32 s37, s36, 6
    s_sub_u32 s37, s35, s37
    s_lshr_b32 s38, s34, 1
    s_lshl_b32 s38, s38, 2
    s_add_u32 s38, s38, s36
    s_and_b32 s39, s34, 1
    s_mul_i32 s39, s39, 6
    s_add_u32 s39, s39, s37
    s_lshl_b32 s28, s38, 7
    s_lshl_b32 s29, s39, 7
    s_lshr_b32 s31, s30, 1
    s_and_b32 s32, s30, 1
    s_waitcnt lgkmcnt(0)
    s_mov_b32 s12, s4
    s_and_b32 s13, s5, 0xffff
    s_mov_b32 s14, 0x200000
    s_mov_b32 s15, 0x20000
    s_mov_b32 s16, s6
    s_and_b32 s17, s7, 0xffff
    s_mov_b32 s18, 0x180000
    s_mov_b32 s19, 0x20000
    s_mov_b32 s20, s8
    s_and_b32 s21, s9, 0xffff
    s_mov_b32 s22, 0x600000
    s_mov_b32 s23, 0x20000
    v_lshrrev_b32 v28, 3, v1
    v_and_b32 v29, 7, v1
    v_lshrrev_b32 v30, 1, v28
    v_xor_b32 v29, v29, v30
    v_mul_u32_u24 v28, 0x400, v28
    v_lshl_add_u32 v4, v29, 4, v28
    v_xor_b32 v29, 4, v29
    v_lshl_add_u32 v5, v29, 4, v28
    v_lshrrev_b32 v29, 1, v2
    v_xor_b32 v29, v29, v3
    v_and_b32 v30, 1, v2
    v_lshl_add_u32 v29, v29, 1, v30
    v_mul_u32_u24 v28, 0xc00, v3
    v_lshl_add_u32 v8, v29, 4, v28
    v_xor_b32 v29, 8, v29
    v_lshl_add_u32 v9, v29, 4, v28
    s_mul_i32 s33, s30, 32
    s_add_u32 s34, s28, s33
    s_mul_i32 s50, s34, 1024
    s_mul_i32 s51, s33, 128
    s_mul_i32 s33, s30, 16
    s_mul_i32 s52, s33, 3072
    s_lshl_b32 s34, s29, 1
    s_add_u32 s52, s52, s34
    s_mul_i32 s53, s33, 256
    s_add_u32 s53, s53, 16384
    s_cmp_eq_u32 s55, 0
    s_cbranch_scc1 L_qkv0_kernel_comp
    s_setprio 3
    s_add_u32 s34, s50, 0x0
    s_add_u32 m0, s51, 0x0
    s_nop 0
    buffer_load_dwordx4 v4, s[12:15], s34 offen lds
    s_add_u32 s34, s50, 0x2000
    s_add_u32 m0, s51, 0x400
    s_nop 0
    buffer_load_dwordx4 v5, s[12:15], s34 offen lds
    s_add_u32 s34, s50, 0x4000
    s_add_u32 m0, s51, 0x800
    s_nop 0
    buffer_load_dwordx4 v4, s[12:15], s34 offen lds
    s_add_u32 s34, s50, 0x6000
    s_add_u32 m0, s51, 0xc00
    s_nop 0
    buffer_load_dwordx4 v5, s[12:15], s34 offen lds
    s_add_u32 s34, s52, 0x0
    s_add_u32 m0, s53, 0x0
    s_nop 0
    buffer_load_dwordx4 v8, s[16:19], s34 offen lds
    s_add_u32 s34, s52, 0x3000
    s_add_u32 m0, s53, 0x400
    s_nop 0
    buffer_load_dwordx4 v8, s[16:19], s34 offen lds
    s_add_u32 s34, s52, 0x6000
    s_add_u32 m0, s53, 0x800
    s_nop 0
    buffer_load_dwordx4 v9, s[16:19], s34 offen lds
    s_add_u32 s34, s52, 0x9000
    s_add_u32 m0, s53, 0xc00
    s_nop 0
    buffer_load_dwordx4 v9, s[16:19], s34 offen lds
    s_add_u32 s34, s50, 0x80
    s_add_u32 m0, s51, 0x8000
    s_nop 0
    buffer_load_dwordx4 v4, s[12:15], s34 offen lds
    s_add_u32 s34, s50, 0x2080
    s_add_u32 m0, s51, 0x8400
    s_nop 0
    buffer_load_dwordx4 v5, s[12:15], s34 offen lds
    s_add_u32 s34, s50, 0x4080
    s_add_u32 m0, s51, 0x8800
    s_nop 0
    buffer_load_dwordx4 v4, s[12:15], s34 offen lds
    s_add_u32 s34, s50, 0x6080
    s_add_u32 m0, s51, 0x8c00
    s_nop 0
    buffer_load_dwordx4 v5, s[12:15], s34 offen lds
    s_add_u32 s34, s52, 0x30000
    s_add_u32 m0, s53, 0x8000
    s_nop 0
    buffer_load_dwordx4 v8, s[16:19], s34 offen lds
    s_add_u32 s34, s52, 0x33000
    s_add_u32 m0, s53, 0x8400
    s_nop 0
    buffer_load_dwordx4 v8, s[16:19], s34 offen lds
    s_add_u32 s34, s52, 0x36000
    s_add_u32 m0, s53, 0x8800
    s_nop 0
    buffer_load_dwordx4 v9, s[16:19], s34 offen lds
    s_add_u32 s34, s52, 0x39000
    s_add_u32 m0, s53, 0x8c00
    s_nop 0
    buffer_load_dwordx4 v9, s[16:19], s34 offen lds
    s_waitcnt vmcnt(8)
    s_barrier
    s_add_u32 s34, s50, 0x100
    s_add_u32 m0, s51, 0x10000
    s_nop 0
    buffer_load_dwordx4 v4, s[12:15], s34 offen lds
    s_add_u32 s34, s50, 0x2100
    s_add_u32 m0, s51, 0x10400
    s_nop 0
    buffer_load_dwordx4 v5, s[12:15], s34 offen lds
    s_add_u32 s34, s50, 0x4100
    s_add_u32 m0, s51, 0x10800
    s_nop 0
    buffer_load_dwordx4 v4, s[12:15], s34 offen lds
    s_add_u32 s34, s50, 0x6100
    s_add_u32 m0, s51, 0x10c00
    s_nop 0
    buffer_load_dwordx4 v5, s[12:15], s34 offen lds
    s_add_u32 s34, s52, 0x60000
    s_add_u32 m0, s53, 0x10000
    s_nop 0
    buffer_load_dwordx4 v8, s[16:19], s34 offen lds
    s_add_u32 s34, s52, 0x63000
    s_add_u32 m0, s53, 0x10400
    s_nop 0
    buffer_load_dwordx4 v8, s[16:19], s34 offen lds
    s_add_u32 s34, s52, 0x66000
    s_add_u32 m0, s53, 0x10800
    s_nop 0
    buffer_load_dwordx4 v9, s[16:19], s34 offen lds
    s_add_u32 s34, s52, 0x69000
    s_add_u32 m0, s53, 0x10c00
    s_nop 0
    buffer_load_dwordx4 v9, s[16:19], s34 offen lds
    s_add_u32 s34, s50, 0x180
    s_add_u32 m0, s51, 0x18000
    s_nop 0
    buffer_load_dwordx4 v4, s[12:15], s34 offen lds
    s_add_u32 s34, s50, 0x2180
    s_add_u32 m0, s51, 0x18400
    s_nop 0
    buffer_load_dwordx4 v5, s[12:15], s34 offen lds
    s_add_u32 s34, s50, 0x4180
    s_add_u32 m0, s51, 0x18800
    s_nop 0
    buffer_load_dwordx4 v4, s[12:15], s34 offen lds
    s_add_u32 s34, s50, 0x6180
    s_add_u32 m0, s51, 0x18c00
    s_nop 0
    buffer_load_dwordx4 v5, s[12:15], s34 offen lds
    s_add_u32 s34, s52, 0x90000
    s_add_u32 m0, s53, 0x18000
    s_nop 0
    buffer_load_dwordx4 v8, s[16:19], s34 offen lds
    s_add_u32 s34, s52, 0x93000
    s_add_u32 m0, s53, 0x18400
    s_nop 0
    buffer_load_dwordx4 v8, s[16:19], s34 offen lds
    s_add_u32 s34, s52, 0x96000
    s_add_u32 m0, s53, 0x18800
    s_nop 0
    buffer_load_dwordx4 v9, s[16:19], s34 offen lds
    s_add_u32 s34, s52, 0x99000
    s_add_u32 m0, s53, 0x18c00
    s_nop 0
    buffer_load_dwordx4 v9, s[16:19], s34 offen lds
    s_waitcnt vmcnt(16)
    s_barrier
    s_add_u32 s34, s50, 0x200
    s_add_u32 m0, s51, 0x0
    s_nop 0
    buffer_load_dwordx4 v4, s[12:15], s34 offen lds
    s_add_u32 s34, s50, 0x2200
    s_add_u32 m0, s51, 0x400
    s_nop 0
    buffer_load_dwordx4 v5, s[12:15], s34 offen lds
    s_add_u32 s34, s50, 0x4200
    s_add_u32 m0, s51, 0x800
    s_nop 0
    buffer_load_dwordx4 v4, s[12:15], s34 offen lds
    s_add_u32 s34, s50, 0x6200
    s_add_u32 m0, s51, 0xc00
    s_nop 0
    buffer_load_dwordx4 v5, s[12:15], s34 offen lds
    s_add_u32 s34, s52, 0xc0000
    s_add_u32 m0, s53, 0x0
    s_nop 0
    buffer_load_dwordx4 v8, s[16:19], s34 offen lds
    s_add_u32 s34, s52, 0xc3000
    s_add_u32 m0, s53, 0x400
    s_nop 0
    buffer_load_dwordx4 v8, s[16:19], s34 offen lds
    s_add_u32 s34, s52, 0xc6000
    s_add_u32 m0, s53, 0x800
    s_nop 0
    buffer_load_dwordx4 v9, s[16:19], s34 offen lds
    s_add_u32 s34, s52, 0xc9000
    s_add_u32 m0, s53, 0xc00
    s_nop 0
    buffer_load_dwordx4 v9, s[16:19], s34 offen lds
    s_waitcnt vmcnt(16)
    s_barrier
    s_add_u32 s34, s50, 0x280
    s_add_u32 m0, s51, 0x8000
    s_nop 0
    buffer_load_dwordx4 v4, s[12:15], s34 offen lds
    s_add_u32 s34, s50, 0x2280
    s_add_u32 m0, s51, 0x8400
    s_nop 0
    buffer_load_dwordx4 v5, s[12:15], s34 offen lds
    s_add_u32 s34, s50, 0x4280
    s_add_u32 m0, s51, 0x8800
    s_nop 0
    buffer_load_dwordx4 v4, s[12:15], s34 offen lds
    s_add_u32 s34, s50, 0x6280
    s_add_u32 m0, s51, 0x8c00
    s_nop 0
    buffer_load_dwordx4 v5, s[12:15], s34 offen lds
    s_add_u32 s34, s52, 0xf0000
    s_add_u32 m0, s53, 0x8000
    s_nop 0
    buffer_load_dwordx4 v8, s[16:19], s34 offen lds
    s_add_u32 s34, s52, 0xf3000
    s_add_u32 m0, s53, 0x8400
    s_nop 0
    buffer_load_dwordx4 v8, s[16:19], s34 offen lds
    s_add_u32 s34, s52, 0xf6000
    s_add_u32 m0, s53, 0x8800
    s_nop 0
    buffer_load_dwordx4 v9, s[16:19], s34 offen lds
    s_add_u32 s34, s52, 0xf9000
    s_add_u32 m0, s53, 0x8c00
    s_nop 0
    buffer_load_dwordx4 v9, s[16:19], s34 offen lds
    s_waitcnt vmcnt(16)
    s_barrier
    s_add_u32 s34, s50, 0x300
    s_add_u32 m0, s51, 0x10000
    s_nop 0
    buffer_load_dwordx4 v4, s[12:15], s34 offen lds
    s_add_u32 s34, s50, 0x2300
    s_add_u32 m0, s51, 0x10400
    s_nop 0
    buffer_load_dwordx4 v5, s[12:15], s34 offen lds
    s_add_u32 s34, s50, 0x4300
    s_add_u32 m0, s51, 0x10800
    s_nop 0
    buffer_load_dwordx4 v4, s[12:15], s34 offen lds
    s_add_u32 s34, s50, 0x6300
    s_add_u32 m0, s51, 0x10c00
    s_nop 0
    buffer_load_dwordx4 v5, s[12:15], s34 offen lds
    s_add_u32 s34, s52, 0x120000
    s_add_u32 m0, s53, 0x10000
    s_nop 0
    buffer_load_dwordx4 v8, s[16:19], s34 offen lds
    s_add_u32 s34, s52, 0x123000
    s_add_u32 m0, s53, 0x10400
    s_nop 0
    buffer_load_dwordx4 v8, s[16:19], s34 offen lds
    s_add_u32 s34, s52, 0x126000
    s_add_u32 m0, s53, 0x10800
    s_nop 0
    buffer_load_dwordx4 v9, s[16:19], s34 offen lds
    s_add_u32 s34, s52, 0x129000
    s_add_u32 m0, s53, 0x10c00
    s_nop 0
    buffer_load_dwordx4 v9, s[16:19], s34 offen lds
    s_waitcnt vmcnt(16)
    s_barrier
    s_add_u32 s34, s50, 0x380
    s_add_u32 m0, s51, 0x18000
    s_nop 0
    buffer_load_dwordx4 v4, s[12:15], s34 offen lds
    s_add_u32 s34, s50, 0x2380
    s_add_u32 m0, s51, 0x18400
    s_nop 0
    buffer_load_dwordx4 v5, s[12:15], s34 offen lds
    s_add_u32 s34, s50, 0x4380
    s_add_u32 m0, s51, 0x18800
    s_nop 0
    buffer_load_dwordx4 v4, s[12:15], s34 offen lds
    s_add_u32 s34, s50, 0x6380
    s_add_u32 m0, s51, 0x18c00
    s_nop 0
    buffer_load_dwordx4 v5, s[12:15], s34 offen lds
    s_add_u32 s34, s52, 0x150000
    s_add_u32 m0, s53, 0x18000
    s_nop 0
    buffer_load_dwordx4 v8, s[16:19], s34 offen lds
    s_add_u32 s34, s52, 0x153000
    s_add_u32 m0, s53, 0x18400
    s_nop 0
    buffer_load_dwordx4 v8, s[16:19], s34 offen lds
    s_add_u32 s34, s52, 0x156000
    s_add_u32 m0, s53, 0x18800
    s_nop 0
    buffer_load_dwordx4 v9, s[16:19], s34 offen lds
    s_add_u32 s34, s52, 0x159000
    s_add_u32 m0, s53, 0x18c00
    s_nop 0
    buffer_load_dwordx4 v9, s[16:19], s34 offen lds
    s_waitcnt vmcnt(16)
    s_barrier
    s_waitcnt vmcnt(8)
    s_barrier
    s_waitcnt vmcnt(0)
    s_barrier
    s_endpgm
L_qkv0_kernel_comp:
    s_mul_i32 s34, s31, 64
    v_add_u32 v28, s34, v2
    v_lshlrev_b32 v28, 7, v28
    v_lshrrev_b32 v29, 1, v2
    v_xor_b32 v29, v29, v3
    s_lshl_b32 s35, s32, 12
    v_xor_b32 v30, 0, v29
    v_lshl_add_u32 v30, v30, 4, v28
    v_add_u32 v14, s35, v30
    v_subrev_u32 v15, s35, v30
    v_xor_b32 v30, 4, v29
    v_lshl_add_u32 v30, v30, 4, v28
    v_add_u32 v16, s35, v30
    v_subrev_u32 v17, s35, v30
    v_bfe_u32 v28, v0, 2, 2
    v_lshl_add_u32 v29, v3, 3, v28
    v_lshlrev_b32 v29, 8, v29
    v_and_b32 v30, 3, v0
    v_lshl_add_u32 v29, v30, 3, v29
    v_add_u32 v29, 16384, v29
    v_and_b32 v30, 1, v3
    v_lshl_add_u32 v28, v30, 2, v28
    s_mul_i32 s34, s32, 4
    s_lshl_b32 s35, s31, 1
    s_xor_b32 s35, s35, 0
    s_add_u32 s34, s34, s35
    v_xor_b32 v30, s34, v28
    v_lshl_add_u32 v22, v30, 5, v29
    s_mul_i32 s34, s32, 4
    s_lshl_b32 s35, s31, 1
    s_xor_b32 s35, s35, 1
    s_add_u32 s34, s34, s35
    v_xor_b32 v30, s34, v28
    v_lshl_add_u32 v23, v30, 5, v29
    s_mul_i32 s34, s32, 4
    s_lshl_b32 s35, s31, 1
    s_xor_b32 s35, s35, 2
    s_add_u32 s34, s34, s35
    v_xor_b32 v30, s34, v28
    v_lshl_add_u32 v24, v30, 5, v29
    s_mul_i32 s34, s32, 4
    s_lshl_b32 s35, s31, 1
    s_xor_b32 s35, s35, 3
    s_add_u32 s34, s34, s35
    v_xor_b32 v30, s34, v28
    v_lshl_add_u32 v25, v30, 5, v29
    v_mov_b32 v120, 0x3f803f80
    v_mov_b32 v121, 0x3f803f80
    v_mov_b32 v122, 0x3f803f80
    v_mov_b32 v123, 0x3f803f80
    s_barrier
    ds_read_b128 v[32:35], v14 offset:0
    ds_read_b128 v[36:39], v14 offset:2048
    ds_read_b128 v[40:43], v15 offset:4096
    ds_read_b128 v[44:47], v15 offset:6144
    ds_read_b64_tr_b16 v[64:65], v22 offset:0
    ds_read_b64_tr_b16 v[66:67], v22 offset:1024
    ds_read_b64_tr_b16 v[68:69], v23 offset:0
    ds_read_b64_tr_b16 v[70:71], v23 offset:1024
    ds_read_b64_tr_b16 v[72:73], v24 offset:0
    ds_read_b64_tr_b16 v[74:75], v24 offset:1024
    ds_read_b64_tr_b16 v[76:77], v25 offset:0
    ds_read_b64_tr_b16 v[78:79], v25 offset:1024
    s_waitcnt lgkmcnt(0)
    v_mfma_f32_16x16x32_bf16 v[128:131], v[64:67], v[32:35], 0
    ds_read_b128 v[48:51], v16 offset:0
    v_mfma_f32_16x16x32_bf16 v[144:147], v[64:67], v[36:39], 0
    ds_read_b128 v[52:55], v16 offset:2048
    v_mfma_f32_16x16x32_bf16 v[160:163], v[64:67], v[40:43], 0
    ds_read_b128 v[56:59], v17 offset:4096
    v_mfma_f32_16x16x32_bf16 v[176:179], v[64:67], v[44:47], 0
    ds_read_b128 v[60:63], v17 offset:6144
    v_mfma_f32_16x16x32_bf16 v[132:135], v[68:71], v[32:35], 0
    ds_read_b64_tr_b16 v[80:81], v22 offset:8192
    v_mfma_f32_16x16x32_bf16 v[148:151], v[68:71], v[36:39], 0
    ds_read_b64_tr_b16 v[82:83], v22 offset:9216
    v_mfma_f32_16x16x32_bf16 v[164:167], v[68:71], v[40:43], 0
    ds_read_b64_tr_b16 v[84:85], v23 offset:8192
    v_mfma_f32_16x16x32_bf16 v[180:183], v[68:71], v[44:47], 0
    ds_read_b64_tr_b16 v[86:87], v23 offset:9216
    v_mfma_f32_16x16x32_bf16 v[136:139], v[72:75], v[32:35], 0
    ds_read_b64_tr_b16 v[88:89], v24 offset:8192
    v_mfma_f32_16x16x32_bf16 v[152:155], v[72:75], v[36:39], 0
    ds_read_b64_tr_b16 v[90:91], v24 offset:9216
    v_mfma_f32_16x16x32_bf16 v[168:171], v[72:75], v[40:43], 0
    ds_read_b64_tr_b16 v[92:93], v25 offset:8192
    v_mfma_f32_16x16x32_bf16 v[184:187], v[72:75], v[44:47], 0
    ds_read_b64_tr_b16 v[94:95], v25 offset:9216
    v_mfma_f32_16x16x32_bf16 v[140:143], v[76:79], v[32:35], 0
    v_mfma_f32_16x16x32_bf16 v[156:159], v[76:79], v[36:39], 0
    v_mfma_f32_16x16x32_bf16 v[172:175], v[76:79], v[40:43], 0
    v_mfma_f32_16x16x32_bf16 v[188:191], v[76:79], v[44:47], 0
    v_mfma_f32_16x16x32_bf16 v[192:195], v[120:123], v[32:35], 0
    v_mfma_f32_16x16x32_bf16 v[200:203], v[32:35], v[32:35], 0
    v_mfma_f32_16x16x32_bf16 v[208:211], v[64:67], v[120:123], 0
    v_mfma_f32_16x16x32_bf16 v[196:199], v[120:123], v[36:39], 0
    v_mfma_f32_16x16x32_bf16 v[204:207], v[36:39], v[36:39], 0
    v_mfma_f32_16x16x32_bf16 v[212:215], v[68:71], v[120:123], 0
    s_waitcnt lgkmcnt(0)
    s_barrier
    v_mfma_f32_16x16x32_bf16 v[128:131], v[80:83], v[48:51], v[128:131]
    ds_read_b128 v[32:35], v14 offset:32768
    v_mfma_f32_16x16x32_bf16 v[144:147], v[80:83], v[52:55], v[144:147]
    ds_read_b128 v[36:39], v14 offset:34816
    v_mfma_f32_16x16x32_bf16 v[160:163], v[80:83], v[56:59], v[160:163]
    ds_read_b128 v[40:43], v15 offset:36864
    v_mfma_f32_16x16x32_bf16 v[176:179], v[80:83], v[60:63], v[176:179]
    ds_read_b128 v[44:47], v15 offset:38912
    v_mfma_f32_16x16x32_bf16 v[132:135], v[84:87], v[48:51], v[132:135]
    ds_read_b64_tr_b16 v[64:65], v22 offset:32768
    v_mfma_f32_16x16x32_bf16 v[148:151], v[84:87], v[52:55], v[148:151]
    ds_read_b64_tr_b16 v[66:67], v22 offset:33792
    v_mfma_f32_16x16x32_bf16 v[164:167], v[84:87], v[56:59], v[164:167]
    ds_read_b64_tr_b16 v[68:69], v23 offset:32768
    v_mfma_f32_16x16x32_bf16 v[180:183], v[84:87], v[60:63], v[180:183]
    ds_read_b64_tr_b16 v[70:71], v23 offset:33792
    v_mfma_f32_16x16x32_bf16 v[136:139], v[88:91], v[48:51], v[136:139]
    ds_read_b64_tr_b16 v[72:73], v24 offset:32768
    v_mfma_f32_16x16x32_bf16 v[152:155], v[88:91], v[52:55], v[152:155]
    ds_read_b64_tr_b16 v[74:75], v24 offset:33792
    v_mfma_f32_16x16x32_bf16 v[168:171], v[88:91], v[56:59], v[168:171]
    ds_read_b64_tr_b16 v[76:77], v25 offset:32768
    v_mfma_f32_16x16x32_bf16 v[184:187], v[88:91], v[60:63], v[184:187]
    ds_read_b64_tr_b16 v[78:79], v25 offset:33792
    v_mfma_f32_16x16x32_bf16 v[140:143], v[92:95], v[48:51], v[140:143]
    v_mfma_f32_16x16x32_bf16 v[156:159], v[92:95], v[52:55], v[156:159]
    v_mfma_f32_16x16x32_bf16 v[172:175], v[92:95], v[56:59], v[172:175]
    v_mfma_f32_16x16x32_bf16 v[188:191], v[92:95], v[60:63], v[188:191]
    v_mfma_f32_16x16x32_bf16 v[192:195], v[120:123], v[48:51], v[192:195]
    v_mfma_f32_16x16x32_bf16 v[200:203], v[48:51], v[48:51], v[200:203]
    v_mfma_f32_16x16x32_bf16 v[208:211], v[80:83], v[120:123], v[208:211]
    v_mfma_f32_16x16x32_bf16 v[196:199], v[120:123], v[52:55], v[196:199]
    v_mfma_f32_16x16x32_bf16 v[204:207], v[52:55], v[52:55], v[204:207]
    v_mfma_f32_16x16x32_bf16 v[212:215], v[84:87], v[120:123], v[212:215]
    s_waitcnt lgkmcnt(0)
    v_mfma_f32_16x16x32_bf16 v[128:131], v[64:67], v[32:35], v[128:131]
    ds_read_b128 v[48:51], v16 offset:32768
    v_mfma_f32_16x16x32_bf16 v[144:147], v[64:67], v[36:39], v[144:147]
    ds_read_b128 v[52:55], v16 offset:34816
    v_mfma_f32_16x16x32_bf16 v[160:163], v[64:67], v[40:43], v[160:163]
    ds_read_b128 v[56:59], v17 offset:36864
    v_mfma_f32_16x16x32_bf16 v[176:179], v[64:67], v[44:47], v[176:179]
    ds_read_b128 v[60:63], v17 offset:38912
    v_mfma_f32_16x16x32_bf16 v[132:135], v[68:71], v[32:35], v[132:135]
    ds_read_b64_tr_b16 v[80:81], v22 offset:40960
    v_mfma_f32_16x16x32_bf16 v[148:151], v[68:71], v[36:39], v[148:151]
    ds_read_b64_tr_b16 v[82:83], v22 offset:41984
    v_mfma_f32_16x16x32_bf16 v[164:167], v[68:71], v[40:43], v[164:167]
    ds_read_b64_tr_b16 v[84:85], v23 offset:40960
    v_mfma_f32_16x16x32_bf16 v[180:183], v[68:71], v[44:47], v[180:183]
    ds_read_b64_tr_b16 v[86:87], v23 offset:41984
    v_mfma_f32_16x16x32_bf16 v[136:139], v[72:75], v[32:35], v[136:139]
    ds_read_b64_tr_b16 v[88:89], v24 offset:40960
    v_mfma_f32_16x16x32_bf16 v[152:155], v[72:75], v[36:39], v[152:155]
    ds_read_b64_tr_b16 v[90:91], v24 offset:41984
    v_mfma_f32_16x16x32_bf16 v[168:171], v[72:75], v[40:43], v[168:171]
    ds_read_b64_tr_b16 v[92:93], v25 offset:40960
    v_mfma_f32_16x16x32_bf16 v[184:187], v[72:75], v[44:47], v[184:187]
    ds_read_b64_tr_b16 v[94:95], v25 offset:41984
    v_mfma_f32_16x16x32_bf16 v[140:143], v[76:79], v[32:35], v[140:143]
    v_mfma_f32_16x16x32_bf16 v[156:159], v[76:79], v[36:39], v[156:159]
    v_mfma_f32_16x16x32_bf16 v[172:175], v[76:79], v[40:43], v[172:175]
    v_mfma_f32_16x16x32_bf16 v[188:191], v[76:79], v[44:47], v[188:191]
    v_mfma_f32_16x16x32_bf16 v[192:195], v[120:123], v[32:35], v[192:195]
    v_mfma_f32_16x16x32_bf16 v[200:203], v[32:35], v[32:35], v[200:203]
    v_mfma_f32_16x16x32_bf16 v[208:211], v[64:67], v[120:123], v[208:211]
    v_mfma_f32_16x16x32_bf16 v[196:199], v[120:123], v[36:39], v[196:199]
    v_mfma_f32_16x16x32_bf16 v[204:207], v[36:39], v[36:39], v[204:207]
    v_mfma_f32_16x16x32_bf16 v[212:215], v[68:71], v[120:123], v[212:215]
    s_waitcnt lgkmcnt(0)
    s_barrier
    v_mfma_f32_16x16x32_bf16 v[128:131], v[80:83], v[48:51], v[128:131]
    v_add_u32 v14, 0x10000, v14
    v_add_u32 v15, 0x10000, v15
    v_mfma_f32_16x16x32_bf16 v[144:147], v[80:83], v[52:55], v[144:147]
    v_add_u32 v16, 0x10000, v16
    v_add_u32 v17, 0x10000, v17
    v_mfma_f32_16x16x32_bf16 v[160:163], v[80:83], v[56:59], v[160:163]
    v_add_u32 v22, 0x10000, v22
    v_add_u32 v23, 0x10000, v23
    v_mfma_f32_16x16x32_bf16 v[176:179], v[80:83], v[60:63], v[176:179]
    v_add_u32 v24, 0x10000, v24
    v_add_u32 v25, 0x10000, v25
    v_mfma_f32_16x16x32_bf16 v[132:135], v[84:87], v[48:51], v[132:135]
    ds_read_b128 v[32:35], v14 offset:0
    ds_read_b128 v[36:39], v14 offset:2048
    v_mfma_f32_16x16x32_bf16 v[148:151], v[84:87], v[52:55], v[148:151]
    ds_read_b128 v[40:43], v15 offset:4096
    ds_read_b128 v[44:47], v15 offset:6144
    v_mfma_f32_16x16x32_bf16 v[164:167], v[84:87], v[56:59], v[164:167]
    ds_read_b64_tr_b16 v[64:65], v22 offset:0
    ds_read_b64_tr_b16 v[66:67], v22 offset:1024
    v_mfma_f32_16x16x32_bf16 v[180:183], v[84:87], v[60:63], v[180:183]
    ds_read_b64_tr_b16 v[68:69], v23 offset:0
    ds_read_b64_tr_b16 v[70:71], v23 offset:1024
    v_mfma_f32_16x16x32_bf16 v[136:139], v[88:91], v[48:51], v[136:139]
    ds_read_b64_tr_b16 v[72:73], v24 offset:0
    ds_read_b64_tr_b16 v[74:75], v24 offset:1024
    v_mfma_f32_16x16x32_bf16 v[152:155], v[88:91], v[52:55], v[152:155]
    ds_read_b64_tr_b16 v[76:77], v25 offset:0
    ds_read_b64_tr_b16 v[78:79], v25 offset:1024
    v_mfma_f32_16x16x32_bf16 v[168:171], v[88:91], v[56:59], v[168:171]
    v_mfma_f32_16x16x32_bf16 v[184:187], v[88:91], v[60:63], v[184:187]
    v_mfma_f32_16x16x32_bf16 v[140:143], v[92:95], v[48:51], v[140:143]
    v_mfma_f32_16x16x32_bf16 v[156:159], v[92:95], v[52:55], v[156:159]
    v_mfma_f32_16x16x32_bf16 v[172:175], v[92:95], v[56:59], v[172:175]
    v_mfma_f32_16x16x32_bf16 v[188:191], v[92:95], v[60:63], v[188:191]
    v_mfma_f32_16x16x32_bf16 v[192:195], v[120:123], v[48:51], v[192:195]
    v_mfma_f32_16x16x32_bf16 v[200:203], v[48:51], v[48:51], v[200:203]
    v_mfma_f32_16x16x32_bf16 v[208:211], v[80:83], v[120:123], v[208:211]
    v_mfma_f32_16x16x32_bf16 v[196:199], v[120:123], v[52:55], v[196:199]
    v_mfma_f32_16x16x32_bf16 v[204:207], v[52:55], v[52:55], v[204:207]
    v_mfma_f32_16x16x32_bf16 v[212:215], v[84:87], v[120:123], v[212:215]
    s_waitcnt lgkmcnt(0)
    v_mfma_f32_16x16x32_bf16 v[128:131], v[64:67], v[32:35], v[128:131]
    ds_read_b128 v[48:51], v16 offset:0
    v_mfma_f32_16x16x32_bf16 v[144:147], v[64:67], v[36:39], v[144:147]
    ds_read_b128 v[52:55], v16 offset:2048
    v_mfma_f32_16x16x32_bf16 v[160:163], v[64:67], v[40:43], v[160:163]
    ds_read_b128 v[56:59], v17 offset:4096
    v_mfma_f32_16x16x32_bf16 v[176:179], v[64:67], v[44:47], v[176:179]
    ds_read_b128 v[60:63], v17 offset:6144
    v_mfma_f32_16x16x32_bf16 v[132:135], v[68:71], v[32:35], v[132:135]
    ds_read_b64_tr_b16 v[80:81], v22 offset:8192
    v_mfma_f32_16x16x32_bf16 v[148:151], v[68:71], v[36:39], v[148:151]
    ds_read_b64_tr_b16 v[82:83], v22 offset:9216
    v_mfma_f32_16x16x32_bf16 v[164:167], v[68:71], v[40:43], v[164:167]
    ds_read_b64_tr_b16 v[84:85], v23 offset:8192
    v_mfma_f32_16x16x32_bf16 v[180:183], v[68:71], v[44:47], v[180:183]
    ds_read_b64_tr_b16 v[86:87], v23 offset:9216
    v_mfma_f32_16x16x32_bf16 v[136:139], v[72:75], v[32:35], v[136:139]
    ds_read_b64_tr_b16 v[88:89], v24 offset:8192
    v_mfma_f32_16x16x32_bf16 v[152:155], v[72:75], v[36:39], v[152:155]
    ds_read_b64_tr_b16 v[90:91], v24 offset:9216
    v_mfma_f32_16x16x32_bf16 v[168:171], v[72:75], v[40:43], v[168:171]
    ds_read_b64_tr_b16 v[92:93], v25 offset:8192
    v_mfma_f32_16x16x32_bf16 v[184:187], v[72:75], v[44:47], v[184:187]
    ds_read_b64_tr_b16 v[94:95], v25 offset:9216
    v_mfma_f32_16x16x32_bf16 v[140:143], v[76:79], v[32:35], v[140:143]
    v_mfma_f32_16x16x32_bf16 v[156:159], v[76:79], v[36:39], v[156:159]
    v_mfma_f32_16x16x32_bf16 v[172:175], v[76:79], v[40:43], v[172:175]
    v_mfma_f32_16x16x32_bf16 v[188:191], v[76:79], v[44:47], v[188:191]
    v_mfma_f32_16x16x32_bf16 v[192:195], v[120:123], v[32:35], v[192:195]
    v_mfma_f32_16x16x32_bf16 v[200:203], v[32:35], v[32:35], v[200:203]
    v_mfma_f32_16x16x32_bf16 v[208:211], v[64:67], v[120:123], v[208:211]
    v_mfma_f32_16x16x32_bf16 v[196:199], v[120:123], v[36:39], v[196:199]
    v_mfma_f32_16x16x32_bf16 v[204:207], v[36:39], v[36:39], v[204:207]
    v_mfma_f32_16x16x32_bf16 v[212:215], v[68:71], v[120:123], v[212:215]
    s_waitcnt lgkmcnt(0)
    s_barrier
    v_mfma_f32_16x16x32_bf16 v[128:131], v[80:83], v[48:51], v[128:131]
    ds_read_b128 v[32:35], v14 offset:32768
    v_mfma_f32_16x16x32_bf16 v[144:147], v[80:83], v[52:55], v[144:147]
    ds_read_b128 v[36:39], v14 offset:34816
    v_mfma_f32_16x16x32_bf16 v[160:163], v[80:83], v[56:59], v[160:163]
    ds_read_b128 v[40:43], v15 offset:36864
    v_mfma_f32_16x16x32_bf16 v[176:179], v[80:83], v[60:63], v[176:179]
    ds_read_b128 v[44:47], v15 offset:38912
    v_mfma_f32_16x16x32_bf16 v[132:135], v[84:87], v[48:51], v[132:135]
    ds_read_b64_tr_b16 v[64:65], v22 offset:32768
    v_mfma_f32_16x16x32_bf16 v[148:151], v[84:87], v[52:55], v[148:151]
    ds_read_b64_tr_b16 v[66:67], v22 offset:33792
    v_mfma_f32_16x16x32_bf16 v[164:167], v[84:87], v[56:59], v[164:167]
    ds_read_b64_tr_b16 v[68:69], v23 offset:32768
    v_mfma_f32_16x16x32_bf16 v[180:183], v[84:87], v[60:63], v[180:183]
    ds_read_b64_tr_b16 v[70:71], v23 offset:33792
    v_mfma_f32_16x16x32_bf16 v[136:139], v[88:91], v[48:51], v[136:139]
    ds_read_b64_tr_b16 v[72:73], v24 offset:32768
    v_mfma_f32_16x16x32_bf16 v[152:155], v[88:91], v[52:55], v[152:155]
    ds_read_b64_tr_b16 v[74:75], v24 offset:33792
    v_mfma_f32_16x16x32_bf16 v[168:171], v[88:91], v[56:59], v[168:171]
    ds_read_b64_tr_b16 v[76:77], v25 offset:32768
    v_mfma_f32_16x16x32_bf16 v[184:187], v[88:91], v[60:63], v[184:187]
    ds_read_b64_tr_b16 v[78:79], v25 offset:33792
    v_mfma_f32_16x16x32_bf16 v[140:143], v[92:95], v[48:51], v[140:143]
    v_mfma_f32_16x16x32_bf16 v[156:159], v[92:95], v[52:55], v[156:159]
    v_mfma_f32_16x16x32_bf16 v[172:175], v[92:95], v[56:59], v[172:175]
    v_mfma_f32_16x16x32_bf16 v[188:191], v[92:95], v[60:63], v[188:191]
    v_mfma_f32_16x16x32_bf16 v[192:195], v[120:123], v[48:51], v[192:195]
    v_mfma_f32_16x16x32_bf16 v[200:203], v[48:51], v[48:51], v[200:203]
    v_mfma_f32_16x16x32_bf16 v[208:211], v[80:83], v[120:123], v[208:211]
    v_mfma_f32_16x16x32_bf16 v[196:199], v[120:123], v[52:55], v[196:199]
    v_mfma_f32_16x16x32_bf16 v[204:207], v[52:55], v[52:55], v[204:207]
    v_mfma_f32_16x16x32_bf16 v[212:215], v[84:87], v[120:123], v[212:215]
    s_waitcnt lgkmcnt(0)
    v_mfma_f32_16x16x32_bf16 v[128:131], v[64:67], v[32:35], v[128:131]
    ds_read_b128 v[48:51], v16 offset:32768
    v_mfma_f32_16x16x32_bf16 v[144:147], v[64:67], v[36:39], v[144:147]
    ds_read_b128 v[52:55], v16 offset:34816
    v_mfma_f32_16x16x32_bf16 v[160:163], v[64:67], v[40:43], v[160:163]
    ds_read_b128 v[56:59], v17 offset:36864
    v_mfma_f32_16x16x32_bf16 v[176:179], v[64:67], v[44:47], v[176:179]
    ds_read_b128 v[60:63], v17 offset:38912
    v_mfma_f32_16x16x32_bf16 v[132:135], v[68:71], v[32:35], v[132:135]
    ds_read_b64_tr_b16 v[80:81], v22 offset:40960
    v_mfma_f32_16x16x32_bf16 v[148:151], v[68:71], v[36:39], v[148:151]
    ds_read_b64_tr_b16 v[82:83], v22 offset:41984
    v_mfma_f32_16x16x32_bf16 v[164:167], v[68:71], v[40:43], v[164:167]
    ds_read_b64_tr_b16 v[84:85], v23 offset:40960
    v_mfma_f32_16x16x32_bf16 v[180:183], v[68:71], v[44:47], v[180:183]
    ds_read_b64_tr_b16 v[86:87], v23 offset:41984
    v_mfma_f32_16x16x32_bf16 v[136:139], v[72:75], v[32:35], v[136:139]
    ds_read_b64_tr_b16 v[88:89], v24 offset:40960
    v_mfma_f32_16x16x32_bf16 v[152:155], v[72:75], v[36:39], v[152:155]
    ds_read_b64_tr_b16 v[90:91], v24 offset:41984
    v_mfma_f32_16x16x32_bf16 v[168:171], v[72:75], v[40:43], v[168:171]
    ds_read_b64_tr_b16 v[92:93], v25 offset:40960
    v_mfma_f32_16x16x32_bf16 v[184:187], v[72:75], v[44:47], v[184:187]
    ds_read_b64_tr_b16 v[94:95], v25 offset:41984
    v_mfma_f32_16x16x32_bf16 v[140:143], v[76:79], v[32:35], v[140:143]
    v_mfma_f32_16x16x32_bf16 v[156:159], v[76:79], v[36:39], v[156:159]
    v_mfma_f32_16x16x32_bf16 v[172:175], v[76:79], v[40:43], v[172:175]
    v_mfma_f32_16x16x32_bf16 v[188:191], v[76:79], v[44:47], v[188:191]
    v_mfma_f32_16x16x32_bf16 v[192:195], v[120:123], v[32:35], v[192:195]
    v_mfma_f32_16x16x32_bf16 v[200:203], v[32:35], v[32:35], v[200:203]
    v_mfma_f32_16x16x32_bf16 v[208:211], v[64:67], v[120:123], v[208:211]
    v_mfma_f32_16x16x32_bf16 v[196:199], v[120:123], v[36:39], v[196:199]
    v_mfma_f32_16x16x32_bf16 v[204:207], v[36:39], v[36:39], v[204:207]
    v_mfma_f32_16x16x32_bf16 v[212:215], v[68:71], v[120:123], v[212:215]
    s_waitcnt lgkmcnt(0)
    s_barrier
    v_mfma_f32_16x16x32_bf16 v[128:131], v[80:83], v[48:51], v[128:131]
    v_add_u32 v14, 0xffff0000, v14
    v_add_u32 v15, 0xffff0000, v15
    v_mfma_f32_16x16x32_bf16 v[144:147], v[80:83], v[52:55], v[144:147]
    v_add_u32 v16, 0xffff0000, v16
    v_add_u32 v17, 0xffff0000, v17
    v_mfma_f32_16x16x32_bf16 v[160:163], v[80:83], v[56:59], v[160:163]
    v_add_u32 v22, 0xffff0000, v22
    v_add_u32 v23, 0xffff0000, v23
    v_mfma_f32_16x16x32_bf16 v[176:179], v[80:83], v[60:63], v[176:179]
    v_add_u32 v24, 0xffff0000, v24
    v_add_u32 v25, 0xffff0000, v25
    v_mfma_f32_16x16x32_bf16 v[132:135], v[84:87], v[48:51], v[132:135]
    ds_read_b128 v[32:35], v14 offset:0
    ds_read_b128 v[36:39], v14 offset:2048
    v_mfma_f32_16x16x32_bf16 v[148:151], v[84:87], v[52:55], v[148:151]
    ds_read_b128 v[40:43], v15 offset:4096
    ds_read_b128 v[44:47], v15 offset:6144
    v_mfma_f32_16x16x32_bf16 v[164:167], v[84:87], v[56:59], v[164:167]
    ds_read_b64_tr_b16 v[64:65], v22 offset:0
    ds_read_b64_tr_b16 v[66:67], v22 offset:1024
    v_mfma_f32_16x16x32_bf16 v[180:183], v[84:87], v[60:63], v[180:183]
    ds_read_b64_tr_b16 v[68:69], v23 offset:0
    ds_read_b64_tr_b16 v[70:71], v23 offset:1024
    v_mfma_f32_16x16x32_bf16 v[136:139], v[88:91], v[48:51], v[136:139]
    ds_read_b64_tr_b16 v[72:73], v24 offset:0
    ds_read_b64_tr_b16 v[74:75], v24 offset:1024
    v_mfma_f32_16x16x32_bf16 v[152:155], v[88:91], v[52:55], v[152:155]
    ds_read_b64_tr_b16 v[76:77], v25 offset:0
    ds_read_b64_tr_b16 v[78:79], v25 offset:1024
    v_mfma_f32_16x16x32_bf16 v[168:171], v[88:91], v[56:59], v[168:171]
    v_mfma_f32_16x16x32_bf16 v[184:187], v[88:91], v[60:63], v[184:187]
    v_mfma_f32_16x16x32_bf16 v[140:143], v[92:95], v[48:51], v[140:143]
    v_mfma_f32_16x16x32_bf16 v[156:159], v[92:95], v[52:55], v[156:159]
    v_mfma_f32_16x16x32_bf16 v[172:175], v[92:95], v[56:59], v[172:175]
    v_mfma_f32_16x16x32_bf16 v[188:191], v[92:95], v[60:63], v[188:191]
    v_mfma_f32_16x16x32_bf16 v[192:195], v[120:123], v[48:51], v[192:195]
    v_mfma_f32_16x16x32_bf16 v[200:203], v[48:51], v[48:51], v[200:203]
    v_mfma_f32_16x16x32_bf16 v[208:211], v[80:83], v[120:123], v[208:211]
    v_mfma_f32_16x16x32_bf16 v[196:199], v[120:123], v[52:55], v[196:199]
    v_mfma_f32_16x16x32_bf16 v[204:207], v[52:55], v[52:55], v[204:207]
    v_mfma_f32_16x16x32_bf16 v[212:215], v[84:87], v[120:123], v[212:215]
    s_waitcnt lgkmcnt(0)
    v_mfma_f32_16x16x32_bf16 v[128:131], v[64:67], v[32:35], v[128:131]
    ds_read_b128 v[48:51], v16 offset:0
    v_mfma_f32_16x16x32_bf16 v[144:147], v[64:67], v[36:39], v[144:147]
    ds_read_b128 v[52:55], v16 offset:2048
    v_mfma_f32_16x16x32_bf16 v[160:163], v[64:67], v[40:43], v[160:163]
    ds_read_b128 v[56:59], v17 offset:4096
    v_mfma_f32_16x16x32_bf16 v[176:179], v[64:67], v[44:47], v[176:179]
    ds_read_b128 v[60:63], v17 offset:6144
    v_mfma_f32_16x16x32_bf16 v[132:135], v[68:71], v[32:35], v[132:135]
    ds_read_b64_tr_b16 v[80:81], v22 offset:8192
    v_mfma_f32_16x16x32_bf16 v[148:151], v[68:71], v[36:39], v[148:151]
    ds_read_b64_tr_b16 v[82:83], v22 offset:9216
    v_mfma_f32_16x16x32_bf16 v[164:167], v[68:71], v[40:43], v[164:167]
    ds_read_b64_tr_b16 v[84:85], v23 offset:8192
    v_mfma_f32_16x16x32_bf16 v[180:183], v[68:71], v[44:47], v[180:183]
    ds_read_b64_tr_b16 v[86:87], v23 offset:9216
    v_mfma_f32_16x16x32_bf16 v[136:139], v[72:75], v[32:35], v[136:139]
    ds_read_b64_tr_b16 v[88:89], v24 offset:8192
    v_mfma_f32_16x16x32_bf16 v[152:155], v[72:75], v[36:39], v[152:155]
    ds_read_b64_tr_b16 v[90:91], v24 offset:9216
    v_mfma_f32_16x16x32_bf16 v[168:171], v[72:75], v[40:43], v[168:171]
    ds_read_b64_tr_b16 v[92:93], v25 offset:8192
    v_mfma_f32_16x16x32_bf16 v[184:187], v[72:75], v[44:47], v[184:187]
    ds_read_b64_tr_b16 v[94:95], v25 offset:9216
    v_mfma_f32_16x16x32_bf16 v[140:143], v[76:79], v[32:35], v[140:143]
    v_mfma_f32_16x16x32_bf16 v[156:159], v[76:79], v[36:39], v[156:159]
    v_mfma_f32_16x16x32_bf16 v[172:175], v[76:79], v[40:43], v[172:175]
    v_mfma_f32_16x16x32_bf16 v[188:191], v[76:79], v[44:47], v[188:191]
    v_mfma_f32_16x16x32_bf16 v[192:195], v[120:123], v[32:35], v[192:195]
    v_mfma_f32_16x16x32_bf16 v[200:203], v[32:35], v[32:35], v[200:203]
    v_mfma_f32_16x16x32_bf16 v[208:211], v[64:67], v[120:123], v[208:211]
    v_mfma_f32_16x16x32_bf16 v[196:199], v[120:123], v[36:39], v[196:199]
    v_mfma_f32_16x16x32_bf16 v[204:207], v[36:39], v[36:39], v[204:207]
    v_mfma_f32_16x16x32_bf16 v[212:215], v[68:71], v[120:123], v[212:215]
    s_waitcnt lgkmcnt(0)
    s_barrier
    v_mfma_f32_16x16x32_bf16 v[128:131], v[80:83], v[48:51], v[128:131]
    ds_read_b128 v[32:35], v14 offset:32768
    v_mfma_f32_16x16x32_bf16 v[144:147], v[80:83], v[52:55], v[144:147]
    ds_read_b128 v[36:39], v14 offset:34816
    v_mfma_f32_16x16x32_bf16 v[160:163], v[80:83], v[56:59], v[160:163]
    ds_read_b128 v[40:43], v15 offset:36864
    v_mfma_f32_16x16x32_bf16 v[176:179], v[80:83], v[60:63], v[176:179]
    ds_read_b128 v[44:47], v15 offset:38912
    v_mfma_f32_16x16x32_bf16 v[132:135], v[84:87], v[48:51], v[132:135]
    ds_read_b64_tr_b16 v[64:65], v22 offset:32768
    v_mfma_f32_16x16x32_bf16 v[148:151], v[84:87], v[52:55], v[148:151]
    ds_read_b64_tr_b16 v[66:67], v22 offset:33792
    v_mfma_f32_16x16x32_bf16 v[164:167], v[84:87], v[56:59], v[164:167]
    ds_read_b64_tr_b16 v[68:69], v23 offset:32768
    v_mfma_f32_16x16x32_bf16 v[180:183], v[84:87], v[60:63], v[180:183]
    ds_read_b64_tr_b16 v[70:71], v23 offset:33792
    v_mfma_f32_16x16x32_bf16 v[136:139], v[88:91], v[48:51], v[136:139]
    ds_read_b64_tr_b16 v[72:73], v24 offset:32768
    v_mfma_f32_16x16x32_bf16 v[152:155], v[88:91], v[52:55], v[152:155]
    ds_read_b64_tr_b16 v[74:75], v24 offset:33792
    v_mfma_f32_16x16x32_bf16 v[168:171], v[88:91], v[56:59], v[168:171]
    ds_read_b64_tr_b16 v[76:77], v25 offset:32768
    v_mfma_f32_16x16x32_bf16 v[184:187], v[88:91], v[60:63], v[184:187]
    ds_read_b64_tr_b16 v[78:79], v25 offset:33792
    v_mfma_f32_16x16x32_bf16 v[140:143], v[92:95], v[48:51], v[140:143]
    v_mfma_f32_16x16x32_bf16 v[156:159], v[92:95], v[52:55], v[156:159]
    v_mfma_f32_16x16x32_bf16 v[172:175], v[92:95], v[56:59], v[172:175]
    v_mfma_f32_16x16x32_bf16 v[188:191], v[92:95], v[60:63], v[188:191]
    v_mfma_f32_16x16x32_bf16 v[192:195], v[120:123], v[48:51], v[192:195]
    v_mfma_f32_16x16x32_bf16 v[200:203], v[48:51], v[48:51], v[200:203]
    v_mfma_f32_16x16x32_bf16 v[208:211], v[80:83], v[120:123], v[208:211]
    v_mfma_f32_16x16x32_bf16 v[196:199], v[120:123], v[52:55], v[196:199]
    v_mfma_f32_16x16x32_bf16 v[204:207], v[52:55], v[52:55], v[204:207]
    v_mfma_f32_16x16x32_bf16 v[212:215], v[84:87], v[120:123], v[212:215]
    s_waitcnt lgkmcnt(0)
    v_mfma_f32_16x16x32_bf16 v[128:131], v[64:67], v[32:35], v[128:131]
    ds_read_b128 v[48:51], v16 offset:32768
    v_mfma_f32_16x16x32_bf16 v[144:147], v[64:67], v[36:39], v[144:147]
    ds_read_b128 v[52:55], v16 offset:34816
    v_mfma_f32_16x16x32_bf16 v[160:163], v[64:67], v[40:43], v[160:163]
    ds_read_b128 v[56:59], v17 offset:36864
    v_mfma_f32_16x16x32_bf16 v[176:179], v[64:67], v[44:47], v[176:179]
    ds_read_b128 v[60:63], v17 offset:38912
    v_mfma_f32_16x16x32_bf16 v[132:135], v[68:71], v[32:35], v[132:135]
    ds_read_b64_tr_b16 v[80:81], v22 offset:40960
    v_mfma_f32_16x16x32_bf16 v[148:151], v[68:71], v[36:39], v[148:151]
    ds_read_b64_tr_b16 v[82:83], v22 offset:41984
    v_mfma_f32_16x16x32_bf16 v[164:167], v[68:71], v[40:43], v[164:167]
    ds_read_b64_tr_b16 v[84:85], v23 offset:40960
    v_mfma_f32_16x16x32_bf16 v[180:183], v[68:71], v[44:47], v[180:183]
    ds_read_b64_tr_b16 v[86:87], v23 offset:41984
    v_mfma_f32_16x16x32_bf16 v[136:139], v[72:75], v[32:35], v[136:139]
    ds_read_b64_tr_b16 v[88:89], v24 offset:40960
    v_mfma_f32_16x16x32_bf16 v[152:155], v[72:75], v[36:39], v[152:155]
    ds_read_b64_tr_b16 v[90:91], v24 offset:41984
    v_mfma_f32_16x16x32_bf16 v[168:171], v[72:75], v[40:43], v[168:171]
    ds_read_b64_tr_b16 v[92:93], v25 offset:40960
    v_mfma_f32_16x16x32_bf16 v[184:187], v[72:75], v[44:47], v[184:187]
    ds_read_b64_tr_b16 v[94:95], v25 offset:41984
    v_mfma_f32_16x16x32_bf16 v[140:143], v[76:79], v[32:35], v[140:143]
    v_mfma_f32_16x16x32_bf16 v[156:159], v[76:79], v[36:39], v[156:159]
    v_mfma_f32_16x16x32_bf16 v[172:175], v[76:79], v[40:43], v[172:175]
    v_mfma_f32_16x16x32_bf16 v[188:191], v[76:79], v[44:47], v[188:191]
    v_mfma_f32_16x16x32_bf16 v[192:195], v[120:123], v[32:35], v[192:195]
    v_mfma_f32_16x16x32_bf16 v[200:203], v[32:35], v[32:35], v[200:203]
    v_mfma_f32_16x16x32_bf16 v[208:211], v[64:67], v[120:123], v[208:211]
    v_mfma_f32_16x16x32_bf16 v[196:199], v[120:123], v[36:39], v[196:199]
    v_mfma_f32_16x16x32_bf16 v[204:207], v[36:39], v[36:39], v[204:207]
    v_mfma_f32_16x16x32_bf16 v[212:215], v[68:71], v[120:123], v[212:215]
    s_waitcnt lgkmcnt(0)
    s_barrier
    v_mfma_f32_16x16x32_bf16 v[128:131], v[80:83], v[48:51], v[128:131]
    v_add_u32 v14, 0x10000, v14
    v_add_u32 v15, 0x10000, v15
    v_mfma_f32_16x16x32_bf16 v[144:147], v[80:83], v[52:55], v[144:147]
    v_add_u32 v16, 0x10000, v16
    v_add_u32 v17, 0x10000, v17
    v_mfma_f32_16x16x32_bf16 v[160:163], v[80:83], v[56:59], v[160:163]
    v_add_u32 v22, 0x10000, v22
    v_add_u32 v23, 0x10000, v23
    v_mfma_f32_16x16x32_bf16 v[176:179], v[80:83], v[60:63], v[176:179]
    v_add_u32 v24, 0x10000, v24
    v_add_u32 v25, 0x10000, v25
    v_mfma_f32_16x16x32_bf16 v[132:135], v[84:87], v[48:51], v[132:135]
    ds_read_b128 v[32:35], v14 offset:0
    ds_read_b128 v[36:39], v14 offset:2048
    v_mfma_f32_16x16x32_bf16 v[148:151], v[84:87], v[52:55], v[148:151]
    ds_read_b128 v[40:43], v15 offset:4096
    ds_read_b128 v[44:47], v15 offset:6144
    v_mfma_f32_16x16x32_bf16 v[164:167], v[84:87], v[56:59], v[164:167]
    ds_read_b64_tr_b16 v[64:65], v22 offset:0
    ds_read_b64_tr_b16 v[66:67], v22 offset:1024
    v_mfma_f32_16x16x32_bf16 v[180:183], v[84:87], v[60:63], v[180:183]
    ds_read_b64_tr_b16 v[68:69], v23 offset:0
    ds_read_b64_tr_b16 v[70:71], v23 offset:1024
    v_mfma_f32_16x16x32_bf16 v[136:139], v[88:91], v[48:51], v[136:139]
    ds_read_b64_tr_b16 v[72:73], v24 offset:0
    ds_read_b64_tr_b16 v[74:75], v24 offset:1024
    v_mfma_f32_16x16x32_bf16 v[152:155], v[88:91], v[52:55], v[152:155]
    ds_read_b64_tr_b16 v[76:77], v25 offset:0
    ds_read_b64_tr_b16 v[78:79], v25 offset:1024
    v_mfma_f32_16x16x32_bf16 v[168:171], v[88:91], v[56:59], v[168:171]
    v_mfma_f32_16x16x32_bf16 v[184:187], v[88:91], v[60:63], v[184:187]
    v_mfma_f32_16x16x32_bf16 v[140:143], v[92:95], v[48:51], v[140:143]
    v_mfma_f32_16x16x32_bf16 v[156:159], v[92:95], v[52:55], v[156:159]
    v_mfma_f32_16x16x32_bf16 v[172:175], v[92:95], v[56:59], v[172:175]
    v_mfma_f32_16x16x32_bf16 v[188:191], v[92:95], v[60:63], v[188:191]
    v_mfma_f32_16x16x32_bf16 v[192:195], v[120:123], v[48:51], v[192:195]
    v_mfma_f32_16x16x32_bf16 v[200:203], v[48:51], v[48:51], v[200:203]
    v_mfma_f32_16x16x32_bf16 v[208:211], v[80:83], v[120:123], v[208:211]
    v_mfma_f32_16x16x32_bf16 v[196:199], v[120:123], v[52:55], v[196:199]
    v_mfma_f32_16x16x32_bf16 v[204:207], v[52:55], v[52:55], v[204:207]
    v_mfma_f32_16x16x32_bf16 v[212:215], v[84:87], v[120:123], v[212:215]
    s_waitcnt lgkmcnt(0)
    v_mfma_f32_16x16x32_bf16 v[128:131], v[64:67], v[32:35], v[128:131]
    ds_read_b128 v[48:51], v16 offset:0
    v_mfma_f32_16x16x32_bf16 v[144:147], v[64:67], v[36:39], v[144:147]
    ds_read_b128 v[52:55], v16 offset:2048
    v_mfma_f32_16x16x32_bf16 v[160:163], v[64:67], v[40:43], v[160:163]
    ds_read_b128 v[56:59], v17 offset:4096
    v_mfma_f32_16x16x32_bf16 v[176:179], v[64:67], v[44:47], v[176:179]
    ds_read_b128 v[60:63], v17 offset:6144
    v_mfma_f32_16x16x32_bf16 v[132:135], v[68:71], v[32:35], v[132:135]
    ds_read_b64_tr_b16 v[80:81], v22 offset:8192
    v_mfma_f32_16x16x32_bf16 v[148:151], v[68:71], v[36:39], v[148:151]
    ds_read_b64_tr_b16 v[82:83], v22 offset:9216
    v_mfma_f32_16x16x32_bf16 v[164:167], v[68:71], v[40:43], v[164:167]
    ds_read_b64_tr_b16 v[84:85], v23 offset:8192
    v_mfma_f32_16x16x32_bf16 v[180:183], v[68:71], v[44:47], v[180:183]
    ds_read_b64_tr_b16 v[86:87], v23 offset:9216
    v_mfma_f32_16x16x32_bf16 v[136:139], v[72:75], v[32:35], v[136:139]
    ds_read_b64_tr_b16 v[88:89], v24 offset:8192
    v_mfma_f32_16x16x32_bf16 v[152:155], v[72:75], v[36:39], v[152:155]
    ds_read_b64_tr_b16 v[90:91], v24 offset:9216
    v_mfma_f32_16x16x32_bf16 v[168:171], v[72:75], v[40:43], v[168:171]
    ds_read_b64_tr_b16 v[92:93], v25 offset:8192
    v_mfma_f32_16x16x32_bf16 v[184:187], v[72:75], v[44:47], v[184:187]
    ds_read_b64_tr_b16 v[94:95], v25 offset:9216
    v_mfma_f32_16x16x32_bf16 v[140:143], v[76:79], v[32:35], v[140:143]
    v_mfma_f32_16x16x32_bf16 v[156:159], v[76:79], v[36:39], v[156:159]
    v_mfma_f32_16x16x32_bf16 v[172:175], v[76:79], v[40:43], v[172:175]
    v_mfma_f32_16x16x32_bf16 v[188:191], v[76:79], v[44:47], v[188:191]
    v_mfma_f32_16x16x32_bf16 v[192:195], v[120:123], v[32:35], v[192:195]
    v_mfma_f32_16x16x32_bf16 v[200:203], v[32:35], v[32:35], v[200:203]
    v_mfma_f32_16x16x32_bf16 v[208:211], v[64:67], v[120:123], v[208:211]
    v_mfma_f32_16x16x32_bf16 v[196:199], v[120:123], v[36:39], v[196:199]
    v_mfma_f32_16x16x32_bf16 v[204:207], v[36:39], v[36:39], v[204:207]
    v_mfma_f32_16x16x32_bf16 v[212:215], v[68:71], v[120:123], v[212:215]
    s_waitcnt lgkmcnt(0)
    s_barrier
    v_mfma_f32_16x16x32_bf16 v[128:131], v[80:83], v[48:51], v[128:131]
    ds_read_b128 v[32:35], v14 offset:32768
    v_mfma_f32_16x16x32_bf16 v[144:147], v[80:83], v[52:55], v[144:147]
    ds_read_b128 v[36:39], v14 offset:34816
    v_mfma_f32_16x16x32_bf16 v[160:163], v[80:83], v[56:59], v[160:163]
    ds_read_b128 v[40:43], v15 offset:36864
    v_mfma_f32_16x16x32_bf16 v[176:179], v[80:83], v[60:63], v[176:179]
    ds_read_b128 v[44:47], v15 offset:38912
    v_mfma_f32_16x16x32_bf16 v[132:135], v[84:87], v[48:51], v[132:135]
    ds_read_b64_tr_b16 v[64:65], v22 offset:32768
    v_mfma_f32_16x16x32_bf16 v[148:151], v[84:87], v[52:55], v[148:151]
    ds_read_b64_tr_b16 v[66:67], v22 offset:33792
    v_mfma_f32_16x16x32_bf16 v[164:167], v[84:87], v[56:59], v[164:167]
    ds_read_b64_tr_b16 v[68:69], v23 offset:32768
    v_mfma_f32_16x16x32_bf16 v[180:183], v[84:87], v[60:63], v[180:183]
    ds_read_b64_tr_b16 v[70:71], v23 offset:33792
    v_mfma_f32_16x16x32_bf16 v[136:139], v[88:91], v[48:51], v[136:139]
    ds_read_b64_tr_b16 v[72:73], v24 offset:32768
    v_mfma_f32_16x16x32_bf16 v[152:155], v[88:91], v[52:55], v[152:155]
    ds_read_b64_tr_b16 v[74:75], v24 offset:33792
    v_mfma_f32_16x16x32_bf16 v[168:171], v[88:91], v[56:59], v[168:171]
    ds_read_b64_tr_b16 v[76:77], v25 offset:32768
    v_mfma_f32_16x16x32_bf16 v[184:187], v[88:91], v[60:63], v[184:187]
    ds_read_b64_tr_b16 v[78:79], v25 offset:33792
    v_mfma_f32_16x16x32_bf16 v[140:143], v[92:95], v[48:51], v[140:143]
    v_mfma_f32_16x16x32_bf16 v[156:159], v[92:95], v[52:55], v[156:159]
    v_mfma_f32_16x16x32_bf16 v[172:175], v[92:95], v[56:59], v[172:175]
    v_mfma_f32_16x16x32_bf16 v[188:191], v[92:95], v[60:63], v[188:191]
    v_mfma_f32_16x16x32_bf16 v[192:195], v[120:123], v[48:51], v[192:195]
    v_mfma_f32_16x16x32_bf16 v[200:203], v[48:51], v[48:51], v[200:203]
    v_mfma_f32_16x16x32_bf16 v[208:211], v[80:83], v[120:123], v[208:211]
    v_mfma_f32_16x16x32_bf16 v[196:199], v[120:123], v[52:55], v[196:199]
    v_mfma_f32_16x16x32_bf16 v[204:207], v[52:55], v[52:55], v[204:207]
    v_mfma_f32_16x16x32_bf16 v[212:215], v[84:87], v[120:123], v[212:215]
    s_waitcnt lgkmcnt(0)
    v_mfma_f32_16x16x32_bf16 v[128:131], v[64:67], v[32:35], v[128:131]
    ds_read_b128 v[48:51], v16 offset:32768
    v_mfma_f32_16x16x32_bf16 v[144:147], v[64:67], v[36:39], v[144:147]
    ds_read_b128 v[52:55], v16 offset:34816
    v_mfma_f32_16x16x32_bf16 v[160:163], v[64:67], v[40:43], v[160:163]
    ds_read_b128 v[56:59], v17 offset:36864
    v_mfma_f32_16x16x32_bf16 v[176:179], v[64:67], v[44:47], v[176:179]
    ds_read_b128 v[60:63], v17 offset:38912
    v_mfma_f32_16x16x32_bf16 v[132:135], v[68:71], v[32:35], v[132:135]
    ds_read_b64_tr_b16 v[80:81], v22 offset:40960
    v_mfma_f32_16x16x32_bf16 v[148:151], v[68:71], v[36:39], v[148:151]
    ds_read_b64_tr_b16 v[82:83], v22 offset:41984
    v_mfma_f32_16x16x32_bf16 v[164:167], v[68:71], v[40:43], v[164:167]
    ds_read_b64_tr_b16 v[84:85], v23 offset:40960
    v_mfma_f32_16x16x32_bf16 v[180:183], v[68:71], v[44:47], v[180:183]
    ds_read_b64_tr_b16 v[86:87], v23 offset:41984
    v_mfma_f32_16x16x32_bf16 v[136:139], v[72:75], v[32:35], v[136:139]
    ds_read_b64_tr_b16 v[88:89], v24 offset:40960
    v_mfma_f32_16x16x32_bf16 v[152:155], v[72:75], v[36:39], v[152:155]
    ds_read_b64_tr_b16 v[90:91], v24 offset:41984
    v_mfma_f32_16x16x32_bf16 v[168:171], v[72:75], v[40:43], v[168:171]
    ds_read_b64_tr_b16 v[92:93], v25 offset:40960
    v_mfma_f32_16x16x32_bf16 v[184:187], v[72:75], v[44:47], v[184:187]
    ds_read_b64_tr_b16 v[94:95], v25 offset:41984
    v_mfma_f32_16x16x32_bf16 v[140:143], v[76:79], v[32:35], v[140:143]
    v_mfma_f32_16x16x32_bf16 v[156:159], v[76:79], v[36:39], v[156:159]
    v_mfma_f32_16x16x32_bf16 v[172:175], v[76:79], v[40:43], v[172:175]
    v_mfma_f32_16x16x32_bf16 v[188:191], v[76:79], v[44:47], v[188:191]
    v_mfma_f32_16x16x32_bf16 v[192:195], v[120:123], v[32:35], v[192:195]
    v_mfma_f32_16x16x32_bf16 v[200:203], v[32:35], v[32:35], v[200:203]
    v_mfma_f32_16x16x32_bf16 v[208:211], v[64:67], v[120:123], v[208:211]
    v_mfma_f32_16x16x32_bf16 v[196:199], v[120:123], v[36:39], v[196:199]
    v_mfma_f32_16x16x32_bf16 v[204:207], v[36:39], v[36:39], v[204:207]
    v_mfma_f32_16x16x32_bf16 v[212:215], v[68:71], v[120:123], v[212:215]
    s_waitcnt lgkmcnt(0)
    v_mfma_f32_16x16x32_bf16 v[128:131], v[80:83], v[48:51], v[128:131]
    v_mfma_f32_16x16x32_bf16 v[144:147], v[80:83], v[52:55], v[144:147]
    v_mfma_f32_16x16x32_bf16 v[160:163], v[80:83], v[56:59], v[160:163]
    v_mfma_f32_16x16x32_bf16 v[176:179], v[80:83], v[60:63], v[176:179]
    v_mfma_f32_16x16x32_bf16 v[132:135], v[84:87], v[48:51], v[132:135]
    v_mfma_f32_16x16x32_bf16 v[148:151], v[84:87], v[52:55], v[148:151]
    v_mfma_f32_16x16x32_bf16 v[164:167], v[84:87], v[56:59], v[164:167]
    v_mfma_f32_16x16x32_bf16 v[180:183], v[84:87], v[60:63], v[180:183]
    v_mfma_f32_16x16x32_bf16 v[136:139], v[88:91], v[48:51], v[136:139]
    v_mfma_f32_16x16x32_bf16 v[152:155], v[88:91], v[52:55], v[152:155]
    v_mfma_f32_16x16x32_bf16 v[168:171], v[88:91], v[56:59], v[168:171]
    v_mfma_f32_16x16x32_bf16 v[184:187], v[88:91], v[60:63], v[184:187]
    v_mfma_f32_16x16x32_bf16 v[140:143], v[92:95], v[48:51], v[140:143]
    v_mfma_f32_16x16x32_bf16 v[156:159], v[92:95], v[52:55], v[156:159]
    v_mfma_f32_16x16x32_bf16 v[172:175], v[92:95], v[56:59], v[172:175]
    v_mfma_f32_16x16x32_bf16 v[188:191], v[92:95], v[60:63], v[188:191]
    v_mfma_f32_16x16x32_bf16 v[192:195], v[120:123], v[48:51], v[192:195]
    v_mfma_f32_16x16x32_bf16 v[200:203], v[48:51], v[48:51], v[200:203]
    v_mfma_f32_16x16x32_bf16 v[208:211], v[80:83], v[120:123], v[208:211]
    v_mfma_f32_16x16x32_bf16 v[196:199], v[120:123], v[52:55], v[196:199]
    v_mfma_f32_16x16x32_bf16 v[204:207], v[52:55], v[52:55], v[204:207]
    v_mfma_f32_16x16x32_bf16 v[212:215], v[84:87], v[120:123], v[212:215]
    s_nop 7
    v_and_b32 v28, 3, v2
    v_lshrrev_b32 v29, 2, v2
    v_mov_b32 v120, v192
    v_mov_b32 v121, v200
    v_cmp_eq_u32 vcc, 1, v28
    s_nop 1
    v_cndmask_b32 v121, v121, v201, vcc
    v_cmp_eq_u32 vcc, 2, v28
    s_nop 1
    v_cndmask_b32 v121, v121, v202, vcc
    v_cmp_eq_u32 vcc, 3, v28
    s_nop 1
    v_cndmask_b32 v121, v121, v203, vcc
    v_cmp_eq_u32 vcc, v29, v3
    v_mov_b32 v52, 0
    s_nop 1
    v_cndmask_b32 v121, v52, v121, vcc
    v_mov_b32 v30, v121
    v_mov_b32 v31, v121
    s_nop 1
    v_permlane16_swap_b32 v30, v31
    s_nop 1
    v_add_f32 v121, v30, v31
    s_nop 0
    v_mov_b32 v30, v121
    v_mov_b32 v31, v121
    s_nop 1
    v_permlane32_swap_b32 v30, v31
    s_nop 1
    v_add_f32 v121, v30, v31
    v_mov_b32 v122, v196
    v_mov_b32 v123, v204
    v_cmp_eq_u32 vcc, 1, v28
    s_nop 1
    v_cndmask_b32 v123, v123, v205, vcc
    v_cmp_eq_u32 vcc, 2, v28
    s_nop 1
    v_cndmask_b32 v123, v123, v206, vcc
    v_cmp_eq_u32 vcc, 3, v28
    s_nop 1
    v_cndmask_b32 v123, v123, v207, vcc
    v_cmp_eq_u32 vcc, v29, v3
    v_mov_b32 v52, 0
    s_nop 1
    v_cndmask_b32 v123, v52, v123, vcc
    v_mov_b32 v30, v123
    v_mov_b32 v31, v123
    s_nop 1
    v_permlane16_swap_b32 v30, v31
    s_nop 1
    v_add_f32 v123, v30, v31
    s_nop 0
    v_mov_b32 v30, v123
    v_mov_b32 v31, v123
    s_nop 1
    v_permlane32_swap_b32 v30, v31
    s_nop 1
    v_add_f32 v123, v30, v31
    s_lshl_b32 s34, s31, 6
    s_lshl_b32 s35, s32, 5
    s_add_u32 s34, s34, s35
    v_add_u32 v28, s34, v2
    v_lshlrev_b32 v28, 3, v28
    v_add_u32 v28, 0x20000, v28
    v_mul_f32 v32, 0x3b000000, v120
    v_mul_f32 v30, 0x3b000000, v121
    v_fma_f32 v30, -v32, v32, v30
    v_max_f32 v30, 0, v30
    v_add_f32 v30, 0x3727c5ac, v30
    v_rsq_f32 v33, v30
    s_nop 0
    ds_write_b64 v28, v[32:33] offset:0
    v_mul_f32 v34, 0x3b000000, v122
    v_mul_f32 v30, 0x3b000000, v123
    v_fma_f32 v30, -v34, v34, v30
    v_max_f32 v30, 0, v30
    v_add_f32 v30, 0x3727c5ac, v30
    v_rsq_f32 v35, v30
    s_nop 0
    ds_write_b64 v28, v[34:35] offset:128
    s_lshl_b32 s34, s32, 8
    s_lshl_b32 s35, s31, 7
    s_add_u32 s34, s34, s35
    v_lshlrev_b32 v29, 4, v3
    v_add_u32 v29, s34, v29
    v_add_u32 v29, 0x20400, v29
    ds_write_b128 v29, v[208:211] offset:0
    ds_write_b128 v29, v[212:215] offset:64
    s_waitcnt lgkmcnt(0)
    s_barrier
    s_lshl_b32 s34, s31, 6
    v_add_u32 v28, s34, v2
    v_lshlrev_b32 v28, 3, v28
    v_add_u32 v28, 0x20000, v28
    s_lshl_b32 s35, s32, 8
    v_add_u32 v30, s35, v28
    v_subrev_u32 v31, s35, v28
    ds_read_b64 v[96:97], v30 offset:0
    ds_read_b64 v[98:99], v30 offset:128
    ds_read_b64 v[100:101], v31 offset:256
    ds_read_b64 v[102:103], v31 offset:384
    s_lshl_b32 s34, s32, 8
    v_lshlrev_b32 v28, 4, v3
    v_add_u32 v28, s34, v28
    v_add_u32 v28, 0x20400, v28
    s_lshl_b32 s35, s31, 7
    v_add_u32 v30, s35, v28
    v_subrev_u32 v31, s35, v28
    ds_read_b128 v[64:67], v30 offset:0
    ds_read_b128 v[68:71], v30 offset:64
    ds_read_b128 v[72:75], v31 offset:128
    ds_read_b128 v[76:79], v31 offset:192
    s_lshl_b32 s34, s31, 6
    s_add_u32 s34, s34, s28
    s_lshl_b32 s35, s32, 5
    s_add_u32 s38, s34, s35
    s_add_u32 s38, s38, 0
    v_add_u32 v28, s38, v2
    v_lshlrev_b32 v28, 5, v28
    v_lshl_add_u32 v104, v3, 3, v28
    s_add_u32 s38, s34, s35
    s_add_u32 s38, s38, 16
    v_add_u32 v28, s38, v2
    v_lshlrev_b32 v28, 5, v28
    v_lshl_add_u32 v105, v3, 3, v28
    s_sub_u32 s38, s34, s35
    s_add_u32 s38, s38, 32
    v_add_u32 v28, s38, v2
    v_lshlrev_b32 v28, 5, v28
    v_lshl_add_u32 v106, v3, 3, v28
    s_sub_u32 s38, s34, s35
    s_add_u32 s38, s38, 48
    v_add_u32 v28, s38, v2
    v_lshlrev_b32 v28, 5, v28
    v_lshl_add_u32 v107, v3, 3, v28
    s_waitcnt vmcnt(0) lgkmcnt(0)
    s_lshl_b32 s34, s31, 1
    s_xor_b32 s34, s34, 0
    s_lshl_b32 s34, s34, 4
    s_lshl_b32 s35, s32, 6
    s_add_u32 s34, s34, s35
    s_add_u32 s34, s34, s29
    s_lshr_b32 s35, s34, 9
    s_bfe_u32 s36, s34, 0x50004
    s_lshl_b32 s37, s35, 21
    s_lshl_b32 s36, s36, 16
    s_add_u32 s37, s37, s36
    s_cmp_eq_u32 s35, 0
    s_cselect_b32 s39, 0x3eb8aa3b, 1.0
    v_mul_f32 v32, s39, v97
    v_mul_f32 v34, s39, v99
    v_mul_f32 v36, s39, v101
    v_mul_f32 v38, s39, v103
    v_pk_fma_f32 v[128:129], v[64:65], v[96:97], v[128:129] op_sel_hi:[1,0,1] neg_lo:[0,1,0] neg_hi:[0,1,0]
    v_pk_fma_f32 v[130:131], v[66:67], v[96:97], v[130:131] op_sel_hi:[1,0,1] neg_lo:[0,1,0] neg_hi:[0,1,0]
    v_pk_fma_f32 v[144:145], v[64:65], v[98:99], v[144:145] op_sel_hi:[1,0,1] neg_lo:[0,1,0] neg_hi:[0,1,0]
    v_pk_fma_f32 v[146:147], v[66:67], v[98:99], v[146:147] op_sel_hi:[1,0,1] neg_lo:[0,1,0] neg_hi:[0,1,0]
    v_pk_fma_f32 v[160:161], v[64:65], v[100:101], v[160:161] op_sel_hi:[1,0,1] neg_lo:[0,1,0] neg_hi:[0,1,0]
    v_pk_fma_f32 v[162:163], v[66:67], v[100:101], v[162:163] op_sel_hi:[1,0,1] neg_lo:[0,1,0] neg_hi:[0,1,0]
    v_pk_fma_f32 v[176:177], v[64:65], v[102:103], v[176:177] op_sel_hi:[1,0,1] neg_lo:[0,1,0] neg_hi:[0,1,0]
    v_pk_fma_f32 v[178:179], v[66:67], v[102:103], v[178:179] op_sel_hi:[1,0,1] neg_lo:[0,1,0] neg_hi:[0,1,0]
    v_pk_mul_f32 v[128:129], v[128:129], v[32:33] op_sel_hi:[1,0]
    v_pk_mul_f32 v[130:131], v[130:131], v[32:33] op_sel_hi:[1,0]
    v_pk_mul_f32 v[144:145], v[144:145], v[34:35] op_sel_hi:[1,0]
    v_pk_mul_f32 v[146:147], v[146:147], v[34:35] op_sel_hi:[1,0]
    v_pk_mul_f32 v[160:161], v[160:161], v[36:37] op_sel_hi:[1,0]
    v_pk_mul_f32 v[162:163], v[162:163], v[36:37] op_sel_hi:[1,0]
    v_pk_mul_f32 v[176:177], v[176:177], v[38:39] op_sel_hi:[1,0]
    v_pk_mul_f32 v[178:179], v[178:179], v[38:39] op_sel_hi:[1,0]
    v_cvt_pk_bf16_f32 v52, v128, v129
    v_cvt_pk_bf16_f32 v53, v130, v131
    v_cvt_pk_bf16_f32 v54, v144, v145
    v_cvt_pk_bf16_f32 v55, v146, v147
    v_cvt_pk_bf16_f32 v56, v160, v161
    v_cvt_pk_bf16_f32 v57, v162, v163
    v_cvt_pk_bf16_f32 v58, v176, v177
    v_cvt_pk_bf16_f32 v59, v178, v179
    buffer_store_dwordx2 v[52:53], v104, s[20:23], s37 offen sc1
    buffer_store_dwordx2 v[54:55], v105, s[20:23], s37 offen sc1
    buffer_store_dwordx2 v[56:57], v106, s[20:23], s37 offen sc1
    buffer_store_dwordx2 v[58:59], v107, s[20:23], s37 offen sc1
    s_lshl_b32 s34, s31, 1
    s_xor_b32 s34, s34, 1
    s_lshl_b32 s34, s34, 4
    s_lshl_b32 s35, s32, 6
    s_add_u32 s34, s34, s35
    s_add_u32 s34, s34, s29
    s_lshr_b32 s35, s34, 9
    s_bfe_u32 s36, s34, 0x50004
    s_lshl_b32 s37, s35, 21
    s_lshl_b32 s36, s36, 16
    s_add_u32 s37, s37, s36
    s_cmp_eq_u32 s35, 0
    s_cselect_b32 s39, 0x3eb8aa3b, 1.0
    v_mul_f32 v32, s39, v97
    v_mul_f32 v34, s39, v99
    v_mul_f32 v36, s39, v101
    v_mul_f32 v38, s39, v103
    v_pk_fma_f32 v[132:133], v[68:69], v[96:97], v[132:133] op_sel_hi:[1,0,1] neg_lo:[0,1,0] neg_hi:[0,1,0]
    v_pk_fma_f32 v[134:135], v[70:71], v[96:97], v[134:135] op_sel_hi:[1,0,1] neg_lo:[0,1,0] neg_hi:[0,1,0]
    v_pk_fma_f32 v[148:149], v[68:69], v[98:99], v[148:149] op_sel_hi:[1,0,1] neg_lo:[0,1,0] neg_hi:[0,1,0]
    v_pk_fma_f32 v[150:151], v[70:71], v[98:99], v[150:151] op_sel_hi:[1,0,1] neg_lo:[0,1,0] neg_hi:[0,1,0]
    v_pk_fma_f32 v[164:165], v[68:69], v[100:101], v[164:165] op_sel_hi:[1,0,1] neg_lo:[0,1,0] neg_hi:[0,1,0]
    v_pk_fma_f32 v[166:167], v[70:71], v[100:101], v[166:167] op_sel_hi:[1,0,1] neg_lo:[0,1,0] neg_hi:[0,1,0]
    v_pk_fma_f32 v[180:181], v[68:69], v[102:103], v[180:181] op_sel_hi:[1,0,1] neg_lo:[0,1,0] neg_hi:[0,1,0]
    v_pk_fma_f32 v[182:183], v[70:71], v[102:103], v[182:183] op_sel_hi:[1,0,1] neg_lo:[0,1,0] neg_hi:[0,1,0]
    v_pk_mul_f32 v[132:133], v[132:133], v[32:33] op_sel_hi:[1,0]
    v_pk_mul_f32 v[134:135], v[134:135], v[32:33] op_sel_hi:[1,0]
    v_pk_mul_f32 v[148:149], v[148:149], v[34:35] op_sel_hi:[1,0]
    v_pk_mul_f32 v[150:151], v[150:151], v[34:35] op_sel_hi:[1,0]
    v_pk_mul_f32 v[164:165], v[164:165], v[36:37] op_sel_hi:[1,0]
    v_pk_mul_f32 v[166:167], v[166:167], v[36:37] op_sel_hi:[1,0]
    v_pk_mul_f32 v[180:181], v[180:181], v[38:39] op_sel_hi:[1,0]
    v_pk_mul_f32 v[182:183], v[182:183], v[38:39] op_sel_hi:[1,0]
    v_cvt_pk_bf16_f32 v52, v132, v133
    v_cvt_pk_bf16_f32 v53, v134, v135
    v_cvt_pk_bf16_f32 v54, v148, v149
    v_cvt_pk_bf16_f32 v55, v150, v151
    v_cvt_pk_bf16_f32 v56, v164, v165
    v_cvt_pk_bf16_f32 v57, v166, v167
    v_cvt_pk_bf16_f32 v58, v180, v181
    v_cvt_pk_bf16_f32 v59, v182, v183
    buffer_store_dwordx2 v[52:53], v104, s[20:23], s37 offen sc1
    buffer_store_dwordx2 v[54:55], v105, s[20:23], s37 offen sc1
    buffer_store_dwordx2 v[56:57], v106, s[20:23], s37 offen sc1
    buffer_store_dwordx2 v[58:59], v107, s[20:23], s37 offen sc1
    s_lshl_b32 s34, s31, 1
    s_xor_b32 s34, s34, 2
    s_lshl_b32 s34, s34, 4
    s_lshl_b32 s35, s32, 6
    s_add_u32 s34, s34, s35
    s_add_u32 s34, s34, s29
    s_lshr_b32 s35, s34, 9
    s_bfe_u32 s36, s34, 0x50004
    s_lshl_b32 s37, s35, 21
    s_lshl_b32 s36, s36, 16
    s_add_u32 s37, s37, s36
    s_cmp_eq_u32 s35, 0
    s_cselect_b32 s39, 0x3eb8aa3b, 1.0
    v_mul_f32 v32, s39, v97
    v_mul_f32 v34, s39, v99
    v_mul_f32 v36, s39, v101
    v_mul_f32 v38, s39, v103
    v_pk_fma_f32 v[136:137], v[72:73], v[96:97], v[136:137] op_sel_hi:[1,0,1] neg_lo:[0,1,0] neg_hi:[0,1,0]
    v_pk_fma_f32 v[138:139], v[74:75], v[96:97], v[138:139] op_sel_hi:[1,0,1] neg_lo:[0,1,0] neg_hi:[0,1,0]
    v_pk_fma_f32 v[152:153], v[72:73], v[98:99], v[152:153] op_sel_hi:[1,0,1] neg_lo:[0,1,0] neg_hi:[0,1,0]
    v_pk_fma_f32 v[154:155], v[74:75], v[98:99], v[154:155] op_sel_hi:[1,0,1] neg_lo:[0,1,0] neg_hi:[0,1,0]
    v_pk_fma_f32 v[168:169], v[72:73], v[100:101], v[168:169] op_sel_hi:[1,0,1] neg_lo:[0,1,0] neg_hi:[0,1,0]
    v_pk_fma_f32 v[170:171], v[74:75], v[100:101], v[170:171] op_sel_hi:[1,0,1] neg_lo:[0,1,0] neg_hi:[0,1,0]
    v_pk_fma_f32 v[184:185], v[72:73], v[102:103], v[184:185] op_sel_hi:[1,0,1] neg_lo:[0,1,0] neg_hi:[0,1,0]
    v_pk_fma_f32 v[186:187], v[74:75], v[102:103], v[186:187] op_sel_hi:[1,0,1] neg_lo:[0,1,0] neg_hi:[0,1,0]
    v_pk_mul_f32 v[136:137], v[136:137], v[32:33] op_sel_hi:[1,0]
    v_pk_mul_f32 v[138:139], v[138:139], v[32:33] op_sel_hi:[1,0]
    v_pk_mul_f32 v[152:153], v[152:153], v[34:35] op_sel_hi:[1,0]
    v_pk_mul_f32 v[154:155], v[154:155], v[34:35] op_sel_hi:[1,0]
    v_pk_mul_f32 v[168:169], v[168:169], v[36:37] op_sel_hi:[1,0]
    v_pk_mul_f32 v[170:171], v[170:171], v[36:37] op_sel_hi:[1,0]
    v_pk_mul_f32 v[184:185], v[184:185], v[38:39] op_sel_hi:[1,0]
    v_pk_mul_f32 v[186:187], v[186:187], v[38:39] op_sel_hi:[1,0]
    v_cvt_pk_bf16_f32 v52, v136, v137
    v_cvt_pk_bf16_f32 v53, v138, v139
    v_cvt_pk_bf16_f32 v54, v152, v153
    v_cvt_pk_bf16_f32 v55, v154, v155
    v_cvt_pk_bf16_f32 v56, v168, v169
    v_cvt_pk_bf16_f32 v57, v170, v171
    v_cvt_pk_bf16_f32 v58, v184, v185
    v_cvt_pk_bf16_f32 v59, v186, v187
    buffer_store_dwordx2 v[52:53], v104, s[20:23], s37 offen sc1
    buffer_store_dwordx2 v[54:55], v105, s[20:23], s37 offen sc1
    buffer_store_dwordx2 v[56:57], v106, s[20:23], s37 offen sc1
    buffer_store_dwordx2 v[58:59], v107, s[20:23], s37 offen sc1
    s_lshl_b32 s34, s31, 1
    s_xor_b32 s34, s34, 3
    s_lshl_b32 s34, s34, 4
    s_lshl_b32 s35, s32, 6
    s_add_u32 s34, s34, s35
    s_add_u32 s34, s34, s29
    s_lshr_b32 s35, s34, 9
    s_bfe_u32 s36, s34, 0x50004
    s_lshl_b32 s37, s35, 21
    s_lshl_b32 s36, s36, 16
    s_add_u32 s37, s37, s36
    s_cmp_eq_u32 s35, 0
    s_cselect_b32 s39, 0x3eb8aa3b, 1.0
    v_mul_f32 v32, s39, v97
    v_mul_f32 v34, s39, v99
    v_mul_f32 v36, s39, v101
    v_mul_f32 v38, s39, v103
    v_pk_fma_f32 v[140:141], v[76:77], v[96:97], v[140:141] op_sel_hi:[1,0,1] neg_lo:[0,1,0] neg_hi:[0,1,0]
    v_pk_fma_f32 v[142:143], v[78:79], v[96:97], v[142:143] op_sel_hi:[1,0,1] neg_lo:[0,1,0] neg_hi:[0,1,0]
    v_pk_fma_f32 v[156:157], v[76:77], v[98:99], v[156:157] op_sel_hi:[1,0,1] neg_lo:[0,1,0] neg_hi:[0,1,0]
    v_pk_fma_f32 v[158:159], v[78:79], v[98:99], v[158:159] op_sel_hi:[1,0,1] neg_lo:[0,1,0] neg_hi:[0,1,0]
    v_pk_fma_f32 v[172:173], v[76:77], v[100:101], v[172:173] op_sel_hi:[1,0,1] neg_lo:[0,1,0] neg_hi:[0,1,0]
    v_pk_fma_f32 v[174:175], v[78:79], v[100:101], v[174:175] op_sel_hi:[1,0,1] neg_lo:[0,1,0] neg_hi:[0,1,0]
    v_pk_fma_f32 v[188:189], v[76:77], v[102:103], v[188:189] op_sel_hi:[1,0,1] neg_lo:[0,1,0] neg_hi:[0,1,0]
    v_pk_fma_f32 v[190:191], v[78:79], v[102:103], v[190:191] op_sel_hi:[1,0,1] neg_lo:[0,1,0] neg_hi:[0,1,0]
    v_pk_mul_f32 v[140:141], v[140:141], v[32:33] op_sel_hi:[1,0]
    v_pk_mul_f32 v[142:143], v[142:143], v[32:33] op_sel_hi:[1,0]
    v_pk_mul_f32 v[156:157], v[156:157], v[34:35] op_sel_hi:[1,0]
    v_pk_mul_f32 v[158:159], v[158:159], v[34:35] op_sel_hi:[1,0]
    v_pk_mul_f32 v[172:173], v[172:173], v[36:37] op_sel_hi:[1,0]
    v_pk_mul_f32 v[174:175], v[174:175], v[36:37] op_sel_hi:[1,0]
    v_pk_mul_f32 v[188:189], v[188:189], v[38:39] op_sel_hi:[1,0]
    v_pk_mul_f32 v[190:191], v[190:191], v[38:39] op_sel_hi:[1,0]
    v_cvt_pk_bf16_f32 v52, v140, v141
    v_cvt_pk_bf16_f32 v53, v142, v143
    v_cvt_pk_bf16_f32 v54, v156, v157
    v_cvt_pk_bf16_f32 v55, v158, v159
    v_cvt_pk_bf16_f32 v56, v172, v173
    v_cvt_pk_bf16_f32 v57, v174, v175
    v_cvt_pk_bf16_f32 v58, v188, v189
    v_cvt_pk_bf16_f32 v59, v190, v191
    buffer_store_dwordx2 v[52:53], v104, s[20:23], s37 offen sc1
    buffer_store_dwordx2 v[54:55], v105, s[20:23], s37 offen sc1
    buffer_store_dwordx2 v[56:57], v106, s[20:23], s37 offen sc1
    buffer_store_dwordx2 v[58:59], v107, s[20:23], s37 offen sc1
L_qkv0_kernel_end:
    s_endpgm
.p2align 8
.globl attn_kernel
.type attn_kernel,@function
attn_kernel:
    s_cmp_ge_u32 s2, 256
    s_cbranch_scc1 L_attn_kernel_end
    s_load_dwordx2 s[4:5], s[0:1], 80
    s_load_dwordx2 s[44:45], s[0:1], 16
    s_load_dwordx2 s[46:47], s[0:1], 32
    s_load_dwordx2 s[48:49], s[0:1], 48
    v_and_b32 v1, 63, v0
    v_lshrrev_b32 v114, 6, v0
    s_nop 0
    v_readfirstlane_b32 s30, v114
    s_and_b32 s34, s2, 7
    s_lshr_b32 s35, s2, 3
    s_lshr_b32 s36, s35, 3
    s_lshl_b32 s34, s34, 2
    s_add_u32 s28, s34, s36
    s_and_b32 s29, s35, 7
    s_lshl_b32 s31, s28, 16
    v_lshlrev_b32 v114, 4, v1
    s_lshl_b32 s32, s30, 13
    s_waitcnt lgkmcnt(0)
    s_mov_b32 s8, s4
    s_and_b32 s9, s5, 0xffff
    s_mov_b32 s10, 0x600000
    s_mov_b32 s11, 0x20000
    s_add_u32 s12, s4, 0x600000
    s_addc_u32 s13, s5, 0
    s_and_b32 s13, s13, 0xffff
    s_mov_b32 s14, 0x200000
    s_mov_b32 s15, 0x20000
    s_add_u32 s38, s31, s32
    s_add_u32 s34, s38, 0x200000
    s_add_u32 m0, s32, 0x0
    s_nop 0
    buffer_load_dwordx4 v114, s[8:11], s34 offen lds
    s_add_u32 s34, s38, 0x200400
    s_add_u32 m0, s32, 0x400
    s_nop 0
    buffer_load_dwordx4 v114, s[8:11], s34 offen lds
    s_add_u32 s34, s38, 0x200800
    s_add_u32 m0, s32, 0x800
    s_nop 0
    buffer_load_dwordx4 v114, s[8:11], s34 offen lds
    s_add_u32 s34, s38, 0x200c00
    s_add_u32 m0, s32, 0xc00
    s_nop 0
    buffer_load_dwordx4 v114, s[8:11], s34 offen lds
    s_add_u32 s34, s38, 0x201000
    s_add_u32 m0, s32, 0x1000
    s_nop 0
    buffer_load_dwordx4 v114, s[8:11], s34 offen lds
    s_add_u32 s34, s38, 0x201400
    s_add_u32 m0, s32, 0x1400
    s_nop 0
    buffer_load_dwordx4 v114, s[8:11], s34 offen lds
    s_add_u32 s34, s38, 0x201800
    s_add_u32 m0, s32, 0x1800
    s_nop 0
    buffer_load_dwordx4 v114, s[8:11], s34 offen lds
    s_add_u32 s34, s38, 0x201c00
    s_add_u32 m0, s32, 0x1c00
    s_nop 0
    buffer_load_dwordx4 v114, s[8:11], s34 offen lds
    v_and_b32 v115, 31, v0
    v_lshlrev_b32 v115, 5, v115
    v_bfe_u32 v116, v0, 5, 1
    v_lshl_add_u32 v2, v116, 4, v115
    s_lshl_b32 s36, s29, 13
    s_lshl_b32 s37, s30, 10
    s_add_u32 s36, s36, s37
    s_add_u32 s36, s36, s31
    buffer_load_dwordx4 v[8:11], v2, s[8:11], s36 offen
    s_lshl_b32 s37, s30, 11
    s_add_u32 s38, s31, s37
    s_add_u32 s34, s38, 0x400000
    s_add_u32 m0, s37, 0x10000
    s_nop 0
    buffer_load_dwordx4 v114, s[8:11], s34 offen lds
    s_add_u32 s34, s38, 0x400400
    s_add_u32 m0, s37, 0x10400
    s_nop 0
    buffer_load_dwordx4 v114, s[8:11], s34 offen lds
    s_add_u32 s34, s38, 0x404000
    s_add_u32 m0, s37, 0x14000
    s_nop 0
    buffer_load_dwordx4 v114, s[8:11], s34 offen lds
    s_add_u32 s34, s38, 0x404400
    s_add_u32 m0, s37, 0x14400
    s_nop 0
    buffer_load_dwordx4 v114, s[8:11], s34 offen lds
    s_add_u32 s34, s38, 0x408000
    s_add_u32 m0, s37, 0x18000
    s_nop 0
    buffer_load_dwordx4 v114, s[8:11], s34 offen lds
    s_add_u32 s34, s38, 0x408400
    s_add_u32 m0, s37, 0x18400
    s_nop 0
    buffer_load_dwordx4 v114, s[8:11], s34 offen lds
    s_add_u32 s34, s38, 0x40c000
    s_add_u32 m0, s37, 0x1c000
    s_nop 0
    buffer_load_dwordx4 v114, s[8:11], s34 offen lds
    s_add_u32 s34, s38, 0x40c400
    s_add_u32 m0, s37, 0x1c400
    s_nop 0
    buffer_load_dwordx4 v114, s[8:11], s34 offen lds
    s_cmp_lt_u32 s2, 32
    s_cbranch_scc1 L_attn_kernel_pfa
    s_cmp_lt_u32 s2, 144
    s_cbranch_scc1 L_attn_kernel_pfb
    s_mov_b32 s52, s48
    s_and_b32 s53, s49, 0xffff
    s_mov_b32 s54, 0x1c0000
    s_mov_b32 s55, 0x20000
    s_sub_u32 s34, s2, 144
    s_branch L_attn_kernel_pfc
L_attn_kernel_pfa:
    s_mov_b32 s52, s44
    s_and_b32 s53, s45, 0xffff
    s_mov_b32 s54, 0x80000
    s_mov_b32 s55, 0x20000
    s_mov_b32 s34, s2
    s_branch L_attn_kernel_pfc
L_attn_kernel_pfb:
    s_mov_b32 s52, s46
    s_and_b32 s53, s47, 0xffff
    s_mov_b32 s54, 0x1c0000
    s_mov_b32 s55, 0x20000
    s_sub_u32 s34, s2, 32
L_attn_kernel_pfc:
    s_lshl_b32 s34, s34, 14
    s_add_u32 s34, s34, s37
    buffer_load_dwordx4 v[124:127], v114, s[52:55], s34 offen
    buffer_load_dwordx4 v[124:127], v114, s[52:55], s34 offen offset:1024
    v_cmp_gt_u32 vcc, 296, v0
    v_mov_b32 v116, 0x3f80
    v_mov_b32 v117, 0
    v_mov_b32 v118, 0
    v_mov_b32 v119, 0
    v_mov_b32 v120, 0
    v_mov_b32 v121, 0
    v_mov_b32 v122, 0
    v_mov_b32 v123, 0
    v_lshlrev_b32 v115, 5, v0
    v_add_u32 v115, 0x20000, v115
    s_and_saveexec_b64 s[40:41], vcc
    s_cbranch_execz L_attn_kernel_nofill
    ds_write_b128 v115, v[116:119]
    ds_write_b128 v115, v[120:123] offset:16
L_attn_kernel_nofill:
    s_mov_b64 exec, s[40:41]
    v_bfe_u32 v115, v0, 2, 2
    v_and_b32 v116, 3, v0
    v_lshlrev_b32 v115, 5, v115
    v_lshl_add_u32 v115, v116, 3, v115
    v_bfe_u32 v116, v0, 5, 1
    v_lshlrev_b32 v117, 7, v116
    v_add_u32 v118, 0x10000, v117
    v_sub_u32 v119, 0x20080, v117
    v_bfe_u32 v116, v0, 4, 1
    v_cmp_eq_u32 vcc, 1, v116
    v_mov_b32 v120, 8192
    v_mov_b32 v121, 0
    s_nop 0
    v_cndmask_b32 v118, v118, v119, vcc
    v_cndmask_b32 v4, v120, v121, vcc
    v_add_u32 v6, v118, v115
    s_mov_b32 s42, 0
    s_waitcnt vmcnt(10)
    v_lshlrev_b32 v115, 5, v1
    v_add_u32 v115, s32, v115
    ds_read_b128 v[32:35], v115 offset:0
    ds_read_b128 v[36:39], v115 offset:16
    ds_read_b128 v[40:43], v115 offset:2048
    ds_read_b128 v[44:47], v115 offset:2064
    ds_read_b128 v[48:51], v115 offset:4096
    ds_read_b128 v[52:55], v115 offset:4112
    ds_read_b128 v[56:59], v115 offset:6144
    ds_read_b128 v[60:63], v115 offset:6160
    v_mov_b32 v116, 0
    v_dot2_f32_bf16 v116, v8, v8, v116
    v_dot2_f32_bf16 v116, v9, v9, v116
    v_dot2_f32_bf16 v116, v10, v10, v116
    v_dot2_f32_bf16 v116, v11, v11, v116
    v_mov_b32 v64, 0
    v_mov_b32 v65, 0
    v_mov_b32 v66, 0
    v_mov_b32 v67, 0
    s_waitcnt lgkmcnt(0)
    v_dot2_f32_bf16 v64, v32, v32, v64
    v_dot2_f32_bf16 v65, v40, v40, v65
    v_dot2_f32_bf16 v66, v48, v48, v66
    v_dot2_f32_bf16 v67, v56, v56, v67
    v_dot2_f32_bf16 v64, v33, v33, v64
    v_dot2_f32_bf16 v65, v41, v41, v65
    v_dot2_f32_bf16 v66, v49, v49, v66
    v_dot2_f32_bf16 v67, v57, v57, v67
    v_dot2_f32_bf16 v64, v34, v34, v64
    v_dot2_f32_bf16 v65, v42, v42, v65
    v_dot2_f32_bf16 v66, v50, v50, v66
    v_dot2_f32_bf16 v67, v58, v58, v67
    v_dot2_f32_bf16 v64, v35, v35, v64
    v_dot2_f32_bf16 v65, v43, v43, v65
    v_dot2_f32_bf16 v66, v51, v51, v66
    v_dot2_f32_bf16 v67, v59, v59, v67
    v_dot2_f32_bf16 v64, v36, v36, v64
    v_dot2_f32_bf16 v65, v44, v44, v65
    v_dot2_f32_bf16 v66, v52, v52, v66
    v_dot2_f32_bf16 v67, v60, v60, v67
    v_dot2_f32_bf16 v64, v37, v37, v64
    v_dot2_f32_bf16 v65, v45, v45, v65
    v_dot2_f32_bf16 v66, v53, v53, v66
    v_dot2_f32_bf16 v67, v61, v61, v67
    v_dot2_f32_bf16 v64, v38, v38, v64
    v_dot2_f32_bf16 v65, v46, v46, v65
    v_dot2_f32_bf16 v66, v54, v54, v66
    v_dot2_f32_bf16 v67, v62, v62, v67
    v_dot2_f32_bf16 v64, v39, v39, v64
    v_dot2_f32_bf16 v65, v47, v47, v65
    v_dot2_f32_bf16 v66, v55, v55, v66
    v_dot2_f32_bf16 v67, v63, v63, v67
    s_nop 2
    v_max_f32 v64, v64, v65
    v_max_f32 v66, v66, v67
    v_max_f32 v64, v64, v66
    s_nop 0
    v_mov_b32 v65, v64
    v_mov_b32 v117, v116
    s_nop 1
    v_permlane32_swap_b32 v64, v65
    v_permlane32_swap_b32 v116, v117
    s_nop 1
    v_max_f32 v64, v64, v65
    v_add_f32 v116, v116, v117
    s_nop 0
    v_mov_b32 v65, v64
    s_nop 1
    v_permlane16_swap_b32 v64, v65
    s_nop 1
    v_max_f32 v64, v64, v65
    s_nop 1
    v_max_f32_dpp v64, v64, v64 row_ror:1 row_mask:0xf bank_mask:0xf
    s_nop 1
    v_max_f32_dpp v64, v64, v64 row_ror:2 row_mask:0xf bank_mask:0xf
    s_nop 1
    v_max_f32_dpp v64, v64, v64 row_ror:4 row_mask:0xf bank_mask:0xf
    s_nop 1
    v_max_f32_dpp v64, v64, v64 row_ror:8 row_mask:0xf bank_mask:0xf
    s_nop 1
    s_lshl_b32 s34, s30, 2
    s_add_u32 s34, s34, 0x22500
    v_mov_b32 v65, s34
    ds_write_b32 v65, v64
    s_waitcnt vmcnt(8) lgkmcnt(0)
    s_barrier
    v_mov_b32 v65, 0x22500
    ds_read_b128 v[32:35], v65
    ds_read_b128 v[36:39], v65 offset:16
    s_waitcnt lgkmcnt(0)
    v_max3_f32 v32, v32, v33, v34
    v_max3_f32 v36, v36, v37, v38
    v_max3_f32 v32, v32, v35, v39
    v_max_f32 v32, v32, v36
    v_mul_f32 v116, v116, v32
    v_sqrt_f32 v116, v116
    s_nop 0
    v_mul_f32 v112, 0xbf810000, v116
L_attn_kernel_main:
    v_mov_b32 v16, v112
    v_mov_b32 v17, v112
    v_mov_b32 v18, v112
    v_mov_b32 v19, v112
    v_mov_b32 v20, v112
    v_mov_b32 v21, v112
    v_mov_b32 v22, v112
    v_mov_b32 v23, v112
    v_mov_b32 v24, v112
    v_mov_b32 v25, v112
    v_mov_b32 v26, v112
    v_mov_b32 v27, v112
    v_mov_b32 v28, v112
    v_mov_b32 v29, v112
    v_mov_b32 v30, v112
    v_mov_b32 v31, v112
    v_mov_b32 v96, 0
    v_mov_b32 v97, 0
    v_mov_b32 v98, 0
    v_mov_b32 v99, 0
    v_mov_b32 v100, 0
    v_mov_b32 v101, 0
    v_mov_b32 v102, 0
    v_mov_b32 v103, 0
    v_mov_b32 v104, 0
    v_mov_b32 v105, 0
    v_mov_b32 v106, 0
    v_mov_b32 v107, 0
    v_mov_b32 v108, 0
    v_mov_b32 v109, 0
    v_mov_b32 v110, 0
    v_mov_b32 v111, 0
    v_mov_b32 v5, v2
    v_mov_b32 v3, v6
    ds_read_b128 v[72:75], v5
    s_waitcnt lgkmcnt(0)
    v_mfma_f32_32x32x16_bf16 v[32:47], v[72:75], v[8:11], v[16:31]
    ds_read_b128 v[76:79], v5 offset:1024
    ds_read_b64_tr_b16 v[80:81], v3 offset:0
    ds_read_b64_tr_b16 v[82:83], v3 offset:256
    ds_read_b64_tr_b16 v[84:85], v3 offset:512
    ds_read_b64_tr_b16 v[86:87], v3 offset:768
    s_mov_b32 s33, 0
    s_nop 3
L_attn_kernel_p2:
    s_cmp_lg_u32 s42, 0
    s_cbranch_scc1 L_attn_kernel_nob
    s_cmp_eq_u32 s33, 1
    s_cbranch_scc1 L_attn_kernel_w4
    s_cmp_eq_u32 s33, 3
    s_cbranch_scc1 L_attn_kernel_w2
    s_cmp_lg_u32 s33, 5
    s_cbranch_scc1 L_attn_kernel_bar
    s_waitcnt vmcnt(2)
    s_branch L_attn_kernel_bar
L_attn_kernel_w4:
    s_waitcnt vmcnt(6)
    s_branch L_attn_kernel_bar
L_attn_kernel_w2:
    s_waitcnt vmcnt(4)
L_attn_kernel_bar:
    s_barrier
L_attn_kernel_nob:
    s_waitcnt lgkmcnt(4)
    v_mfma_f32_32x32x16_bf16 v[48:63], v[76:79], v[8:11], v[16:31]
    ds_read_b128 v[72:75], v5 offset:2048
    v_exp_f32 v32, v32
    v_exp_f32 v33, v33
    v_exp_f32 v34, v34
    v_exp_f32 v35, v35
    v_cvt_pk_bf16_f32 v64, v32, v33
    v_exp_f32 v36, v36
    v_exp_f32 v37, v37
    v_cvt_pk_bf16_f32 v65, v34, v35
    v_exp_f32 v38, v38
    v_exp_f32 v39, v39
    v_cvt_pk_bf16_f32 v66, v36, v37
    ds_read_b64_tr_b16 v[88:89], v3 offset:1024
    ds_read_b64_tr_b16 v[90:91], v3 offset:1280
    v_cvt_pk_bf16_f32 v67, v38, v39
    ds_read_b64_tr_b16 v[92:93], v3 offset:1536
    ds_read_b64_tr_b16 v[94:95], v3 offset:1792
    s_waitcnt lgkmcnt(5)
    v_mfma_f32_32x32x16_bf16 v[96:111], v[80:83], v[64:67], v[96:111]
    v_exp_f32 v40, v40
    v_exp_f32 v41, v41
    v_exp_f32 v42, v42
    v_exp_f32 v43, v43
    v_cvt_pk_bf16_f32 v68, v40, v41
    v_exp_f32 v44, v44
    v_exp_f32 v45, v45
    v_cvt_pk_bf16_f32 v69, v42, v43
    v_exp_f32 v46, v46
    v_exp_f32 v47, v47
    v_cvt_pk_bf16_f32 v70, v44, v45
    v_cvt_pk_bf16_f32 v71, v46, v47
    s_nop 1
    v_mfma_f32_32x32x16_bf16 v[96:111], v[84:87], v[68:71], v[96:111]
    s_waitcnt lgkmcnt(4)
    v_mfma_f32_32x32x16_bf16 v[32:47], v[72:75], v[8:11], v[16:31]
    ds_read_b128 v[76:79], v5 offset:3072
    v_exp_f32 v48, v48
    v_exp_f32 v49, v49
    v_exp_f32 v50, v50
    v_exp_f32 v51, v51
    v_cvt_pk_bf16_f32 v64, v48, v49
    v_exp_f32 v52, v52
    v_exp_f32 v53, v53
    v_cvt_pk_bf16_f32 v65, v50, v51
    v_exp_f32 v54, v54
    v_exp_f32 v55, v55
    v_cvt_pk_bf16_f32 v66, v52, v53
    ds_read_b64_tr_b16 v[80:81], v3 offset:2048
    ds_read_b64_tr_b16 v[82:83], v3 offset:2304
    v_cvt_pk_bf16_f32 v67, v54, v55
    ds_read_b64_tr_b16 v[84:85], v3 offset:2560
    ds_read_b64_tr_b16 v[86:87], v3 offset:2816
    s_waitcnt lgkmcnt(5)
    v_mfma_f32_32x32x16_bf16 v[96:111], v[88:91], v[64:67], v[96:111]
    v_exp_f32 v56, v56
    v_exp_f32 v57, v57
    v_exp_f32 v58, v58
    v_exp_f32 v59, v59
    v_cvt_pk_bf16_f32 v68, v56, v57
    v_exp_f32 v60, v60
    v_exp_f32 v61, v61
    v_cvt_pk_bf16_f32 v69, v58, v59
    v_exp_f32 v62, v62
    v_exp_f32 v63, v63
    v_cvt_pk_bf16_f32 v70, v60, v61
    v_cvt_pk_bf16_f32 v71, v62, v63
    s_nop 1
    v_mfma_f32_32x32x16_bf16 v[96:111], v[92:95], v[68:71], v[96:111]
    s_waitcnt lgkmcnt(4)
    v_mfma_f32_32x32x16_bf16 v[48:63], v[76:79], v[8:11], v[16:31]
    ds_read_b128 v[72:75], v5 offset:4096
    v_exp_f32 v32, v32
    v_exp_f32 v33, v33
    v_exp_f32 v34, v34
    v_exp_f32 v35, v35
    v_cvt_pk_bf16_f32 v64, v32, v33
    v_exp_f32 v36, v36
    v_exp_f32 v37, v37
    v_cvt_pk_bf16_f32 v65, v34, v35
    v_exp_f32 v38, v38
    v_exp_f32 v39, v39
    v_cvt_pk_bf16_f32 v66, v36, v37
    ds_read_b64_tr_b16 v[88:89], v3 offset:3072
    ds_read_b64_tr_b16 v[90:91], v3 offset:3328
    v_cvt_pk_bf16_f32 v67, v38, v39
    ds_read_b64_tr_b16 v[92:93], v3 offset:3584
    ds_read_b64_tr_b16 v[94:95], v3 offset:3840
    s_waitcnt lgkmcnt(5)
    v_mfma_f32_32x32x16_bf16 v[96:111], v[80:83], v[64:67], v[96:111]
    v_exp_f32 v40, v40
    v_exp_f32 v41, v41
    v_exp_f32 v42, v42
    v_exp_f32 v43, v43
    v_cvt_pk_bf16_f32 v68, v40, v41
    v_exp_f32 v44, v44
    v_exp_f32 v45, v45
    v_cvt_pk_bf16_f32 v69, v42, v43
    v_exp_f32 v46, v46
    v_exp_f32 v47, v47
    v_cvt_pk_bf16_f32 v70, v44, v45
    v_cvt_pk_bf16_f32 v71, v46, v47
    s_nop 1
    v_mfma_f32_32x32x16_bf16 v[96:111], v[84:87], v[68:71], v[96:111]
    s_waitcnt lgkmcnt(4)
    v_mfma_f32_32x32x16_bf16 v[32:47], v[72:75], v[8:11], v[16:31]
    ds_read_b128 v[76:79], v5 offset:5120
    v_exp_f32 v48, v48
    v_exp_f32 v49, v49
    v_exp_f32 v50, v50
    v_exp_f32 v51, v51
    v_cvt_pk_bf16_f32 v64, v48, v49
    v_exp_f32 v52, v52
    v_exp_f32 v53, v53
    v_cvt_pk_bf16_f32 v65, v50, v51
    v_exp_f32 v54, v54
    v_exp_f32 v55, v55
    v_cvt_pk_bf16_f32 v66, v52, v53
    ds_read_b64_tr_b16 v[80:81], v3 offset:4096
    ds_read_b64_tr_b16 v[82:83], v3 offset:4352
    v_cvt_pk_bf16_f32 v67, v54, v55
    ds_read_b64_tr_b16 v[84:85], v3 offset:4608
    ds_read_b64_tr_b16 v[86:87], v3 offset:4864
    s_waitcnt lgkmcnt(5)
    v_mfma_f32_32x32x16_bf16 v[96:111], v[88:91], v[64:67], v[96:111]
    v_exp_f32 v56, v56
    v_exp_f32 v57, v57
    v_exp_f32 v58, v58
    v_exp_f32 v59, v59
    v_cvt_pk_bf16_f32 v68, v56, v57
    v_exp_f32 v60, v60
    v_exp_f32 v61, v61
    v_cvt_pk_bf16_f32 v69, v58, v59
    v_exp_f32 v62, v62
    v_exp_f32 v63, v63
    v_cvt_pk_bf16_f32 v70, v60, v61
    v_cvt_pk_bf16_f32 v71, v62, v63
    s_nop 1
    v_mfma_f32_32x32x16_bf16 v[96:111], v[92:95], v[68:71], v[96:111]
    s_waitcnt lgkmcnt(4)
    v_mfma_f32_32x32x16_bf16 v[48:63], v[76:79], v[8:11], v[16:31]
    ds_read_b128 v[72:75], v5 offset:6144
    v_exp_f32 v32, v32
    v_exp_f32 v33, v33
    v_exp_f32 v34, v34
    v_exp_f32 v35, v35
    v_cvt_pk_bf16_f32 v64, v32, v33
    v_exp_f32 v36, v36
    v_exp_f32 v37, v37
    v_cvt_pk_bf16_f32 v65, v34, v35
    v_exp_f32 v38, v38
    v_exp_f32 v39, v39
    v_cvt_pk_bf16_f32 v66, v36, v37
    ds_read_b64_tr_b16 v[88:89], v3 offset:5120
    ds_read_b64_tr_b16 v[90:91], v3 offset:5376
    v_cvt_pk_bf16_f32 v67, v38, v39
    ds_read_b64_tr_b16 v[92:93], v3 offset:5632
    ds_read_b64_tr_b16 v[94:95], v3 offset:5888
    s_waitcnt lgkmcnt(5)
    v_mfma_f32_32x32x16_bf16 v[96:111], v[80:83], v[64:67], v[96:111]
    v_exp_f32 v40, v40
    v_exp_f32 v41, v41
    v_exp_f32 v42, v42
    v_exp_f32 v43, v43
    v_cvt_pk_bf16_f32 v68, v40, v41
    v_exp_f32 v44, v44
    v_exp_f32 v45, v45
    v_cvt_pk_bf16_f32 v69, v42, v43
    v_exp_f32 v46, v46
    v_exp_f32 v47, v47
    v_cvt_pk_bf16_f32 v70, v44, v45
    v_cvt_pk_bf16_f32 v71, v46, v47
    s_nop 1
    v_mfma_f32_32x32x16_bf16 v[96:111], v[84:87], v[68:71], v[96:111]
    s_waitcnt lgkmcnt(4)
    v_mfma_f32_32x32x16_bf16 v[32:47], v[72:75], v[8:11], v[16:31]
    ds_read_b128 v[76:79], v5 offset:7168
    v_exp_f32 v48, v48
    v_exp_f32 v49, v49
    v_exp_f32 v50, v50
    v_exp_f32 v51, v51
    v_cvt_pk_bf16_f32 v64, v48, v49
    v_exp_f32 v52, v52
    v_exp_f32 v53, v53
    v_cvt_pk_bf16_f32 v65, v50, v51
    v_exp_f32 v54, v54
    v_exp_f32 v55, v55
    v_cvt_pk_bf16_f32 v66, v52, v53
    ds_read_b64_tr_b16 v[80:81], v3 offset:6144
    ds_read_b64_tr_b16 v[82:83], v3 offset:6400
    v_cvt_pk_bf16_f32 v67, v54, v55
    ds_read_b64_tr_b16 v[84:85], v3 offset:6656
    ds_read_b64_tr_b16 v[86:87], v3 offset:6912
    s_waitcnt lgkmcnt(5)
    v_mfma_f32_32x32x16_bf16 v[96:111], v[88:91], v[64:67], v[96:111]
    v_exp_f32 v56, v56
    v_exp_f32 v57, v57
    v_exp_f32 v58, v58
    v_exp_f32 v59, v59
    v_cvt_pk_bf16_f32 v68, v56, v57
    v_exp_f32 v60, v60
    v_exp_f32 v61, v61
    v_cvt_pk_bf16_f32 v69, v58, v59
    v_exp_f32 v62, v62
    v_exp_f32 v63, v63
    v_cvt_pk_bf16_f32 v70, v60, v61
    v_cvt_pk_bf16_f32 v71, v62, v63
    s_nop 1
    v_mfma_f32_32x32x16_bf16 v[96:111], v[92:95], v[68:71], v[96:111]
    s_waitcnt lgkmcnt(4)
    v_mfma_f32_32x32x16_bf16 v[48:63], v[76:79], v[8:11], v[16:31]
    ds_read_b128 v[72:75], v5 offset:8192
    v_exp_f32 v32, v32
    v_exp_f32 v33, v33
    v_exp_f32 v34, v34
    v_exp_f32 v35, v35
    v_cvt_pk_bf16_f32 v64, v32, v33
    v_exp_f32 v36, v36
    v_exp_f32 v37, v37
    v_cvt_pk_bf16_f32 v65, v34, v35
    v_exp_f32 v38, v38
    v_exp_f32 v39, v39
    v_cvt_pk_bf16_f32 v66, v36, v37
    ds_read_b64_tr_b16 v[88:89], v3 offset:7168
    ds_read_b64_tr_b16 v[90:91], v3 offset:7424
    v_cvt_pk_bf16_f32 v67, v38, v39
    ds_read_b64_tr_b16 v[92:93], v3 offset:7680
    ds_read_b64_tr_b16 v[94:95], v3 offset:7936
    s_waitcnt lgkmcnt(5)
    v_mfma_f32_32x32x16_bf16 v[96:111], v[80:83], v[64:67], v[96:111]
    v_exp_f32 v40, v40
    v_exp_f32 v41, v41
    v_exp_f32 v42, v42
    v_exp_f32 v43, v43
    v_cvt_pk_bf16_f32 v68, v40, v41
    v_exp_f32 v44, v44
    v_exp_f32 v45, v45
    v_cvt_pk_bf16_f32 v69, v42, v43
    v_exp_f32 v46, v46
    v_exp_f32 v47, v47
    v_cvt_pk_bf16_f32 v70, v44, v45
    v_cvt_pk_bf16_f32 v71, v46, v47
    s_nop 1
    v_mfma_f32_32x32x16_bf16 v[96:111], v[84:87], v[68:71], v[96:111]
    s_waitcnt lgkmcnt(4)
    v_mfma_f32_32x32x16_bf16 v[32:47], v[72:75], v[8:11], v[16:31]
    ds_read_b128 v[76:79], v5 offset:9216
    v_exp_f32 v48, v48
    v_exp_f32 v49, v49
    v_exp_f32 v50, v50
    v_exp_f32 v51, v51
    v_cvt_pk_bf16_f32 v64, v48, v49
    v_exp_f32 v52, v52
    v_exp_f32 v53, v53
    v_cvt_pk_bf16_f32 v65, v50, v51
    v_exp_f32 v54, v54
    v_exp_f32 v55, v55
    v_cvt_pk_bf16_f32 v66, v52, v53
    ds_read_b64_tr_b16 v[80:81], v3 offset:8192
    ds_read_b64_tr_b16 v[82:83], v3 offset:8448
    v_cvt_pk_bf16_f32 v67, v54, v55
    ds_read_b64_tr_b16 v[84:85], v3 offset:8704
    ds_read_b64_tr_b16 v[86:87], v3 offset:8960
    s_waitcnt lgkmcnt(5)
    v_mfma_f32_32x32x16_bf16 v[96:111], v[88:91], v[64:67], v[96:111]
    v_exp_f32 v56, v56
    v_exp_f32 v57, v57
    v_exp_f32 v58, v58
    v_exp_f32 v59, v59
    v_cvt_pk_bf16_f32 v68, v56, v57
    v_exp_f32 v60, v60
    v_exp_f32 v61, v61
    v_cvt_pk_bf16_f32 v69, v58, v59
    v_exp_f32 v62, v62
    v_exp_f32 v63, v63
    v_cvt_pk_bf16_f32 v70, v60, v61
    v_cvt_pk_bf16_f32 v71, v62, v63
    s_nop 1
    v_mfma_f32_32x32x16_bf16 v[96:111], v[92:95], v[68:71], v[96:111]
    v_add_u32 v5, 8192, v5
    v_add_u32 v3, v4, v3
    s_add_u32 s33, s33, 1
    s_cmp_lg_u32 s33, 8
    s_cbranch_scc1 L_attn_kernel_p2
    s_nop 15
    v_mov_b32 v113, v104
    v_mov_b32 v114, v104
    s_nop 1
    v_permlane32_swap_b32 v113, v114
    s_nop 1
    s_cmp_lg_u32 s42, 0
    s_cbranch_scc1 L_attn_kernel_fin
    v_mov_b32 v115, 0x1f800000
    v_cmp_nge_f32 vcc, v113, v115
    s_nop 4
    s_cbranch_vccz L_attn_kernel_fin
    s_mov_b32 s42, 16
    v_mov_b32 v48, 0xff7fffff
    v_mov_b32 v49, 0xff7fffff
    v_mov_b32 v50, 0xff7fffff
    v_mov_b32 v51, 0xff7fffff
    v_mov_b32 v52, 0xff7fffff
    v_mov_b32 v53, 0xff7fffff
    v_mov_b32 v54, 0xff7fffff
    v_mov_b32 v55, 0xff7fffff
    v_mov_b32 v56, 0xff7fffff
    v_mov_b32 v57, 0xff7fffff
    v_mov_b32 v58, 0xff7fffff
    v_mov_b32 v59, 0xff7fffff
    v_mov_b32 v60, 0xff7fffff
    v_mov_b32 v61, 0xff7fffff
    v_mov_b32 v62, 0xff7fffff
    v_mov_b32 v63, 0xff7fffff
    v_mov_b32 v112, 0xff7fffff
    v_mov_b32 v113, 0xff7fffff
    s_waitcnt lgkmcnt(0)
    v_mov_b32 v5, v2
    ds_read_b128 v[72:75], v5
    ds_read_b128 v[76:79], v5 offset:1024
    s_mov_b32 s33, 8
L_attn_kernel_p1:
    s_waitcnt lgkmcnt(1)
    v_mfma_f32_32x32x16_bf16 v[32:47], v[72:75], v[8:11], 0
    ds_read_b128 v[72:75], v5 offset:2048
    s_nop 0
    v_max3_f32 v112, v48, v49, v112
    v_max3_f32 v113, v50, v51, v113
    v_max3_f32 v112, v52, v53, v112
    v_max3_f32 v113, v54, v55, v113
    v_max3_f32 v112, v56, v57, v112
    v_max3_f32 v113, v58, v59, v113
    v_max3_f32 v112, v60, v61, v112
    v_max3_f32 v113, v62, v63, v113
    s_waitcnt lgkmcnt(1)
    v_mfma_f32_32x32x16_bf16 v[48:63], v[76:79], v[8:11], 0
    ds_read_b128 v[76:79], v5 offset:3072
    s_nop 0
    v_max3_f32 v112, v32, v33, v112
    v_max3_f32 v113, v34, v35, v113
    v_max3_f32 v112, v36, v37, v112
    v_max3_f32 v113, v38, v39, v113
    v_max3_f32 v112, v40, v41, v112
    v_max3_f32 v113, v42, v43, v113
    v_max3_f32 v112, v44, v45, v112
    v_max3_f32 v113, v46, v47, v113
    s_waitcnt lgkmcnt(1)
    v_mfma_f32_32x32x16_bf16 v[32:47], v[72:75], v[8:11], 0
    ds_read_b128 v[72:75], v5 offset:4096
    s_nop 0
    v_max3_f32 v112, v48, v49, v112
    v_max3_f32 v113, v50, v51, v113
    v_max3_f32 v112, v52, v53, v112
    v_max3_f32 v113, v54, v55, v113
    v_max3_f32 v112, v56, v57, v112
    v_max3_f32 v113, v58, v59, v113
    v_max3_f32 v112, v60, v61, v112
    v_max3_f32 v113, v62, v63, v113
    s_waitcnt lgkmcnt(1)
    v_mfma_f32_32x32x16_bf16 v[48:63], v[76:79], v[8:11], 0
    ds_read_b128 v[76:79], v5 offset:5120
    s_nop 0
    v_max3_f32 v112, v32, v33, v112
    v_max3_f32 v113, v34, v35, v113
    v_max3_f32 v112, v36, v37, v112
    v_max3_f32 v113, v38, v39, v113
    v_max3_f32 v112, v40, v41, v112
    v_max3_f32 v113, v42, v43, v113
    v_max3_f32 v112, v44, v45, v112
    v_max3_f32 v113, v46, v47, v113
    s_waitcnt lgkmcnt(1)
    v_mfma_f32_32x32x16_bf16 v[32:47], v[72:75], v[8:11], 0
    ds_read_b128 v[72:75], v5 offset:6144
    s_nop 0
    v_max3_f32 v112, v48, v49, v112
    v_max3_f32 v113, v50, v51, v113
    v_max3_f32 v112, v52, v53, v112
    v_max3_f32 v113, v54, v55, v113
    v_max3_f32 v112, v56, v57, v112
    v_max3_f32 v113, v58, v59, v113
    v_max3_f32 v112, v60, v61, v112
    v_max3_f32 v113, v62, v63, v113
    s_waitcnt lgkmcnt(1)
    v_mfma_f32_32x32x16_bf16 v[48:63], v[76:79], v[8:11], 0
    ds_read_b128 v[76:79], v5 offset:7168
    s_nop 0
    v_max3_f32 v112, v32, v33, v112
    v_max3_f32 v113, v34, v35, v113
    v_max3_f32 v112, v36, v37, v112
    v_max3_f32 v113, v38, v39, v113
    v_max3_f32 v112, v40, v41, v112
    v_max3_f32 v113, v42, v43, v113
    v_max3_f32 v112, v44, v45, v112
    v_max3_f32 v113, v46, v47, v113
    s_waitcnt lgkmcnt(1)
    v_mfma_f32_32x32x16_bf16 v[32:47], v[72:75], v[8:11], 0
    ds_read_b128 v[72:75], v5 offset:8192
    s_nop 0
    v_max3_f32 v112, v48, v49, v112
    v_max3_f32 v113, v50, v51, v113
    v_max3_f32 v112, v52, v53, v112
    v_max3_f32 v113, v54, v55, v113
    v_max3_f32 v112, v56, v57, v112
    v_max3_f32 v113, v58, v59, v113
    v_max3_f32 v112, v60, v61, v112
    v_max3_f32 v113, v62, v63, v113
    s_waitcnt lgkmcnt(1)
    v_mfma_f32_32x32x16_bf16 v[48:63], v[76:79], v[8:11], 0
    ds_read_b128 v[76:79], v5 offset:9216
    s_nop 0
    v_max3_f32 v112, v32, v33, v112
    v_max3_f32 v113, v34, v35, v113
    v_max3_f32 v112, v36, v37, v112
    v_max3_f32 v113, v38, v39, v113
    v_max3_f32 v112, v40, v41, v112
    v_max3_f32 v113, v42, v43, v113
    v_max3_f32 v112, v44, v45, v112
    v_max3_f32 v113, v46, v47, v113
    v_add_u32 v5, 8192, v5
    s_sub_u32 s33, s33, 1
    s_cmp_lg_u32 s33, 0
    s_cbranch_scc1 L_attn_kernel_p1
    s_nop 11
    v_max3_f32 v112, v48, v49, v112
    v_max3_f32 v113, v50, v51, v113
    v_max3_f32 v112, v52, v53, v112
    v_max3_f32 v113, v54, v55, v113
    v_max3_f32 v112, v56, v57, v112
    v_max3_f32 v113, v58, v59, v113
    v_max3_f32 v112, v60, v61, v112
    v_max3_f32 v113, v62, v63, v113
    v_max_f32 v112, v112, v113
    s_nop 0
    v_mov_b32 v113, v112
    s_nop 1
    v_permlane32_swap_b32 v112, v113
    s_nop 1
    v_max_f32 v112, v112, v113
    v_sub_f32 v112, 0, v112
    s_waitcnt lgkmcnt(0)
    s_branch L_attn_kernel_main
L_attn_kernel_fin:
    v_rcp_f32 v113, v113
    s_nop 0
    v_mul_f32 v96, v96, v113
    v_mul_f32 v97, v97, v113
    v_mul_f32 v98, v98, v113
    v_mul_f32 v99, v99, v113
    v_mul_f32 v100, v100, v113
    v_mul_f32 v101, v101, v113
    v_mul_f32 v102, v102, v113
    v_mul_f32 v103, v103, v113
    v_cvt_pk_bf16_f32 v116, v96, v97
    v_cvt_pk_bf16_f32 v117, v98, v99
    v_cvt_pk_bf16_f32 v118, v100, v101
    v_cvt_pk_bf16_f32 v119, v102, v103
    v_and_b32 v114, 31, v0
    v_lshlrev_b32 v114, 10, v114
    v_bfe_u32 v115, v0, 5, 1
    v_lshl_add_u32 v114, v115, 3, v114
    s_lshl_b32 s36, s29, 18
    s_lshl_b32 s37, s30, 15
    s_add_u32 s36, s36, s37
    s_lshl_b32 s37, s28, 5
    s_add_u32 s36, s36, s37
    buffer_store_dwordx2 v[116:117], v114, s[12:15], s36 offen
    buffer_store_dwordx2 v[118:119], v114, s[12:15], s36 offen offset:16
L_attn_kernel_end:
    s_endpgm
.p2align 8
.globl wo0_kernel
.type wo0_kernel,@function
wo0_kernel:
    s_cmp_ge_u32 s2, 256
    s_cbranch_scc1 L_wo0_kernel_end
    s_load_dwordx2 s[6:7], s[0:1], 16
    s_load_dwordx2 s[8:9], s[0:1], 80
    s_load_dwordx2 s[4:5], s[0:1], 0
    v_and_b32 v1, 63, v0
    v_and_b32 v2, 15, v0
    v_bfe_u32 v3, v0, 4, 2
    v_lshrrev_b32 v28, 6, v0
    s_nop 0
    v_readfirstlane_b32 s30, v28
    s_and_b32 s34, s2, 7
    s_lshr_b32 s35, s2, 3
    s_lshr_b32 s55, s30, 2
    s_and_b32 s30, s30, 3
    s_lshr_b32 s36, s35, 3
    s_lshl_b32 s34, s34, 2
    s_add_u32 s34, s34, s36
    s_and_b32 s35, s35, 7
    s_lshl_b32 s28, s34, 6
    s_lshl_b32 s29, s35, 6
    s_lshr_b32 s31, s30, 1
    s_and_b32 s32, s30, 1
    s_waitcnt lgkmcnt(0)
    s_add_u32 s12, s8, 0x600000
    s_addc_u32 s13, s9, 0
    s_and_b32 s13, s13, 0xffff
    s_mov_b32 s14, 0x200000
    s_mov_b32 s15, 0x20000
    s_mov_b32 s16, s6
    s_and_b32 s17, s7, 0xffff
    s_mov_b32 s18, 0x80000
    s_mov_b32 s19, 0x20000
    s_add_u32 s20, s8, 0x800000
    s_addc_u32 s21, s9, 0
    s_and_b32 s21, s21, 0xffff
    s_mov_b32 s22, 0x200000
    s_mov_b32 s23, 0x20000
    s_mov_b32 s24, s4
    s_and_b32 s25, s5, 0xffff
    s_mov_b32 s26, 0x200000
    s_mov_b32 s27, 0x20000
    v_xor_b32 v29, v2, v3
    v_mul_u32_u24 v28, 0x400, v3
    v_xor_b32 v30, 0, v29
    v_lshl_add_u32 v4, v30, 4, v28
    v_xor_b32 v30, 4, v29
    v_lshl_add_u32 v5, v30, 4, v28
    v_xor_b32 v30, 8, v29
    v_lshl_add_u32 v6, v30, 4, v28
    v_xor_b32 v30, 12, v29
    v_lshl_add_u32 v7, v30, 4, v28
    v_lshrrev_b32 v28, 3, v1
    v_bfe_u32 v29, v1, 4, 1
    v_bfe_u32 v30, v1, 1, 2
    v_xor_b32 v30, v30, v29
    v_and_b32 v31, 1, v1
    v_lshl_add_u32 v31, v30, 1, v31
    v_mul_u32_u24 v28, 0x400, v28
    v_lshl_add_u32 v8, v31, 4, v28
    v_xor_b32 v31, 4, v31
    v_lshl_add_u32 v9, v31, 4, v28
    s_mul_i32 s33, s30, 16
    s_add_u32 s34, s28, s33
    s_mul_i32 s50, s34, 1024
    s_mul_i32 s51, s33, 256
    s_mul_i32 s33, s30, 32
    s_mul_i32 s52, s33, 1024
    s_lshl_b32 s34, s29, 1
    s_add_u32 s52, s52, s34
    s_mul_i32 s53, s33, 128
    s_add_u32 s53, s53, 16384
    s_cmp_eq_u32 s55, 0
    s_cbranch_scc1 L_wo0_kernel_comp
    s_setprio 3
    s_add_u32 s34, s50, 0x0
    s_add_u32 m0, s51, 0x0
    s_nop 0
    buffer_load_dwordx4 v4, s[12:15], s34 offen lds
    s_add_u32 s34, s50, 0x1000
    s_add_u32 m0, s51, 0x400
    s_nop 0
    buffer_load_dwordx4 v5, s[12:15], s34 offen lds
    s_add_u32 s34, s50, 0x2000
    s_add_u32 m0, s51, 0x800
    s_nop 0
    buffer_load_dwordx4 v6, s[12:15], s34 offen lds
    s_add_u32 s34, s50, 0x3000
    s_add_u32 m0, s51, 0xc00
    s_nop 0
    buffer_load_dwordx4 v7, s[12:15], s34 offen lds
    s_add_u32 s34, s52, 0x0
    s_add_u32 m0, s53, 0x0
    s_nop 0
    buffer_load_dwordx4 v8, s[16:19], s34 offen lds
    s_add_u32 s34, s52, 0x2000
    s_add_u32 m0, s53, 0x400
    s_nop 0
    buffer_load_dwordx4 v9, s[16:19], s34 offen lds
    s_add_u32 s34, s52, 0x4000
    s_add_u32 m0, s53, 0x800
    s_nop 0
    buffer_load_dwordx4 v8, s[16:19], s34 offen lds
    s_add_u32 s34, s52, 0x6000
    s_add_u32 m0, s53, 0xc00
    s_nop 0
    buffer_load_dwordx4 v9, s[16:19], s34 offen lds
    s_add_u32 s34, s50, 0x100
    s_add_u32 m0, s51, 0x8000
    s_nop 0
    buffer_load_dwordx4 v4, s[12:15], s34 offen lds
    s_add_u32 s34, s50, 0x1100
    s_add_u32 m0, s51, 0x8400
    s_nop 0
    buffer_load_dwordx4 v5, s[12:15], s34 offen lds
    s_add_u32 s34, s50, 0x2100
    s_add_u32 m0, s51, 0x8800
    s_nop 0
    buffer_load_dwordx4 v6, s[12:15], s34 offen lds
    s_add_u32 s34, s50, 0x3100
    s_add_u32 m0, s51, 0x8c00
    s_nop 0
    buffer_load_dwordx4 v7, s[12:15], s34 offen lds
    s_add_u32 s34, s52, 0x20000
    s_add_u32 m0, s53, 0x8000
    s_nop 0
    buffer_load_dwordx4 v8, s[16:19], s34 offen lds
    s_add_u32 s34, s52, 0x22000
    s_add_u32 m0, s53, 0x8400
    s_nop 0
    buffer_load_dwordx4 v9, s[16:19], s34 offen lds
    s_add_u32 s34, s52, 0x24000
    s_add_u32 m0, s53, 0x8800
    s_nop 0
    buffer_load_dwordx4 v8, s[16:19], s34 offen lds
    s_add_u32 s34, s52, 0x26000
    s_add_u32 m0, s53, 0x8c00
    s_nop 0
    buffer_load_dwordx4 v9, s[16:19], s34 offen lds
    s_waitcnt vmcnt(8)
    s_barrier
    s_add_u32 s34, s50, 0x200
    s_add_u32 m0, s51, 0x10000
    s_nop 0
    buffer_load_dwordx4 v4, s[12:15], s34 offen lds
    s_add_u32 s34, s50, 0x1200
    s_add_u32 m0, s51, 0x10400
    s_nop 0
    buffer_load_dwordx4 v5, s[12:15], s34 offen lds
    s_add_u32 s34, s50, 0x2200
    s_add_u32 m0, s51, 0x10800
    s_nop 0
    buffer_load_dwordx4 v6, s[12:15], s34 offen lds
    s_add_u32 s34, s50, 0x3200
    s_add_u32 m0, s51, 0x10c00
    s_nop 0
    buffer_load_dwordx4 v7, s[12:15], s34 offen lds
    s_add_u32 s34, s52, 0x40000
    s_add_u32 m0, s53, 0x10000
    s_nop 0
    buffer_load_dwordx4 v8, s[16:19], s34 offen lds
    s_add_u32 s34, s52, 0x42000
    s_add_u32 m0, s53, 0x10400
    s_nop 0
    buffer_load_dwordx4 v9, s[16:19], s34 offen lds
    s_add_u32 s34, s52, 0x44000
    s_add_u32 m0, s53, 0x10800
    s_nop 0
    buffer_load_dwordx4 v8, s[16:19], s34 offen lds
    s_add_u32 s34, s52, 0x46000
    s_add_u32 m0, s53, 0x10c00
    s_nop 0
    buffer_load_dwordx4 v9, s[16:19], s34 offen lds
    s_add_u32 s34, s50, 0x300
    s_add_u32 m0, s51, 0x18000
    s_nop 0
    buffer_load_dwordx4 v4, s[12:15], s34 offen lds
    s_add_u32 s34, s50, 0x1300
    s_add_u32 m0, s51, 0x18400
    s_nop 0
    buffer_load_dwordx4 v5, s[12:15], s34 offen lds
    s_add_u32 s34, s50, 0x2300
    s_add_u32 m0, s51, 0x18800
    s_nop 0
    buffer_load_dwordx4 v6, s[12:15], s34 offen lds
    s_add_u32 s34, s50, 0x3300
    s_add_u32 m0, s51, 0x18c00
    s_nop 0
    buffer_load_dwordx4 v7, s[12:15], s34 offen lds
    s_add_u32 s34, s52, 0x60000
    s_add_u32 m0, s53, 0x18000
    s_nop 0
    buffer_load_dwordx4 v8, s[16:19], s34 offen lds
    s_add_u32 s34, s52, 0x62000
    s_add_u32 m0, s53, 0x18400
    s_nop 0
    buffer_load_dwordx4 v9, s[16:19], s34 offen lds
    s_add_u32 s34, s52, 0x64000
    s_add_u32 m0, s53, 0x18800
    s_nop 0
    buffer_load_dwordx4 v8, s[16:19], s34 offen lds
    s_add_u32 s34, s52, 0x66000
    s_add_u32 m0, s53, 0x18c00
    s_nop 0
    buffer_load_dwordx4 v9, s[16:19], s34 offen lds
    s_waitcnt vmcnt(16)
    s_barrier
    s_waitcnt vmcnt(8)
    s_barrier
    s_waitcnt vmcnt(0)
    s_barrier
    s_endpgm
L_wo0_kernel_comp:
    s_lshl_b32 s34, s31, 5
    s_add_u32 s34, s34, s28
    v_add_u32 v12, s34, v2
    v_lshlrev_b32 v12, 10, v12
    v_lshl_add_u32 v12, v3, 3, v12
    s_lshl_b32 s54, s29, 1
    s_lshl_b32 s34, s32, 6
    s_add_u32 s54, s54, s34
    v_add_u32 v13, 0x4000, v12
    buffer_load_dwordx2 v[96:97], v12, s[24:27], s54 offen offset:0
    buffer_load_dwordx2 v[98:99], v12, s[24:27], s54 offen offset:32
    buffer_load_dwordx2 v[100:101], v13, s[24:27], s54 offen offset:0
    buffer_load_dwordx2 v[102:103], v13, s[24:27], s54 offen offset:32
    s_mul_i32 s34, s31, 32
    v_add_u32 v28, s34, v2
    v_lshlrev_b32 v28, 8, v28
    v_xor_b32 v29, v2, v3
    v_xor_b32 v30, 0, v29
    v_lshl_add_u32 v30, v30, 4, v28
    v_mov_b32 v14, v30
    v_xor_b32 v30, 4, v29
    v_lshl_add_u32 v30, v30, 4, v28
    v_mov_b32 v15, v30
    v_xor_b32 v30, 8, v29
    v_lshl_add_u32 v30, v30, 4, v28
    v_mov_b32 v16, v30
    v_xor_b32 v30, 12, v29
    v_lshl_add_u32 v30, v30, 4, v28
    v_mov_b32 v17, v30
    v_bfe_u32 v28, v0, 2, 2
    v_lshl_add_u32 v29, v3, 3, v28
    v_lshlrev_b32 v29, 7, v29
    v_and_b32 v30, 3, v0
    v_lshl_add_u32 v29, v30, 3, v29
    v_add_u32 v29, 16384, v29
    v_and_b32 v30, 1, v3
    v_lshrrev_b32 v28, 1, v28
    v_lshl_add_u32 v28, v30, 1, v28
    s_mul_i32 s34, s32, 2
    s_add_u32 s34, s34, 0
    v_xor_b32 v30, s34, v28
    v_lshl_add_u32 v22, v30, 5, v29
    s_mul_i32 s34, s32, 2
    s_add_u32 s34, s34, 1
    v_xor_b32 v30, s34, v28
    v_lshl_add_u32 v23, v30, 5, v29
    s_barrier
    ds_read_b128 v[32:35], v14 offset:0
    ds_read_b128 v[36:39], v14 offset:4096
    ds_read_b64_tr_b16 v[64:65], v22 offset:0
    ds_read_b64_tr_b16 v[66:67], v22 offset:512
    ds_read_b64_tr_b16 v[68:69], v23 offset:0
    ds_read_b64_tr_b16 v[70:71], v23 offset:512
    s_waitcnt lgkmcnt(0)
    v_mfma_f32_16x16x32_bf16 v[128:131], v[64:67], v[32:35], 0
    ds_read_b128 v[48:51], v15 offset:0
    ds_read_b128 v[52:55], v15 offset:4096
    v_mfma_f32_16x16x32_bf16 v[136:139], v[64:67], v[36:39], 0
    ds_read_b64_tr_b16 v[80:81], v22 offset:4096
    ds_read_b64_tr_b16 v[82:83], v22 offset:4608
    v_mfma_f32_16x16x32_bf16 v[132:135], v[68:71], v[32:35], 0
    ds_read_b64_tr_b16 v[84:85], v23 offset:4096
    ds_read_b64_tr_b16 v[86:87], v23 offset:4608
    v_mfma_f32_16x16x32_bf16 v[140:143], v[68:71], v[36:39], 0
    s_waitcnt lgkmcnt(0)
    v_mfma_f32_16x16x32_bf16 v[128:131], v[80:83], v[48:51], v[128:131]
    ds_read_b128 v[32:35], v16 offset:0
    ds_read_b128 v[36:39], v16 offset:4096
    v_mfma_f32_16x16x32_bf16 v[136:139], v[80:83], v[52:55], v[136:139]
    ds_read_b64_tr_b16 v[64:65], v22 offset:8192
    ds_read_b64_tr_b16 v[66:67], v22 offset:8704
    v_mfma_f32_16x16x32_bf16 v[132:135], v[84:87], v[48:51], v[132:135]
    ds_read_b64_tr_b16 v[68:69], v23 offset:8192
    ds_read_b64_tr_b16 v[70:71], v23 offset:8704
    v_mfma_f32_16x16x32_bf16 v[140:143], v[84:87], v[52:55], v[140:143]
    s_waitcnt lgkmcnt(0)
    v_mfma_f32_16x16x32_bf16 v[128:131], v[64:67], v[32:35], v[128:131]
    ds_read_b128 v[48:51], v17 offset:0
    ds_read_b128 v[52:55], v17 offset:4096
    v_mfma_f32_16x16x32_bf16 v[136:139], v[64:67], v[36:39], v[136:139]
    ds_read_b64_tr_b16 v[80:81], v22 offset:12288
    ds_read_b64_tr_b16 v[82:83], v22 offset:12800
    v_mfma_f32_16x16x32_bf16 v[132:135], v[68:71], v[32:35], v[132:135]
    ds_read_b64_tr_b16 v[84:85], v23 offset:12288
    ds_read_b64_tr_b16 v[86:87], v23 offset:12800
    v_mfma_f32_16x16x32_bf16 v[140:143], v[68:71], v[36:39], v[140:143]
    s_waitcnt lgkmcnt(0)
    s_barrier
    v_mfma_f32_16x16x32_bf16 v[128:131], v[80:83], v[48:51], v[128:131]
    ds_read_b128 v[32:35], v14 offset:32768
    ds_read_b128 v[36:39], v14 offset:36864
    v_mfma_f32_16x16x32_bf16 v[136:139], v[80:83], v[52:55], v[136:139]
    ds_read_b64_tr_b16 v[64:65], v22 offset:32768
    ds_read_b64_tr_b16 v[66:67], v22 offset:33280
    v_mfma_f32_16x16x32_bf16 v[132:135], v[84:87], v[48:51], v[132:135]
    ds_read_b64_tr_b16 v[68:69], v23 offset:32768
    ds_read_b64_tr_b16 v[70:71], v23 offset:33280
    v_mfma_f32_16x16x32_bf16 v[140:143], v[84:87], v[52:55], v[140:143]
    s_waitcnt lgkmcnt(0)
    v_mfma_f32_16x16x32_bf16 v[128:131], v[64:67], v[32:35], v[128:131]
    ds_read_b128 v[48:51], v15 offset:32768
    ds_read_b128 v[52:55], v15 offset:36864
    v_mfma_f32_16x16x32_bf16 v[136:139], v[64:67], v[36:39], v[136:139]
    ds_read_b64_tr_b16 v[80:81], v22 offset:36864
    ds_read_b64_tr_b16 v[82:83], v22 offset:37376
    v_mfma_f32_16x16x32_bf16 v[132:135], v[68:71], v[32:35], v[132:135]
    ds_read_b64_tr_b16 v[84:85], v23 offset:36864
    ds_read_b64_tr_b16 v[86:87], v23 offset:37376
    v_mfma_f32_16x16x32_bf16 v[140:143], v[68:71], v[36:39], v[140:143]
    s_waitcnt lgkmcnt(0)
    v_mfma_f32_16x16x32_bf16 v[128:131], v[80:83], v[48:51], v[128:131]
    ds_read_b128 v[32:35], v16 offset:32768
    ds_read_b128 v[36:39], v16 offset:36864
    v_mfma_f32_16x16x32_bf16 v[136:139], v[80:83], v[52:55], v[136:139]
    ds_read_b64_tr_b16 v[64:65], v22 offset:40960
    ds_read_b64_tr_b16 v[66:67], v22 offset:41472
    v_mfma_f32_16x16x32_bf16 v[132:135], v[84:87], v[48:51], v[132:135]
    ds_read_b64_tr_b16 v[68:69], v23 offset:40960
    ds_read_b64_tr_b16 v[70:71], v23 offset:41472
    v_mfma_f32_16x16x32_bf16 v[140:143], v[84:87], v[52:55], v[140:143]
    s_waitcnt lgkmcnt(0)
    v_mfma_f32_16x16x32_bf16 v[128:131], v[64:67], v[32:35], v[128:131]
    ds_read_b128 v[48:51], v17 offset:32768
    ds_read_b128 v[52:55], v17 offset:36864
    v_mfma_f32_16x16x32_bf16 v[136:139], v[64:67], v[36:39], v[136:139]
    ds_read_b64_tr_b16 v[80:81], v22 offset:45056
    ds_read_b64_tr_b16 v[82:83], v22 offset:45568
    v_mfma_f32_16x16x32_bf16 v[132:135], v[68:71], v[32:35], v[132:135]
    ds_read_b64_tr_b16 v[84:85], v23 offset:45056
    ds_read_b64_tr_b16 v[86:87], v23 offset:45568
    v_mfma_f32_16x16x32_bf16 v[140:143], v[68:71], v[36:39], v[140:143]
    s_waitcnt lgkmcnt(0)
    s_barrier
    v_mfma_f32_16x16x32_bf16 v[128:131], v[80:83], v[48:51], v[128:131]
    v_add_u32 v14, 0x10000, v14
    v_add_u32 v15, 0x10000, v15
    v_add_u32 v16, 0x10000, v16
    v_add_u32 v17, 0x10000, v17
    v_mfma_f32_16x16x32_bf16 v[136:139], v[80:83], v[52:55], v[136:139]
    v_add_u32 v22, 0x10000, v22
    v_add_u32 v23, 0x10000, v23
    ds_read_b128 v[32:35], v14 offset:0
    ds_read_b128 v[36:39], v14 offset:4096
    v_mfma_f32_16x16x32_bf16 v[132:135], v[84:87], v[48:51], v[132:135]
    ds_read_b64_tr_b16 v[64:65], v22 offset:0
    ds_read_b64_tr_b16 v[66:67], v22 offset:512
    ds_read_b64_tr_b16 v[68:69], v23 offset:0
    ds_read_b64_tr_b16 v[70:71], v23 offset:512
    v_mfma_f32_16x16x32_bf16 v[140:143], v[84:87], v[52:55], v[140:143]
    s_waitcnt lgkmcnt(0)
    v_mfma_f32_16x16x32_bf16 v[128:131], v[64:67], v[32:35], v[128:131]
    ds_read_b128 v[48:51], v15 offset:0
    ds_read_b128 v[52:55], v15 offset:4096
    v_mfma_f32_16x16x32_bf16 v[136:139], v[64:67], v[36:39], v[136:139]
    ds_read_b64_tr_b16 v[80:81], v22 offset:4096
    ds_read_b64_tr_b16 v[82:83], v22 offset:4608
    v_mfma_f32_16x16x32_bf16 v[132:135], v[68:71], v[32:35], v[132:135]
    ds_read_b64_tr_b16 v[84:85], v23 offset:4096
    ds_read_b64_tr_b16 v[86:87], v23 offset:4608
    v_mfma_f32_16x16x32_bf16 v[140:143], v[68:71], v[36:39], v[140:143]
    s_waitcnt lgkmcnt(0)
    v_mfma_f32_16x16x32_bf16 v[128:131], v[80:83], v[48:51], v[128:131]
    ds_read_b128 v[32:35], v16 offset:0
    ds_read_b128 v[36:39], v16 offset:4096
    v_mfma_f32_16x16x32_bf16 v[136:139], v[80:83], v[52:55], v[136:139]
    ds_read_b64_tr_b16 v[64:65], v22 offset:8192
    ds_read_b64_tr_b16 v[66:67], v22 offset:8704
    v_mfma_f32_16x16x32_bf16 v[132:135], v[84:87], v[48:51], v[132:135]
    ds_read_b64_tr_b16 v[68:69], v23 offset:8192
    ds_read_b64_tr_b16 v[70:71], v23 offset:8704
    v_mfma_f32_16x16x32_bf16 v[140:143], v[84:87], v[52:55], v[140:143]
    s_waitcnt lgkmcnt(0)
    v_mfma_f32_16x16x32_bf16 v[128:131], v[64:67], v[32:35], v[128:131]
    ds_read_b128 v[48:51], v17 offset:0
    ds_read_b128 v[52:55], v17 offset:4096
    v_mfma_f32_16x16x32_bf16 v[136:139], v[64:67], v[36:39], v[136:139]
    ds_read_b64_tr_b16 v[80:81], v22 offset:12288
    ds_read_b64_tr_b16 v[82:83], v22 offset:12800
    v_mfma_f32_16x16x32_bf16 v[132:135], v[68:71], v[32:35], v[132:135]
    ds_read_b64_tr_b16 v[84:85], v23 offset:12288
    ds_read_b64_tr_b16 v[86:87], v23 offset:12800
    v_mfma_f32_16x16x32_bf16 v[140:143], v[68:71], v[36:39], v[140:143]
    s_waitcnt lgkmcnt(0)
    s_barrier
    v_mfma_f32_16x16x32_bf16 v[128:131], v[80:83], v[48:51], v[128:131]
    ds_read_b128 v[32:35], v14 offset:32768
    ds_read_b128 v[36:39], v14 offset:36864
    v_mfma_f32_16x16x32_bf16 v[136:139], v[80:83], v[52:55], v[136:139]
    ds_read_b64_tr_b16 v[64:65], v22 offset:32768
    ds_read_b64_tr_b16 v[66:67], v22 offset:33280
    v_mfma_f32_16x16x32_bf16 v[132:135], v[84:87], v[48:51], v[132:135]
    ds_read_b64_tr_b16 v[68:69], v23 offset:32768
    ds_read_b64_tr_b16 v[70:71], v23 offset:33280
    v_mfma_f32_16x16x32_bf16 v[140:143], v[84:87], v[52:55], v[140:143]
    s_waitcnt lgkmcnt(0)
    v_mfma_f32_16x16x32_bf16 v[128:131], v[64:67], v[32:35], v[128:131]
    ds_read_b128 v[48:51], v15 offset:32768
    ds_read_b128 v[52:55], v15 offset:36864
    v_mfma_f32_16x16x32_bf16 v[136:139], v[64:67], v[36:39], v[136:139]
    ds_read_b64_tr_b16 v[80:81], v22 offset:36864
    ds_read_b64_tr_b16 v[82:83], v22 offset:37376
    v_mfma_f32_16x16x32_bf16 v[132:135], v[68:71], v[32:35], v[132:135]
    ds_read_b64_tr_b16 v[84:85], v23 offset:36864
    ds_read_b64_tr_b16 v[86:87], v23 offset:37376
    v_mfma_f32_16x16x32_bf16 v[140:143], v[68:71], v[36:39], v[140:143]
    s_waitcnt lgkmcnt(0)
    v_mfma_f32_16x16x32_bf16 v[128:131], v[80:83], v[48:51], v[128:131]
    ds_read_b128 v[32:35], v16 offset:32768
    ds_read_b128 v[36:39], v16 offset:36864
    v_mfma_f32_16x16x32_bf16 v[136:139], v[80:83], v[52:55], v[136:139]
    ds_read_b64_tr_b16 v[64:65], v22 offset:40960
    ds_read_b64_tr_b16 v[66:67], v22 offset:41472
    v_mfma_f32_16x16x32_bf16 v[132:135], v[84:87], v[48:51], v[132:135]
    ds_read_b64_tr_b16 v[68:69], v23 offset:40960
    ds_read_b64_tr_b16 v[70:71], v23 offset:41472
    v_mfma_f32_16x16x32_bf16 v[140:143], v[84:87], v[52:55], v[140:143]
    s_waitcnt lgkmcnt(0)
    v_mfma_f32_16x16x32_bf16 v[128:131], v[64:67], v[32:35], v[128:131]
    ds_read_b128 v[48:51], v17 offset:32768
    ds_read_b128 v[52:55], v17 offset:36864
    v_mfma_f32_16x16x32_bf16 v[136:139], v[64:67], v[36:39], v[136:139]
    ds_read_b64_tr_b16 v[80:81], v22 offset:45056
    ds_read_b64_tr_b16 v[82:83], v22 offset:45568
    v_mfma_f32_16x16x32_bf16 v[132:135], v[68:71], v[32:35], v[132:135]
    ds_read_b64_tr_b16 v[84:85], v23 offset:45056
    ds_read_b64_tr_b16 v[86:87], v23 offset:45568
    v_mfma_f32_16x16x32_bf16 v[140:143], v[68:71], v[36:39], v[140:143]
    s_waitcnt lgkmcnt(0)
    v_mfma_f32_16x16x32_bf16 v[128:131], v[80:83], v[48:51], v[128:131]
    v_mfma_f32_16x16x32_bf16 v[136:139], v[80:83], v[52:55], v[136:139]
    v_mfma_f32_16x16x32_bf16 v[132:135], v[84:87], v[48:51], v[132:135]
    v_mfma_f32_16x16x32_bf16 v[140:143], v[84:87], v[52:55], v[140:143]
    s_nop 7
    s_waitcnt vmcnt(0)
    v_lshlrev_b32 v32, 16, v96
    v_and_b32 v33, 0xffff0000, v96
    v_lshlrev_b32 v34, 16, v97
    v_and_b32 v35, 0xffff0000, v97
    v_add_f32 v40, v128, v32
    v_add_f32 v41, v129, v33
    v_add_f32 v42, v130, v34
    v_add_f32 v43, v131, v35
    v_cvt_pk_bf16_f32 v48, v40, v41
    v_cvt_pk_bf16_f32 v49, v42, v43
    buffer_store_dwordx2 v[48:49], v12, s[20:23], s54 offen offset:0
    v_lshlrev_b32 v32, 16, v98
    v_and_b32 v33, 0xffff0000, v98
    v_lshlrev_b32 v34, 16, v99
    v_and_b32 v35, 0xffff0000, v99
    v_add_f32 v40, v132, v32
    v_add_f32 v41, v133, v33
    v_add_f32 v42, v134, v34
    v_add_f32 v43, v135, v35
    v_cvt_pk_bf16_f32 v50, v40, v41
    v_cvt_pk_bf16_f32 v51, v42, v43
    buffer_store_dwordx2 v[50:51], v12, s[20:23], s54 offen offset:32
    v_lshlrev_b32 v32, 16, v100
    v_and_b32 v33, 0xffff0000, v100
    v_lshlrev_b32 v34, 16, v101
    v_and_b32 v35, 0xffff0000, v101
    v_add_f32 v40, v136, v32
    v_add_f32 v41, v137, v33
    v_add_f32 v42, v138, v34
    v_add_f32 v43, v139, v35
    v_cvt_pk_bf16_f32 v52, v40, v41
    v_cvt_pk_bf16_f32 v53, v42, v43
    buffer_store_dwordx2 v[52:53], v13, s[20:23], s54 offen offset:0
    v_lshlrev_b32 v32, 16, v102
    v_and_b32 v33, 0xffff0000, v102
    v_lshlrev_b32 v34, 16, v103
    v_and_b32 v35, 0xffff0000, v103
    v_add_f32 v40, v140, v32
    v_add_f32 v41, v141, v33
    v_add_f32 v42, v142, v34
    v_add_f32 v43, v143, v35
    v_cvt_pk_bf16_f32 v54, v40, v41
    v_cvt_pk_bf16_f32 v55, v42, v43
    buffer_store_dwordx2 v[54:55], v13, s[20:23], s54 offen offset:32
L_wo0_kernel_end:
    s_endpgm
.p2align 8
.globl ffn1_kernel
.type ffn1_kernel,@function
ffn1_kernel:
    s_cmp_ge_u32 s2, 224
    s_cbranch_scc1 L_ffn1_kernel_end
    s_load_dwordx2 s[6:7], s[0:1], 32
    s_load_dwordx2 s[8:9], s[0:1], 80
    s_load_dwordx2 s[10:11], s[0:1], 40
    v_and_b32 v1, 63, v0
    v_and_b32 v2, 15, v0
    v_bfe_u32 v3, v0, 4, 2
    v_lshrrev_b32 v28, 6, v0
    s_nop 0
    v_readfirstlane_b32 s30, v28
    s_and_b32 s34, s2, 7
    s_lshr_b32 s35, s2, 3
    s_lshr_b32 s55, s30, 2
    s_and_b32 s30, s30, 3
    s_mul_i32 s36, s35, 37
    s_lshr_b32 s36, s36, 8
    s_mul_i32 s37, s36, 7
    s_sub_u32 s37, s35, s37
    s_lshr_b32 s38, s34, 1
    s_lshl_b32 s38, s38, 2
    s_add_u32 s38, s38, s36
    s_and_b32 s39, s34, 1
    s_mul_i32 s39, s39, 7
    s_add_u32 s39, s39, s37
    s_lshl_b32 s28, s38, 7
    s_lshl_b32 s29, s39, 7
    s_lshr_b32 s31, s30, 1
    s_and_b32 s32, s30, 1
    s_waitcnt lgkmcnt(0)
    s_add_u32 s12, s8, 0x800000
    s_addc_u32 s13, s9, 0
    s_and_b32 s13, s13, 0xffff
    s_mov_b32 s14, 0x200000
    s_mov_b32 s15, 0x20000
    s_mov_b32 s16, s6
    s_and_b32 s17, s7, 0xffff
    s_mov_b32 s18, 0x1c0000
    s_mov_b32 s19, 0x20000
    s_add_u32 s20, s8, 0xa00000
    s_addc_u32 s21, s9, 0
    s_and_b32 s21, s21, 0xffff
    s_mov_b32 s22, 0x700000
    s_mov_b32 s23, 0x20000
    s_mov_b32 s44, s10
    s_and_b32 s45, s11, 0xffff
    s_mov_b32 s46, 0xe00
    s_mov_b32 s47, 0x20000
    v_lshrrev_b32 v28, 3, v1
    v_and_b32 v29, 7, v1
    v_lshrrev_b32 v30, 1, v28
    v_xor_b32 v29, v29, v30
    v_mul_u32_u24 v28, 0x400, v28
    v_lshl_add_u32 v4, v29, 4, v28
    v_xor_b32 v29, 4, v29
    v_lshl_add_u32 v5, v29, 4, v28
    v_lshrrev_b32 v29, 1, v2
    v_xor_b32 v29, v29, v3
    v_and_b32 v30, 1, v2
    v_lshl_add_u32 v29, v29, 1, v30
    v_mul_u32_u24 v28, 0xe00, v3
    v_lshl_add_u32 v8, v29, 4, v28
    v_xor_b32 v29, 8, v29
    v_lshl_add_u32 v9, v29, 4, v28
    s_mul_i32 s33, s30, 32
    s_add_u32 s34, s28, s33
    s_mul_i32 s50, s34, 1024
    s_mul_i32 s51, s33, 128
    s_mul_i32 s33, s30, 16
    s_mul_i32 s52, s33, 3584
    s_lshl_b32 s34, s29, 1
    s_add_u32 s52, s52, s34
    s_mul_i32 s53, s33, 256
    s_add_u32 s53, s53, 16384
    s_cmp_eq_u32 s55, 0
    s_cbranch_scc1 L_ffn1_kernel_comp
    s_setprio 3
    s_add_u32 s34, s50, 0x0
    s_add_u32 m0, s51, 0x0
    s_nop 0
    buffer_load_dwordx4 v4, s[12:15], s34 offen lds
    s_add_u32 s34, s50, 0x2000
    s_add_u32 m0, s51, 0x400
    s_nop 0
    buffer_load_dwordx4 v5, s[12:15], s34 offen lds
    s_add_u32 s34, s50, 0x4000
    s_add_u32 m0, s51, 0x800
    s_nop 0
    buffer_load_dwordx4 v4, s[12:15], s34 offen lds
    s_add_u32 s34, s50, 0x6000
    s_add_u32 m0, s51, 0xc00
    s_nop 0
    buffer_load_dwordx4 v5, s[12:15], s34 offen lds
    s_add_u32 s34, s52, 0x0
    s_add_u32 m0, s53, 0x0
    s_nop 0
    buffer_load_dwordx4 v8, s[16:19], s34 offen lds
    s_add_u32 s34, s52, 0x3800
    s_add_u32 m0, s53, 0x400
    s_nop 0
    buffer_load_dwordx4 v8, s[16:19], s34 offen lds
    s_add_u32 s34, s52, 0x7000
    s_add_u32 m0, s53, 0x800
    s_nop 0
    buffer_load_dwordx4 v9, s[16:19], s34 offen lds
    s_add_u32 s34, s52, 0xa800
    s_add_u32 m0, s53, 0xc00
    s_nop 0
    buffer_load_dwordx4 v9, s[16:19], s34 offen lds
    s_add_u32 s34, s50, 0x80
    s_add_u32 m0, s51, 0x8000
    s_nop 0
    buffer_load_dwordx4 v4, s[12:15], s34 offen lds
    s_add_u32 s34, s50, 0x2080
    s_add_u32 m0, s51, 0x8400
    s_nop 0
    buffer_load_dwordx4 v5, s[12:15], s34 offen lds
    s_add_u32 s34, s50, 0x4080
    s_add_u32 m0, s51, 0x8800
    s_nop 0
    buffer_load_dwordx4 v4, s[12:15], s34 offen lds
    s_add_u32 s34, s50, 0x6080
    s_add_u32 m0, s51, 0x8c00
    s_nop 0
    buffer_load_dwordx4 v5, s[12:15], s34 offen lds
    s_add_u32 s34, s52, 0x38000
    s_add_u32 m0, s53, 0x8000
    s_nop 0
    buffer_load_dwordx4 v8, s[16:19], s34 offen lds
    s_add_u32 s34, s52, 0x3b800
    s_add_u32 m0, s53, 0x8400
    s_nop 0
    buffer_load_dwordx4 v8, s[16:19], s34 offen lds
    s_add_u32 s34, s52, 0x3f000
    s_add_u32 m0, s53, 0x8800
    s_nop 0
    buffer_load_dwordx4 v9, s[16:19], s34 offen lds
    s_add_u32 s34, s52, 0x42800
    s_add_u32 m0, s53, 0x8c00
    s_nop 0
    buffer_load_dwordx4 v9, s[16:19], s34 offen lds
    s_waitcnt vmcnt(8)
    s_barrier
    s_add_u32 s34, s50, 0x100
    s_add_u32 m0, s51, 0x10000
    s_nop 0
    buffer_load_dwordx4 v4, s[12:15], s34 offen lds
    s_add_u32 s34, s50, 0x2100
    s_add_u32 m0, s51, 0x10400
    s_nop 0
    buffer_load_dwordx4 v5, s[12:15], s34 offen lds
    s_add_u32 s34, s50, 0x4100
    s_add_u32 m0, s51, 0x10800
    s_nop 0
    buffer_load_dwordx4 v4, s[12:15], s34 offen lds
    s_add_u32 s34, s50, 0x6100
    s_add_u32 m0, s51, 0x10c00
    s_nop 0
    buffer_load_dwordx4 v5, s[12:15], s34 offen lds
    s_add_u32 s34, s52, 0x70000
    s_add_u32 m0, s53, 0x10000
    s_nop 0
    buffer_load_dwordx4 v8, s[16:19], s34 offen lds
    s_add_u32 s34, s52, 0x73800
    s_add_u32 m0, s53, 0x10400
    s_nop 0
    buffer_load_dwordx4 v8, s[16:19], s34 offen lds
    s_add_u32 s34, s52, 0x77000
    s_add_u32 m0, s53, 0x10800
    s_nop 0
    buffer_load_dwordx4 v9, s[16:19], s34 offen lds
    s_add_u32 s34, s52, 0x7a800
    s_add_u32 m0, s53, 0x10c00
    s_nop 0
    buffer_load_dwordx4 v9, s[16:19], s34 offen lds
    s_add_u32 s34, s50, 0x180
    s_add_u32 m0, s51, 0x18000
    s_nop 0
    buffer_load_dwordx4 v4, s[12:15], s34 offen lds
    s_add_u32 s34, s50, 0x2180
    s_add_u32 m0, s51, 0x18400
    s_nop 0
    buffer_load_dwordx4 v5, s[12:15], s34 offen lds
    s_add_u32 s34, s50, 0x4180
    s_add_u32 m0, s51, 0x18800
    s_nop 0
    buffer_load_dwordx4 v4, s[12:15], s34 offen lds
    s_add_u32 s34, s50, 0x6180
    s_add_u32 m0, s51, 0x18c00
    s_nop 0
    buffer_load_dwordx4 v5, s[12:15], s34 offen lds
    s_add_u32 s34, s52, 0xa8000
    s_add_u32 m0, s53, 0x18000
    s_nop 0
    buffer_load_dwordx4 v8, s[16:19], s34 offen lds
    s_add_u32 s34, s52, 0xab800
    s_add_u32 m0, s53, 0x18400
    s_nop 0
    buffer_load_dwordx4 v8, s[16:19], s34 offen lds
    s_add_u32 s34, s52, 0xaf000
    s_add_u32 m0, s53, 0x18800
    s_nop 0
    buffer_load_dwordx4 v9, s[16:19], s34 offen lds
    s_add_u32 s34, s52, 0xb2800
    s_add_u32 m0, s53, 0x18c00
    s_nop 0
    buffer_load_dwordx4 v9, s[16:19], s34 offen lds
    s_waitcnt vmcnt(16)
    s_barrier
    s_add_u32 s34, s50, 0x200
    s_add_u32 m0, s51, 0x0
    s_nop 0
    buffer_load_dwordx4 v4, s[12:15], s34 offen lds
    s_add_u32 s34, s50, 0x2200
    s_add_u32 m0, s51, 0x400
    s_nop 0
    buffer_load_dwordx4 v5, s[12:15], s34 offen lds
    s_add_u32 s34, s50, 0x4200
    s_add_u32 m0, s51, 0x800
    s_nop 0
    buffer_load_dwordx4 v4, s[12:15], s34 offen lds
    s_add_u32 s34, s50, 0x6200
    s_add_u32 m0, s51, 0xc00
    s_nop 0
    buffer_load_dwordx4 v5, s[12:15], s34 offen lds
    s_add_u32 s34, s52, 0xe0000
    s_add_u32 m0, s53, 0x0
    s_nop 0
    buffer_load_dwordx4 v8, s[16:19], s34 offen lds
    s_add_u32 s34, s52, 0xe3800
    s_add_u32 m0, s53, 0x400
    s_nop 0
    buffer_load_dwordx4 v8, s[16:19], s34 offen lds
    s_add_u32 s34, s52, 0xe7000
    s_add_u32 m0, s53, 0x800
    s_nop 0
    buffer_load_dwordx4 v9, s[16:19], s34 offen lds
    s_add_u32 s34, s52, 0xea800
    s_add_u32 m0, s53, 0xc00
    s_nop 0
    buffer_load_dwordx4 v9, s[16:19], s34 offen lds
    s_waitcnt vmcnt(16)
    s_barrier
    s_add_u32 s34, s50, 0x280
    s_add_u32 m0, s51, 0x8000
    s_nop 0
    buffer_load_dwordx4 v4, s[12:15], s34 offen lds
    s_add_u32 s34, s50, 0x2280
    s_add_u32 m0, s51, 0x8400
    s_nop 0
    buffer_load_dwordx4 v5, s[12:15], s34 offen lds
    s_add_u32 s34, s50, 0x4280
    s_add_u32 m0, s51, 0x8800
    s_nop 0
    buffer_load_dwordx4 v4, s[12:15], s34 offen lds
    s_add_u32 s34, s50, 0x6280
    s_add_u32 m0, s51, 0x8c00
    s_nop 0
    buffer_load_dwordx4 v5, s[12:15], s34 offen lds
    s_add_u32 s34, s52, 0x118000
    s_add_u32 m0, s53, 0x8000
    s_nop 0
    buffer_load_dwordx4 v8, s[16:19], s34 offen lds
    s_add_u32 s34, s52, 0x11b800
    s_add_u32 m0, s53, 0x8400
    s_nop 0
    buffer_load_dwordx4 v8, s[16:19], s34 offen lds
    s_add_u32 s34, s52, 0x11f000
    s_add_u32 m0, s53, 0x8800
    s_nop 0
    buffer_load_dwordx4 v9, s[16:19], s34 offen lds
    s_add_u32 s34, s52, 0x122800
    s_add_u32 m0, s53, 0x8c00
    s_nop 0
    buffer_load_dwordx4 v9, s[16:19], s34 offen lds
    s_waitcnt vmcnt(16)
    s_barrier
    s_add_u32 s34, s50, 0x300
    s_add_u32 m0, s51, 0x10000
    s_nop 0
    buffer_load_dwordx4 v4, s[12:15], s34 offen lds
    s_add_u32 s34, s50, 0x2300
    s_add_u32 m0, s51, 0x10400
    s_nop 0
    buffer_load_dwordx4 v5, s[12:15], s34 offen lds
    s_add_u32 s34, s50, 0x4300
    s_add_u32 m0, s51, 0x10800
    s_nop 0
    buffer_load_dwordx4 v4, s[12:15], s34 offen lds
    s_add_u32 s34, s50, 0x6300
    s_add_u32 m0, s51, 0x10c00
    s_nop 0
    buffer_load_dwordx4 v5, s[12:15], s34 offen lds
    s_add_u32 s34, s52, 0x150000
    s_add_u32 m0, s53, 0x10000
    s_nop 0
    buffer_load_dwordx4 v8, s[16:19], s34 offen lds
    s_add_u32 s34, s52, 0x153800
    s_add_u32 m0, s53, 0x10400
    s_nop 0
    buffer_load_dwordx4 v8, s[16:19], s34 offen lds
    s_add_u32 s34, s52, 0x157000
    s_add_u32 m0, s53, 0x10800
    s_nop 0
    buffer_load_dwordx4 v9, s[16:19], s34 offen lds
    s_add_u32 s34, s52, 0x15a800
    s_add_u32 m0, s53, 0x10c00
    s_nop 0
    buffer_load_dwordx4 v9, s[16:19], s34 offen lds
    s_waitcnt vmcnt(16)
    s_barrier
    s_add_u32 s34, s50, 0x380
    s_add_u32 m0, s51, 0x18000
    s_nop 0
    buffer_load_dwordx4 v4, s[12:15], s34 offen lds
    s_add_u32 s34, s50, 0x2380
    s_add_u32 m0, s51, 0x18400
    s_nop 0
    buffer_load_dwordx4 v5, s[12:15], s34 offen lds
    s_add_u32 s34, s50, 0x4380
    s_add_u32 m0, s51, 0x18800
    s_nop 0
    buffer_load_dwordx4 v4, s[12:15], s34 offen lds
    s_add_u32 s34, s50, 0x6380
    s_add_u32 m0, s51, 0x18c00
    s_nop 0
    buffer_load_dwordx4 v5, s[12:15], s34 offen lds
    s_add_u32 s34, s52, 0x188000
    s_add_u32 m0, s53, 0x18000
    s_nop 0
    buffer_load_dwordx4 v8, s[16:19], s34 offen lds
    s_add_u32 s34, s52, 0x18b800
    s_add_u32 m0, s53, 0x18400
    s_nop 0
    buffer_load_dwordx4 v8, s[16:19], s34 offen lds
    s_add_u32 s34, s52, 0x18f000
    s_add_u32 m0, s53, 0x18800
    s_nop 0
    buffer_load_dwordx4 v9, s[16:19], s34 offen lds
    s_add_u32 s34, s52, 0x192800
    s_add_u32 m0, s53, 0x18c00
    s_nop 0
    buffer_load_dwordx4 v9, s[16:19], s34 offen lds
    s_waitcnt vmcnt(16)
    s_barrier
    s_waitcnt vmcnt(8)
    s_barrier
    s_waitcnt vmcnt(0)
    s_barrier
    s_endpgm
L_ffn1_kernel_comp:
    v_lshlrev_b32 v28, 3, v3
    s_lshl_b32 s34, s29, 1
    s_lshl_b32 s35, s32, 7
    s_add_u32 s34, s34, s35
    s_lshl_b32 s35, s31, 6
    s_add_u32 s36, s34, s35
    s_sub_u32 s37, s34, s35
    buffer_load_dwordx2 v[112:113], v28, s[44:47], s36 offen offset:0
    buffer_load_dwordx2 v[114:115], v28, s[44:47], s36 offen offset:32
    buffer_load_dwordx2 v[116:117], v28, s[44:47], s37 offen offset:64
    buffer_load_dwordx2 v[118:119], v28, s[44:47], s37 offen offset:96
    s_mul_i32 s34, s31, 64
    v_add_u32 v28, s34, v2
    v_lshlrev_b32 v28, 7, v28
    v_lshrrev_b32 v29, 1, v2
    v_xor_b32 v29, v29, v3
    s_lshl_b32 s35, s32, 12
    v_xor_b32 v30, 0, v29
    v_lshl_add_u32 v30, v30, 4, v28
    v_add_u32 v14, s35, v30
    v_subrev_u32 v15, s35, v30
    v_xor_b32 v30, 4, v29
    v_lshl_add_u32 v30, v30, 4, v28
    v_add_u32 v16, s35, v30
    v_subrev_u32 v17, s35, v30
    v_bfe_u32 v28, v0, 2, 2
    v_lshl_add_u32 v29, v3, 3, v28
    v_lshlrev_b32 v29, 8, v29
    v_and_b32 v30, 3, v0
    v_lshl_add_u32 v29, v30, 3, v29
    v_add_u32 v29, 16384, v29
    v_and_b32 v30, 1, v3
    v_lshl_add_u32 v28, v30, 2, v28
    s_mul_i32 s34, s32, 4
    s_lshl_b32 s35, s31, 1
    s_xor_b32 s35, s35, 0
    s_add_u32 s34, s34, s35
    v_xor_b32 v30, s34, v28
    v_lshl_add_u32 v22, v30, 5, v29
    s_mul_i32 s34, s32, 4
    s_lshl_b32 s35, s31, 1
    s_xor_b32 s35, s35, 1
    s_add_u32 s34, s34, s35
    v_xor_b32 v30, s34, v28
    v_lshl_add_u32 v23, v30, 5, v29
    s_mul_i32 s34, s32, 4
    s_lshl_b32 s35, s31, 1
    s_xor_b32 s35, s35, 2
    s_add_u32 s34, s34, s35
    v_xor_b32 v30, s34, v28
    v_lshl_add_u32 v24, v30, 5, v29
    s_mul_i32 s34, s32, 4
    s_lshl_b32 s35, s31, 1
    s_xor_b32 s35, s35, 3
    s_add_u32 s34, s34, s35
    v_xor_b32 v30, s34, v28
    v_lshl_add_u32 v25, v30, 5, v29
    v_mov_b32 v120, 0x3f803f80
    v_mov_b32 v121, 0x3f803f80
    v_mov_b32 v122, 0x3f803f80
    v_mov_b32 v123, 0x3f803f80
    s_barrier
    ds_read_b128 v[32:35], v14 offset:0
    ds_read_b128 v[36:39], v14 offset:2048
    ds_read_b128 v[40:43], v15 offset:4096
    ds_read_b128 v[44:47], v15 offset:6144
    ds_read_b64_tr_b16 v[64:65], v22 offset:0
    ds_read_b64_tr_b16 v[66:67], v22 offset:1024
    ds_read_b64_tr_b16 v[68:69], v23 offset:0
    ds_read_b64_tr_b16 v[70:71], v23 offset:1024
    ds_read_b64_tr_b16 v[72:73], v24 offset:0
    ds_read_b64_tr_b16 v[74:75], v24 offset:1024
    ds_read_b64_tr_b16 v[76:77], v25 offset:0
    ds_read_b64_tr_b16 v[78:79], v25 offset:1024
    s_waitcnt lgkmcnt(0)
    v_mfma_f32_16x16x32_bf16 v[128:131], v[64:67], v[32:35], 0
    ds_read_b128 v[48:51], v16 offset:0
    v_mfma_f32_16x16x32_bf16 v[144:147], v[64:67], v[36:39], 0
    ds_read_b128 v[52:55], v16 offset:2048
    v_mfma_f32_16x16x32_bf16 v[160:163], v[64:67], v[40:43], 0
    ds_read_b128 v[56:59], v17 offset:4096
    v_mfma_f32_16x16x32_bf16 v[176:179], v[64:67], v[44:47], 0
    ds_read_b128 v[60:63], v17 offset:6144
    v_mfma_f32_16x16x32_bf16 v[132:135], v[68:71], v[32:35], 0
    ds_read_b64_tr_b16 v[80:81], v22 offset:8192
    v_mfma_f32_16x16x32_bf16 v[148:151], v[68:71], v[36:39], 0
    ds_read_b64_tr_b16 v[82:83], v22 offset:9216
    v_mfma_f32_16x16x32_bf16 v[164:167], v[68:71], v[40:43], 0
    ds_read_b64_tr_b16 v[84:85], v23 offset:8192
    v_mfma_f32_16x16x32_bf16 v[180:183], v[68:71], v[44:47], 0
    ds_read_b64_tr_b16 v[86:87], v23 offset:9216
    v_mfma_f32_16x16x32_bf16 v[136:139], v[72:75], v[32:35], 0
    ds_read_b64_tr_b16 v[88:89], v24 offset:8192
    v_mfma_f32_16x16x32_bf16 v[152:155], v[72:75], v[36:39], 0
    ds_read_b64_tr_b16 v[90:91], v24 offset:9216
    v_mfma_f32_16x16x32_bf16 v[168:171], v[72:75], v[40:43], 0
    ds_read_b64_tr_b16 v[92:93], v25 offset:8192
    v_mfma_f32_16x16x32_bf16 v[184:187], v[72:75], v[44:47], 0
    ds_read_b64_tr_b16 v[94:95], v25 offset:9216
    v_mfma_f32_16x16x32_bf16 v[140:143], v[76:79], v[32:35], 0
    v_mfma_f32_16x16x32_bf16 v[156:159], v[76:79], v[36:39], 0
    v_mfma_f32_16x16x32_bf16 v[172:175], v[76:79], v[40:43], 0
    v_mfma_f32_16x16x32_bf16 v[188:191], v[76:79], v[44:47], 0
    v_mfma_f32_16x16x32_bf16 v[192:195], v[120:123], v[32:35], 0
    v_mfma_f32_16x16x32_bf16 v[200:203], v[32:35], v[32:35], 0
    v_mfma_f32_16x16x32_bf16 v[208:211], v[64:67], v[120:123], 0
    v_mfma_f32_16x16x32_bf16 v[196:199], v[120:123], v[36:39], 0
    v_mfma_f32_16x16x32_bf16 v[204:207], v[36:39], v[36:39], 0
    v_mfma_f32_16x16x32_bf16 v[212:215], v[68:71], v[120:123], 0
    s_waitcnt lgkmcnt(0)
    s_barrier
    v_mfma_f32_16x16x32_bf16 v[128:131], v[80:83], v[48:51], v[128:131]
    ds_read_b128 v[32:35], v14 offset:32768
    v_mfma_f32_16x16x32_bf16 v[144:147], v[80:83], v[52:55], v[144:147]
    ds_read_b128 v[36:39], v14 offset:34816
    v_mfma_f32_16x16x32_bf16 v[160:163], v[80:83], v[56:59], v[160:163]
    ds_read_b128 v[40:43], v15 offset:36864
    v_mfma_f32_16x16x32_bf16 v[176:179], v[80:83], v[60:63], v[176:179]
    ds_read_b128 v[44:47], v15 offset:38912
    v_mfma_f32_16x16x32_bf16 v[132:135], v[84:87], v[48:51], v[132:135]
    ds_read_b64_tr_b16 v[64:65], v22 offset:32768
    v_mfma_f32_16x16x32_bf16 v[148:151], v[84:87], v[52:55], v[148:151]
    ds_read_b64_tr_b16 v[66:67], v22 offset:33792
    v_mfma_f32_16x16x32_bf16 v[164:167], v[84:87], v[56:59], v[164:167]
    ds_read_b64_tr_b16 v[68:69], v23 offset:32768
    v_mfma_f32_16x16x32_bf16 v[180:183], v[84:87], v[60:63], v[180:183]
    ds_read_b64_tr_b16 v[70:71], v23 offset:33792
    v_mfma_f32_16x16x32_bf16 v[136:139], v[88:91], v[48:51], v[136:139]
    ds_read_b64_tr_b16 v[72:73], v24 offset:32768
    v_mfma_f32_16x16x32_bf16 v[152:155], v[88:91], v[52:55], v[152:155]
    ds_read_b64_tr_b16 v[74:75], v24 offset:33792
    v_mfma_f32_16x16x32_bf16 v[168:171], v[88:91], v[56:59], v[168:171]
    ds_read_b64_tr_b16 v[76:77], v25 offset:32768
    v_mfma_f32_16x16x32_bf16 v[184:187], v[88:91], v[60:63], v[184:187]
    ds_read_b64_tr_b16 v[78:79], v25 offset:33792
    v_mfma_f32_16x16x32_bf16 v[140:143], v[92:95], v[48:51], v[140:143]
    v_mfma_f32_16x16x32_bf16 v[156:159], v[92:95], v[52:55], v[156:159]
    v_mfma_f32_16x16x32_bf16 v[172:175], v[92:95], v[56:59], v[172:175]
    v_mfma_f32_16x16x32_bf16 v[188:191], v[92:95], v[60:63], v[188:191]
    v_mfma_f32_16x16x32_bf16 v[192:195], v[120:123], v[48:51], v[192:195]
    v_mfma_f32_16x16x32_bf16 v[200:203], v[48:51], v[48:51], v[200:203]
    v_mfma_f32_16x16x32_bf16 v[208:211], v[80:83], v[120:123], v[208:211]
    v_mfma_f32_16x16x32_bf16 v[196:199], v[120:123], v[52:55], v[196:199]
    v_mfma_f32_16x16x32_bf16 v[204:207], v[52:55], v[52:55], v[204:207]
    v_mfma_f32_16x16x32_bf16 v[212:215], v[84:87], v[120:123], v[212:215]
    s_waitcnt lgkmcnt(0)
    v_mfma_f32_16x16x32_bf16 v[128:131], v[64:67], v[32:35], v[128:131]
    ds_read_b128 v[48:51], v16 offset:32768
    v_mfma_f32_16x16x32_bf16 v[144:147], v[64:67], v[36:39], v[144:147]
    ds_read_b128 v[52:55], v16 offset:34816
    v_mfma_f32_16x16x32_bf16 v[160:163], v[64:67], v[40:43], v[160:163]
    ds_read_b128 v[56:59], v17 offset:36864
    v_mfma_f32_16x16x32_bf16 v[176:179], v[64:67], v[44:47], v[176:179]
    ds_read_b128 v[60:63], v17 offset:38912
    v_mfma_f32_16x16x32_bf16 v[132:135], v[68:71], v[32:35], v[132:135]
    ds_read_b64_tr_b16 v[80:81], v22 offset:40960
    v_mfma_f32_16x16x32_bf16 v[148:151], v[68:71], v[36:39], v[148:151]
    ds_read_b64_tr_b16 v[82:83], v22 offset:41984
    v_mfma_f32_16x16x32_bf16 v[164:167], v[68:71], v[40:43], v[164:167]
    ds_read_b64_tr_b16 v[84:85], v23 offset:40960
    v_mfma_f32_16x16x32_bf16 v[180:183], v[68:71], v[44:47], v[180:183]
    ds_read_b64_tr_b16 v[86:87], v23 offset:41984
    v_mfma_f32_16x16x32_bf16 v[136:139], v[72:75], v[32:35], v[136:139]
    ds_read_b64_tr_b16 v[88:89], v24 offset:40960
    v_mfma_f32_16x16x32_bf16 v[152:155], v[72:75], v[36:39], v[152:155]
    ds_read_b64_tr_b16 v[90:91], v24 offset:41984
    v_mfma_f32_16x16x32_bf16 v[168:171], v[72:75], v[40:43], v[168:171]
    ds_read_b64_tr_b16 v[92:93], v25 offset:40960
    v_mfma_f32_16x16x32_bf16 v[184:187], v[72:75], v[44:47], v[184:187]
    ds_read_b64_tr_b16 v[94:95], v25 offset:41984
    v_mfma_f32_16x16x32_bf16 v[140:143], v[76:79], v[32:35], v[140:143]
    v_mfma_f32_16x16x32_bf16 v[156:159], v[76:79], v[36:39], v[156:159]
    v_mfma_f32_16x16x32_bf16 v[172:175], v[76:79], v[40:43], v[172:175]
    v_mfma_f32_16x16x32_bf16 v[188:191], v[76:79], v[44:47], v[188:191]
    v_mfma_f32_16x16x32_bf16 v[192:195], v[120:123], v[32:35], v[192:195]
    v_mfma_f32_16x16x32_bf16 v[200:203], v[32:35], v[32:35], v[200:203]
    v_mfma_f32_16x16x32_bf16 v[208:211], v[64:67], v[120:123], v[208:211]
    v_mfma_f32_16x16x32_bf16 v[196:199], v[120:123], v[36:39], v[196:199]
    v_mfma_f32_16x16x32_bf16 v[204:207], v[36:39], v[36:39], v[204:207]
    v_mfma_f32_16x16x32_bf16 v[212:215], v[68:71], v[120:123], v[212:215]
    s_waitcnt lgkmcnt(0)
    s_barrier
    v_mfma_f32_16x16x32_bf16 v[128:131], v[80:83], v[48:51], v[128:131]
    v_add_u32 v14, 0x10000, v14
    v_add_u32 v15, 0x10000, v15
    v_mfma_f32_16x16x32_bf16 v[144:147], v[80:83], v[52:55], v[144:147]
    v_add_u32 v16, 0x10000, v16
    v_add_u32 v17, 0x10000, v17
    v_mfma_f32_16x16x32_bf16 v[160:163], v[80:83], v[56:59], v[160:163]
    v_add_u32 v22, 0x10000, v22
    v_add_u32 v23, 0x10000, v23
    v_mfma_f32_16x16x32_bf16 v[176:179], v[80:83], v[60:63], v[176:179]
    v_add_u32 v24, 0x10000, v24
    v_add_u32 v25, 0x10000, v25
    v_mfma_f32_16x16x32_bf16 v[132:135], v[84:87], v[48:51], v[132:135]
    ds_read_b128 v[32:35], v14 offset:0
    ds_read_b128 v[36:39], v14 offset:2048
    v_mfma_f32_16x16x32_bf16 v[148:151], v[84:87], v[52:55], v[148:151]
    ds_read_b128 v[40:43], v15 offset:4096
    ds_read_b128 v[44:47], v15 offset:6144
    v_mfma_f32_16x16x32_bf16 v[164:167], v[84:87], v[56:59], v[164:167]
    ds_read_b64_tr_b16 v[64:65], v22 offset:0
    ds_read_b64_tr_b16 v[66:67], v22 offset:1024
    v_mfma_f32_16x16x32_bf16 v[180:183], v[84:87], v[60:63], v[180:183]
    ds_read_b64_tr_b16 v[68:69], v23 offset:0
    ds_read_b64_tr_b16 v[70:71], v23 offset:1024
    v_mfma_f32_16x16x32_bf16 v[136:139], v[88:91], v[48:51], v[136:139]
    ds_read_b64_tr_b16 v[72:73], v24 offset:0
    ds_read_b64_tr_b16 v[74:75], v24 offset:1024
    v_mfma_f32_16x16x32_bf16 v[152:155], v[88:91], v[52:55], v[152:155]
    ds_read_b64_tr_b16 v[76:77], v25 offset:0
    ds_read_b64_tr_b16 v[78:79], v25 offset:1024
    v_mfma_f32_16x16x32_bf16 v[168:171], v[88:91], v[56:59], v[168:171]
    v_mfma_f32_16x16x32_bf16 v[184:187], v[88:91], v[60:63], v[184:187]
    v_mfma_f32_16x16x32_bf16 v[140:143], v[92:95], v[48:51], v[140:143]
    v_mfma_f32_16x16x32_bf16 v[156:159], v[92:95], v[52:55], v[156:159]
    v_mfma_f32_16x16x32_bf16 v[172:175], v[92:95], v[56:59], v[172:175]
    v_mfma_f32_16x16x32_bf16 v[188:191], v[92:95], v[60:63], v[188:191]
    v_mfma_f32_16x16x32_bf16 v[192:195], v[120:123], v[48:51], v[192:195]
    v_mfma_f32_16x16x32_bf16 v[200:203], v[48:51], v[48:51], v[200:203]
    v_mfma_f32_16x16x32_bf16 v[208:211], v[80:83], v[120:123], v[208:211]
    v_mfma_f32_16x16x32_bf16 v[196:199], v[120:123], v[52:55], v[196:199]
    v_mfma_f32_16x16x32_bf16 v[204:207], v[52:55], v[52:55], v[204:207]
    v_mfma_f32_16x16x32_bf16 v[212:215], v[84:87], v[120:123], v[212:215]
    s_waitcnt lgkmcnt(0)
    v_mfma_f32_16x16x32_bf16 v[128:131], v[64:67], v[32:35], v[128:131]
    ds_read_b128 v[48:51], v16 offset:0
    v_mfma_f32_16x16x32_bf16 v[144:147], v[64:67], v[36:39], v[144:147]
    ds_read_b128 v[52:55], v16 offset:2048
    v_mfma_f32_16x16x32_bf16 v[160:163], v[64:67], v[40:43], v[160:163]
    ds_read_b128 v[56:59], v17 offset:4096
    v_mfma_f32_16x16x32_bf16 v[176:179], v[64:67], v[44:47], v[176:179]
    ds_read_b128 v[60:63], v17 offset:6144
    v_mfma_f32_16x16x32_bf16 v[132:135], v[68:71], v[32:35], v[132:135]
    ds_read_b64_tr_b16 v[80:81], v22 offset:8192
    v_mfma_f32_16x16x32_bf16 v[148:151], v[68:71], v[36:39], v[148:151]
    ds_read_b64_tr_b16 v[82:83], v22 offset:9216
    v_mfma_f32_16x16x32_bf16 v[164:167], v[68:71], v[40:43], v[164:167]
    ds_read_b64_tr_b16 v[84:85], v23 offset:8192
    v_mfma_f32_16x16x32_bf16 v[180:183], v[68:71], v[44:47], v[180:183]
    ds_read_b64_tr_b16 v[86:87], v23 offset:9216
    v_mfma_f32_16x16x32_bf16 v[136:139], v[72:75], v[32:35], v[136:139]
    ds_read_b64_tr_b16 v[88:89], v24 offset:8192
    v_mfma_f32_16x16x32_bf16 v[152:155], v[72:75], v[36:39], v[152:155]
    ds_read_b64_tr_b16 v[90:91], v24 offset:9216
    v_mfma_f32_16x16x32_bf16 v[168:171], v[72:75], v[40:43], v[168:171]
    ds_read_b64_tr_b16 v[92:93], v25 offset:8192
    v_mfma_f32_16x16x32_bf16 v[184:187], v[72:75], v[44:47], v[184:187]
    ds_read_b64_tr_b16 v[94:95], v25 offset:9216
    v_mfma_f32_16x16x32_bf16 v[140:143], v[76:79], v[32:35], v[140:143]
    v_mfma_f32_16x16x32_bf16 v[156:159], v[76:79], v[36:39], v[156:159]
    v_mfma_f32_16x16x32_bf16 v[172:175], v[76:79], v[40:43], v[172:175]
    v_mfma_f32_16x16x32_bf16 v[188:191], v[76:79], v[44:47], v[188:191]
    v_mfma_f32_16x16x32_bf16 v[192:195], v[120:123], v[32:35], v[192:195]
    v_mfma_f32_16x16x32_bf16 v[200:203], v[32:35], v[32:35], v[200:203]
    v_mfma_f32_16x16x32_bf16 v[208:211], v[64:67], v[120:123], v[208:211]
    v_mfma_f32_16x16x32_bf16 v[196:199], v[120:123], v[36:39], v[196:199]
    v_mfma_f32_16x16x32_bf16 v[204:207], v[36:39], v[36:39], v[204:207]
    v_mfma_f32_16x16x32_bf16 v[212:215], v[68:71], v[120:123], v[212:215]
    s_waitcnt lgkmcnt(0)
    s_barrier
    v_mfma_f32_16x16x32_bf16 v[128:131], v[80:83], v[48:51], v[128:131]
    ds_read_b128 v[32:35], v14 offset:32768
    v_mfma_f32_16x16x32_bf16 v[144:147], v[80:83], v[52:55], v[144:147]
    ds_read_b128 v[36:39], v14 offset:34816
    v_mfma_f32_16x16x32_bf16 v[160:163], v[80:83], v[56:59], v[160:163]
    ds_read_b128 v[40:43], v15 offset:36864
    v_mfma_f32_16x16x32_bf16 v[176:179], v[80:83], v[60:63], v[176:179]
    ds_read_b128 v[44:47], v15 offset:38912
    v_mfma_f32_16x16x32_bf16 v[132:135], v[84:87], v[48:51], v[132:135]
    ds_read_b64_tr_b16 v[64:65], v22 offset:32768
    v_mfma_f32_16x16x32_bf16 v[148:151], v[84:87], v[52:55], v[148:151]
    ds_read_b64_tr_b16 v[66:67], v22 offset:33792
    v_mfma_f32_16x16x32_bf16 v[164:167], v[84:87], v[56:59], v[164:167]
    ds_read_b64_tr_b16 v[68:69], v23 offset:32768
    v_mfma_f32_16x16x32_bf16 v[180:183], v[84:87], v[60:63], v[180:183]
    ds_read_b64_tr_b16 v[70:71], v23 offset:33792
    v_mfma_f32_16x16x32_bf16 v[136:139], v[88:91], v[48:51], v[136:139]
    ds_read_b64_tr_b16 v[72:73], v24 offset:32768
    v_mfma_f32_16x16x32_bf16 v[152:155], v[88:91], v[52:55], v[152:155]
    ds_read_b64_tr_b16 v[74:75], v24 offset:33792
    v_mfma_f32_16x16x32_bf16 v[168:171], v[88:91], v[56:59], v[168:171]
    ds_read_b64_tr_b16 v[76:77], v25 offset:32768
    v_mfma_f32_16x16x32_bf16 v[184:187], v[88:91], v[60:63], v[184:187]
    ds_read_b64_tr_b16 v[78:79], v25 offset:33792
    v_mfma_f32_16x16x32_bf16 v[140:143], v[92:95], v[48:51], v[140:143]
    v_mfma_f32_16x16x32_bf16 v[156:159], v[92:95], v[52:55], v[156:159]
    v_mfma_f32_16x16x32_bf16 v[172:175], v[92:95], v[56:59], v[172:175]
    v_mfma_f32_16x16x32_bf16 v[188:191], v[92:95], v[60:63], v[188:191]
    v_mfma_f32_16x16x32_bf16 v[192:195], v[120:123], v[48:51], v[192:195]
    v_mfma_f32_16x16x32_bf16 v[200:203], v[48:51], v[48:51], v[200:203]
    v_mfma_f32_16x16x32_bf16 v[208:211], v[80:83], v[120:123], v[208:211]
    v_mfma_f32_16x16x32_bf16 v[196:199], v[120:123], v[52:55], v[196:199]
    v_mfma_f32_16x16x32_bf16 v[204:207], v[52:55], v[52:55], v[204:207]
    v_mfma_f32_16x16x32_bf16 v[212:215], v[84:87], v[120:123], v[212:215]
    s_waitcnt lgkmcnt(0)
    v_mfma_f32_16x16x32_bf16 v[128:131], v[64:67], v[32:35], v[128:131]
    ds_read_b128 v[48:51], v16 offset:32768
    v_mfma_f32_16x16x32_bf16 v[144:147], v[64:67], v[36:39], v[144:147]
    ds_read_b128 v[52:55], v16 offset:34816
    v_mfma_f32_16x16x32_bf16 v[160:163], v[64:67], v[40:43], v[160:163]
    ds_read_b128 v[56:59], v17 offset:36864
    v_mfma_f32_16x16x32_bf16 v[176:179], v[64:67], v[44:47], v[176:179]
    ds_read_b128 v[60:63], v17 offset:38912
    v_mfma_f32_16x16x32_bf16 v[132:135], v[68:71], v[32:35], v[132:135]
    ds_read_b64_tr_b16 v[80:81], v22 offset:40960
    v_mfma_f32_16x16x32_bf16 v[148:151], v[68:71], v[36:39], v[148:151]
    ds_read_b64_tr_b16 v[82:83], v22 offset:41984
    v_mfma_f32_16x16x32_bf16 v[164:167], v[68:71], v[40:43], v[164:167]
    ds_read_b64_tr_b16 v[84:85], v23 offset:40960
    v_mfma_f32_16x16x32_bf16 v[180:183], v[68:71], v[44:47], v[180:183]
    ds_read_b64_tr_b16 v[86:87], v23 offset:41984
    v_mfma_f32_16x16x32_bf16 v[136:139], v[72:75], v[32:35], v[136:139]
    ds_read_b64_tr_b16 v[88:89], v24 offset:40960
    v_mfma_f32_16x16x32_bf16 v[152:155], v[72:75], v[36:39], v[152:155]
    ds_read_b64_tr_b16 v[90:91], v24 offset:41984
    v_mfma_f32_16x16x32_bf16 v[168:171], v[72:75], v[40:43], v[168:171]
    ds_read_b64_tr_b16 v[92:93], v25 offset:40960
    v_mfma_f32_16x16x32_bf16 v[184:187], v[72:75], v[44:47], v[184:187]
    ds_read_b64_tr_b16 v[94:95], v25 offset:41984
    v_mfma_f32_16x16x32_bf16 v[140:143], v[76:79], v[32:35], v[140:143]
    v_mfma_f32_16x16x32_bf16 v[156:159], v[76:79], v[36:39], v[156:159]
    v_mfma_f32_16x16x32_bf16 v[172:175], v[76:79], v[40:43], v[172:175]
    v_mfma_f32_16x16x32_bf16 v[188:191], v[76:79], v[44:47], v[188:191]
    v_mfma_f32_16x16x32_bf16 v[192:195], v[120:123], v[32:35], v[192:195]
    v_mfma_f32_16x16x32_bf16 v[200:203], v[32:35], v[32:35], v[200:203]
    v_mfma_f32_16x16x32_bf16 v[208:211], v[64:67], v[120:123], v[208:211]
    v_mfma_f32_16x16x32_bf16 v[196:199], v[120:123], v[36:39], v[196:199]
    v_mfma_f32_16x16x32_bf16 v[204:207], v[36:39], v[36:39], v[204:207]
    v_mfma_f32_16x16x32_bf16 v[212:215], v[68:71], v[120:123], v[212:215]
    s_waitcnt lgkmcnt(0)
    s_barrier
    v_mfma_f32_16x16x32_bf16 v[128:131], v[80:83], v[48:51], v[128:131]
    v_add_u32 v14, 0xffff0000, v14
    v_add_u32 v15, 0xffff0000, v15
    v_mfma_f32_16x16x32_bf16 v[144:147], v[80:83], v[52:55], v[144:147]
    v_add_u32 v16, 0xffff0000, v16
    v_add_u32 v17, 0xffff0000, v17
    v_mfma_f32_16x16x32_bf16 v[160:163], v[80:83], v[56:59], v[160:163]
    v_add_u32 v22, 0xffff0000, v22
    v_add_u32 v23, 0xffff0000, v23
    v_mfma_f32_16x16x32_bf16 v[176:179], v[80:83], v[60:63], v[176:179]
    v_add_u32 v24, 0xffff0000, v24
    v_add_u32 v25, 0xffff0000, v25
    v_mfma_f32_16x16x32_bf16 v[132:135], v[84:87], v[48:51], v[132:135]
    ds_read_b128 v[32:35], v14 offset:0
    ds_read_b128 v[36:39], v14 offset:2048
    v_mfma_f32_16x16x32_bf16 v[148:151], v[84:87], v[52:55], v[148:151]
    ds_read_b128 v[40:43], v15 offset:4096
    ds_read_b128 v[44:47], v15 offset:6144
    v_mfma_f32_16x16x32_bf16 v[164:167], v[84:87], v[56:59], v[164:167]
    ds_read_b64_tr_b16 v[64:65], v22 offset:0
    ds_read_b64_tr_b16 v[66:67], v22 offset:1024
    v_mfma_f32_16x16x32_bf16 v[180:183], v[84:87], v[60:63], v[180:183]
    ds_read_b64_tr_b16 v[68:69], v23 offset:0
    ds_read_b64_tr_b16 v[70:71], v23 offset:1024
    v_mfma_f32_16x16x32_bf16 v[136:139], v[88:91], v[48:51], v[136:139]
    ds_read_b64_tr_b16 v[72:73], v24 offset:0
    ds_read_b64_tr_b16 v[74:75], v24 offset:1024
    v_mfma_f32_16x16x32_bf16 v[152:155], v[88:91], v[52:55], v[152:155]
    ds_read_b64_tr_b16 v[76:77], v25 offset:0
    ds_read_b64_tr_b16 v[78:79], v25 offset:1024
    v_mfma_f32_16x16x32_bf16 v[168:171], v[88:91], v[56:59], v[168:171]
    v_mfma_f32_16x16x32_bf16 v[184:187], v[88:91], v[60:63], v[184:187]
    v_mfma_f32_16x16x32_bf16 v[140:143], v[92:95], v[48:51], v[140:143]
    v_mfma_f32_16x16x32_bf16 v[156:159], v[92:95], v[52:55], v[156:159]
    v_mfma_f32_16x16x32_bf16 v[172:175], v[92:95], v[56:59], v[172:175]
    v_mfma_f32_16x16x32_bf16 v[188:191], v[92:95], v[60:63], v[188:191]
    v_mfma_f32_16x16x32_bf16 v[192:195], v[120:123], v[48:51], v[192:195]
    v_mfma_f32_16x16x32_bf16 v[200:203], v[48:51], v[48:51], v[200:203]
    v_mfma_f32_16x16x32_bf16 v[208:211], v[80:83], v[120:123], v[208:211]
    v_mfma_f32_16x16x32_bf16 v[196:199], v[120:123], v[52:55], v[196:199]
    v_mfma_f32_16x16x32_bf16 v[204:207], v[52:55], v[52:55], v[204:207]
    v_mfma_f32_16x16x32_bf16 v[212:215], v[84:87], v[120:123], v[212:215]
    s_waitcnt lgkmcnt(0)
    v_mfma_f32_16x16x32_bf16 v[128:131], v[64:67], v[32:35], v[128:131]
    ds_read_b128 v[48:51], v16 offset:0
    v_mfma_f32_16x16x32_bf16 v[144:147], v[64:67], v[36:39], v[144:147]
    ds_read_b128 v[52:55], v16 offset:2048
    v_mfma_f32_16x16x32_bf16 v[160:163], v[64:67], v[40:43], v[160:163]
    ds_read_b128 v[56:59], v17 offset:4096
    v_mfma_f32_16x16x32_bf16 v[176:179], v[64:67], v[44:47], v[176:179]
    ds_read_b128 v[60:63], v17 offset:6144
    v_mfma_f32_16x16x32_bf16 v[132:135], v[68:71], v[32:35], v[132:135]
    ds_read_b64_tr_b16 v[80:81], v22 offset:8192
    v_mfma_f32_16x16x32_bf16 v[148:151], v[68:71], v[36:39], v[148:151]
    ds_read_b64_tr_b16 v[82:83], v22 offset:9216
    v_mfma_f32_16x16x32_bf16 v[164:167], v[68:71], v[40:43], v[164:167]
    ds_read_b64_tr_b16 v[84:85], v23 offset:8192
    v_mfma_f32_16x16x32_bf16 v[180:183], v[68:71], v[44:47], v[180:183]
    ds_read_b64_tr_b16 v[86:87], v23 offset:9216
    v_mfma_f32_16x16x32_bf16 v[136:139], v[72:75], v[32:35], v[136:139]
    ds_read_b64_tr_b16 v[88:89], v24 offset:8192
    v_mfma_f32_16x16x32_bf16 v[152:155], v[72:75], v[36:39], v[152:155]
    ds_read_b64_tr_b16 v[90:91], v24 offset:9216
    v_mfma_f32_16x16x32_bf16 v[168:171], v[72:75], v[40:43], v[168:171]
    ds_read_b64_tr_b16 v[92:93], v25 offset:8192
    v_mfma_f32_16x16x32_bf16 v[184:187], v[72:75], v[44:47], v[184:187]
    ds_read_b64_tr_b16 v[94:95], v25 offset:9216
    v_mfma_f32_16x16x32_bf16 v[140:143], v[76:79], v[32:35], v[140:143]
    v_mfma_f32_16x16x32_bf16 v[156:159], v[76:79], v[36:39], v[156:159]
    v_mfma_f32_16x16x32_bf16 v[172:175], v[76:79], v[40:43], v[172:175]
    v_mfma_f32_16x16x32_bf16 v[188:191], v[76:79], v[44:47], v[188:191]
    v_mfma_f32_16x16x32_bf16 v[192:195], v[120:123], v[32:35], v[192:195]
    v_mfma_f32_16x16x32_bf16 v[200:203], v[32:35], v[32:35], v[200:203]
    v_mfma_f32_16x16x32_bf16 v[208:211], v[64:67], v[120:123], v[208:211]
    v_mfma_f32_16x16x32_bf16 v[196:199], v[120:123], v[36:39], v[196:199]
    v_mfma_f32_16x16x32_bf16 v[204:207], v[36:39], v[36:39], v[204:207]
    v_mfma_f32_16x16x32_bf16 v[212:215], v[68:71], v[120:123], v[212:215]
    s_waitcnt lgkmcnt(0)
    s_barrier
    v_mfma_f32_16x16x32_bf16 v[128:131], v[80:83], v[48:51], v[128:131]
    ds_read_b128 v[32:35], v14 offset:32768
    v_mfma_f32_16x16x32_bf16 v[144:147], v[80:83], v[52:55], v[144:147]
    ds_read_b128 v[36:39], v14 offset:34816
    v_mfma_f32_16x16x32_bf16 v[160:163], v[80:83], v[56:59], v[160:163]
    ds_read_b128 v[40:43], v15 offset:36864
    v_mfma_f32_16x16x32_bf16 v[176:179], v[80:83], v[60:63], v[176:179]
    ds_read_b128 v[44:47], v15 offset:38912
    v_mfma_f32_16x16x32_bf16 v[132:135], v[84:87], v[48:51], v[132:135]
    ds_read_b64_tr_b16 v[64:65], v22 offset:32768
    v_mfma_f32_16x16x32_bf16 v[148:151], v[84:87], v[52:55], v[148:151]
    ds_read_b64_tr_b16 v[66:67], v22 offset:33792
    v_mfma_f32_16x16x32_bf16 v[164:167], v[84:87], v[56:59], v[164:167]
    ds_read_b64_tr_b16 v[68:69], v23 offset:32768
    v_mfma_f32_16x16x32_bf16 v[180:183], v[84:87], v[60:63], v[180:183]
    ds_read_b64_tr_b16 v[70:71], v23 offset:33792
    v_mfma_f32_16x16x32_bf16 v[136:139], v[88:91], v[48:51], v[136:139]
    ds_read_b64_tr_b16 v[72:73], v24 offset:32768
    v_mfma_f32_16x16x32_bf16 v[152:155], v[88:91], v[52:55], v[152:155]
    ds_read_b64_tr_b16 v[74:75], v24 offset:33792
    v_mfma_f32_16x16x32_bf16 v[168:171], v[88:91], v[56:59], v[168:171]
    ds_read_b64_tr_b16 v[76:77], v25 offset:32768
    v_mfma_f32_16x16x32_bf16 v[184:187], v[88:91], v[60:63], v[184:187]
    ds_read_b64_tr_b16 v[78:79], v25 offset:33792
    v_mfma_f32_16x16x32_bf16 v[140:143], v[92:95], v[48:51], v[140:143]
    v_mfma_f32_16x16x32_bf16 v[156:159], v[92:95], v[52:55], v[156:159]
    v_mfma_f32_16x16x32_bf16 v[172:175], v[92:95], v[56:59], v[172:175]
    v_mfma_f32_16x16x32_bf16 v[188:191], v[92:95], v[60:63], v[188:191]
    v_mfma_f32_16x16x32_bf16 v[192:195], v[120:123], v[48:51], v[192:195]
    v_mfma_f32_16x16x32_bf16 v[200:203], v[48:51], v[48:51], v[200:203]
    v_mfma_f32_16x16x32_bf16 v[208:211], v[80:83], v[120:123], v[208:211]
    v_mfma_f32_16x16x32_bf16 v[196:199], v[120:123], v[52:55], v[196:199]
    v_mfma_f32_16x16x32_bf16 v[204:207], v[52:55], v[52:55], v[204:207]
    v_mfma_f32_16x16x32_bf16 v[212:215], v[84:87], v[120:123], v[212:215]
    s_waitcnt lgkmcnt(0)
    v_mfma_f32_16x16x32_bf16 v[128:131], v[64:67], v[32:35], v[128:131]
    ds_read_b128 v[48:51], v16 offset:32768
    v_mfma_f32_16x16x32_bf16 v[144:147], v[64:67], v[36:39], v[144:147]
    ds_read_b128 v[52:55], v16 offset:34816
    v_mfma_f32_16x16x32_bf16 v[160:163], v[64:67], v[40:43], v[160:163]
    ds_read_b128 v[56:59], v17 offset:36864
    v_mfma_f32_16x16x32_bf16 v[176:179], v[64:67], v[44:47], v[176:179]
    ds_read_b128 v[60:63], v17 offset:38912
    v_mfma_f32_16x16x32_bf16 v[132:135], v[68:71], v[32:35], v[132:135]
    ds_read_b64_tr_b16 v[80:81], v22 offset:40960
    v_mfma_f32_16x16x32_bf16 v[148:151], v[68:71], v[36:39], v[148:151]
    ds_read_b64_tr_b16 v[82:83], v22 offset:41984
    v_mfma_f32_16x16x32_bf16 v[164:167], v[68:71], v[40:43], v[164:167]
    ds_read_b64_tr_b16 v[84:85], v23 offset:40960
    v_mfma_f32_16x16x32_bf16 v[180:183], v[68:71], v[44:47], v[180:183]
    ds_read_b64_tr_b16 v[86:87], v23 offset:41984
    v_mfma_f32_16x16x32_bf16 v[136:139], v[72:75], v[32:35], v[136:139]
    ds_read_b64_tr_b16 v[88:89], v24 offset:40960
    v_mfma_f32_16x16x32_bf16 v[152:155], v[72:75], v[36:39], v[152:155]
    ds_read_b64_tr_b16 v[90:91], v24 offset:41984
    v_mfma_f32_16x16x32_bf16 v[168:171], v[72:75], v[40:43], v[168:171]
    ds_read_b64_tr_b16 v[92:93], v25 offset:40960
    v_mfma_f32_16x16x32_bf16 v[184:187], v[72:75], v[44:47], v[184:187]
    ds_read_b64_tr_b16 v[94:95], v25 offset:41984
    v_mfma_f32_16x16x32_bf16 v[140:143], v[76:79], v[32:35], v[140:143]
    v_mfma_f32_16x16x32_bf16 v[156:159], v[76:79], v[36:39], v[156:159]
    v_mfma_f32_16x16x32_bf16 v[172:175], v[76:79], v[40:43], v[172:175]
    v_mfma_f32_16x16x32_bf16 v[188:191], v[76:79], v[44:47], v[188:191]
    v_mfma_f32_16x16x32_bf16 v[192:195], v[120:123], v[32:35], v[192:195]
    v_mfma_f32_16x16x32_bf16 v[200:203], v[32:35], v[32:35], v[200:203]
    v_mfma_f32_16x16x32_bf16 v[208:211], v[64:67], v[120:123], v[208:211]
    v_mfma_f32_16x16x32_bf16 v[196:199], v[120:123], v[36:39], v[196:199]
    v_mfma_f32_16x16x32_bf16 v[204:207], v[36:39], v[36:39], v[204:207]
    v_mfma_f32_16x16x32_bf16 v[212:215], v[68:71], v[120:123], v[212:215]
    s_waitcnt lgkmcnt(0)
    s_barrier
    v_mfma_f32_16x16x32_bf16 v[128:131], v[80:83], v[48:51], v[128:131]
    v_add_u32 v14, 0x10000, v14
    v_add_u32 v15, 0x10000, v15
    v_mfma_f32_16x16x32_bf16 v[144:147], v[80:83], v[52:55], v[144:147]
    v_add_u32 v16, 0x10000, v16
    v_add_u32 v17, 0x10000, v17
    v_mfma_f32_16x16x32_bf16 v[160:163], v[80:83], v[56:59], v[160:163]
    v_add_u32 v22, 0x10000, v22
    v_add_u32 v23, 0x10000, v23
    v_mfma_f32_16x16x32_bf16 v[176:179], v[80:83], v[60:63], v[176:179]
    v_add_u32 v24, 0x10000, v24
    v_add_u32 v25, 0x10000, v25
    v_mfma_f32_16x16x32_bf16 v[132:135], v[84:87], v[48:51], v[132:135]
    ds_read_b128 v[32:35], v14 offset:0
    ds_read_b128 v[36:39], v14 offset:2048
    v_mfma_f32_16x16x32_bf16 v[148:151], v[84:87], v[52:55], v[148:151]
    ds_read_b128 v[40:43], v15 offset:4096
    ds_read_b128 v[44:47], v15 offset:6144
    v_mfma_f32_16x16x32_bf16 v[164:167], v[84:87], v[56:59], v[164:167]
    ds_read_b64_tr_b16 v[64:65], v22 offset:0
    ds_read_b64_tr_b16 v[66:67], v22 offset:1024
    v_mfma_f32_16x16x32_bf16 v[180:183], v[84:87], v[60:63], v[180:183]
    ds_read_b64_tr_b16 v[68:69], v23 offset:0
    ds_read_b64_tr_b16 v[70:71], v23 offset:1024
    v_mfma_f32_16x16x32_bf16 v[136:139], v[88:91], v[48:51], v[136:139]
    ds_read_b64_tr_b16 v[72:73], v24 offset:0
    ds_read_b64_tr_b16 v[74:75], v24 offset:1024
    v_mfma_f32_16x16x32_bf16 v[152:155], v[88:91], v[52:55], v[152:155]
    ds_read_b64_tr_b16 v[76:77], v25 offset:0
    ds_read_b64_tr_b16 v[78:79], v25 offset:1024
    v_mfma_f32_16x16x32_bf16 v[168:171], v[88:91], v[56:59], v[168:171]
    v_mfma_f32_16x16x32_bf16 v[184:187], v[88:91], v[60:63], v[184:187]
    v_mfma_f32_16x16x32_bf16 v[140:143], v[92:95], v[48:51], v[140:143]
    v_mfma_f32_16x16x32_bf16 v[156:159], v[92:95], v[52:55], v[156:159]
    v_mfma_f32_16x16x32_bf16 v[172:175], v[92:95], v[56:59], v[172:175]
    v_mfma_f32_16x16x32_bf16 v[188:191], v[92:95], v[60:63], v[188:191]
    v_mfma_f32_16x16x32_bf16 v[192:195], v[120:123], v[48:51], v[192:195]
    v_mfma_f32_16x16x32_bf16 v[200:203], v[48:51], v[48:51], v[200:203]
    v_mfma_f32_16x16x32_bf16 v[208:211], v[80:83], v[120:123], v[208:211]
    v_mfma_f32_16x16x32_bf16 v[196:199], v[120:123], v[52:55], v[196:199]
    v_mfma_f32_16x16x32_bf16 v[204:207], v[52:55], v[52:55], v[204:207]
    v_mfma_f32_16x16x32_bf16 v[212:215], v[84:87], v[120:123], v[212:215]
    s_waitcnt lgkmcnt(0)
    v_mfma_f32_16x16x32_bf16 v[128:131], v[64:67], v[32:35], v[128:131]
    ds_read_b128 v[48:51], v16 offset:0
    v_mfma_f32_16x16x32_bf16 v[144:147], v[64:67], v[36:39], v[144:147]
    ds_read_b128 v[52:55], v16 offset:2048
    v_mfma_f32_16x16x32_bf16 v[160:163], v[64:67], v[40:43], v[160:163]
    ds_read_b128 v[56:59], v17 offset:4096
    v_mfma_f32_16x16x32_bf16 v[176:179], v[64:67], v[44:47], v[176:179]
    ds_read_b128 v[60:63], v17 offset:6144
    v_mfma_f32_16x16x32_bf16 v[132:135], v[68:71], v[32:35], v[132:135]
    ds_read_b64_tr_b16 v[80:81], v22 offset:8192
    v_mfma_f32_16x16x32_bf16 v[148:151], v[68:71], v[36:39], v[148:151]
    ds_read_b64_tr_b16 v[82:83], v22 offset:9216
    v_mfma_f32_16x16x32_bf16 v[164:167], v[68:71], v[40:43], v[164:167]
    ds_read_b64_tr_b16 v[84:85], v23 offset:8192
    v_mfma_f32_16x16x32_bf16 v[180:183], v[68:71], v[44:47], v[180:183]
    ds_read_b64_tr_b16 v[86:87], v23 offset:9216
    v_mfma_f32_16x16x32_bf16 v[136:139], v[72:75], v[32:35], v[136:139]
    ds_read_b64_tr_b16 v[88:89], v24 offset:8192
    v_mfma_f32_16x16x32_bf16 v[152:155], v[72:75], v[36:39], v[152:155]
    ds_read_b64_tr_b16 v[90:91], v24 offset:9216
    v_mfma_f32_16x16x32_bf16 v[168:171], v[72:75], v[40:43], v[168:171]
    ds_read_b64_tr_b16 v[92:93], v25 offset:8192
    v_mfma_f32_16x16x32_bf16 v[184:187], v[72:75], v[44:47], v[184:187]
    ds_read_b64_tr_b16 v[94:95], v25 offset:9216
    v_mfma_f32_16x16x32_bf16 v[140:143], v[76:79], v[32:35], v[140:143]
    v_mfma_f32_16x16x32_bf16 v[156:159], v[76:79], v[36:39], v[156:159]
    v_mfma_f32_16x16x32_bf16 v[172:175], v[76:79], v[40:43], v[172:175]
    v_mfma_f32_16x16x32_bf16 v[188:191], v[76:79], v[44:47], v[188:191]
    v_mfma_f32_16x16x32_bf16 v[192:195], v[120:123], v[32:35], v[192:195]
    v_mfma_f32_16x16x32_bf16 v[200:203], v[32:35], v[32:35], v[200:203]
    v_mfma_f32_16x16x32_bf16 v[208:211], v[64:67], v[120:123], v[208:211]
    v_mfma_f32_16x16x32_bf16 v[196:199], v[120:123], v[36:39], v[196:199]
    v_mfma_f32_16x16x32_bf16 v[204:207], v[36:39], v[36:39], v[204:207]
    v_mfma_f32_16x16x32_bf16 v[212:215], v[68:71], v[120:123], v[212:215]
    s_waitcnt lgkmcnt(0)
    s_barrier
    v_mfma_f32_16x16x32_bf16 v[128:131], v[80:83], v[48:51], v[128:131]
    ds_read_b128 v[32:35], v14 offset:32768
    v_mfma_f32_16x16x32_bf16 v[144:147], v[80:83], v[52:55], v[144:147]
    ds_read_b128 v[36:39], v14 offset:34816
    v_mfma_f32_16x16x32_bf16 v[160:163], v[80:83], v[56:59], v[160:163]
    ds_read_b128 v[40:43], v15 offset:36864
    v_mfma_f32_16x16x32_bf16 v[176:179], v[80:83], v[60:63], v[176:179]
    ds_read_b128 v[44:47], v15 offset:38912
    v_mfma_f32_16x16x32_bf16 v[132:135], v[84:87], v[48:51], v[132:135]
    ds_read_b64_tr_b16 v[64:65], v22 offset:32768
    v_mfma_f32_16x16x32_bf16 v[148:151], v[84:87], v[52:55], v[148:151]
    ds_read_b64_tr_b16 v[66:67], v22 offset:33792
    v_mfma_f32_16x16x32_bf16 v[164:167], v[84:87], v[56:59], v[164:167]
    ds_read_b64_tr_b16 v[68:69], v23 offset:32768
    v_mfma_f32_16x16x32_bf16 v[180:183], v[84:87], v[60:63], v[180:183]
    ds_read_b64_tr_b16 v[70:71], v23 offset:33792
    v_mfma_f32_16x16x32_bf16 v[136:139], v[88:91], v[48:51], v[136:139]
    ds_read_b64_tr_b16 v[72:73], v24 offset:32768
    v_mfma_f32_16x16x32_bf16 v[152:155], v[88:91], v[52:55], v[152:155]
    ds_read_b64_tr_b16 v[74:75], v24 offset:33792
    v_mfma_f32_16x16x32_bf16 v[168:171], v[88:91], v[56:59], v[168:171]
    ds_read_b64_tr_b16 v[76:77], v25 offset:32768
    v_mfma_f32_16x16x32_bf16 v[184:187], v[88:91], v[60:63], v[184:187]
    ds_read_b64_tr_b16 v[78:79], v25 offset:33792
    v_mfma_f32_16x16x32_bf16 v[140:143], v[92:95], v[48:51], v[140:143]
    v_mfma_f32_16x16x32_bf16 v[156:159], v[92:95], v[52:55], v[156:159]
    v_mfma_f32_16x16x32_bf16 v[172:175], v[92:95], v[56:59], v[172:175]
    v_mfma_f32_16x16x32_bf16 v[188:191], v[92:95], v[60:63], v[188:191]
    v_mfma_f32_16x16x32_bf16 v[192:195], v[120:123], v[48:51], v[192:195]
    v_mfma_f32_16x16x32_bf16 v[200:203], v[48:51], v[48:51], v[200:203]
    v_mfma_f32_16x16x32_bf16 v[208:211], v[80:83], v[120:123], v[208:211]
    v_mfma_f32_16x16x32_bf16 v[196:199], v[120:123], v[52:55], v[196:199]
    v_mfma_f32_16x16x32_bf16 v[204:207], v[52:55], v[52:55], v[204:207]
    v_mfma_f32_16x16x32_bf16 v[212:215], v[84:87], v[120:123], v[212:215]
    s_waitcnt lgkmcnt(0)
    v_mfma_f32_16x16x32_bf16 v[128:131], v[64:67], v[32:35], v[128:131]
    ds_read_b128 v[48:51], v16 offset:32768
    v_mfma_f32_16x16x32_bf16 v[144:147], v[64:67], v[36:39], v[144:147]
    ds_read_b128 v[52:55], v16 offset:34816
    v_mfma_f32_16x16x32_bf16 v[160:163], v[64:67], v[40:43], v[160:163]
    ds_read_b128 v[56:59], v17 offset:36864
    v_mfma_f32_16x16x32_bf16 v[176:179], v[64:67], v[44:47], v[176:179]
    ds_read_b128 v[60:63], v17 offset:38912
    v_mfma_f32_16x16x32_bf16 v[132:135], v[68:71], v[32:35], v[132:135]
    ds_read_b64_tr_b16 v[80:81], v22 offset:40960
    v_mfma_f32_16x16x32_bf16 v[148:151], v[68:71], v[36:39], v[148:151]
    ds_read_b64_tr_b16 v[82:83], v22 offset:41984
    v_mfma_f32_16x16x32_bf16 v[164:167], v[68:71], v[40:43], v[164:167]
    ds_read_b64_tr_b16 v[84:85], v23 offset:40960
    v_mfma_f32_16x16x32_bf16 v[180:183], v[68:71], v[44:47], v[180:183]
    ds_read_b64_tr_b16 v[86:87], v23 offset:41984
    v_mfma_f32_16x16x32_bf16 v[136:139], v[72:75], v[32:35], v[136:139]
    ds_read_b64_tr_b16 v[88:89], v24 offset:40960
    v_mfma_f32_16x16x32_bf16 v[152:155], v[72:75], v[36:39], v[152:155]
    ds_read_b64_tr_b16 v[90:91], v24 offset:41984
    v_mfma_f32_16x16x32_bf16 v[168:171], v[72:75], v[40:43], v[168:171]
    ds_read_b64_tr_b16 v[92:93], v25 offset:40960
    v_mfma_f32_16x16x32_bf16 v[184:187], v[72:75], v[44:47], v[184:187]
    ds_read_b64_tr_b16 v[94:95], v25 offset:41984
    v_mfma_f32_16x16x32_bf16 v[140:143], v[76:79], v[32:35], v[140:143]
    v_mfma_f32_16x16x32_bf16 v[156:159], v[76:79], v[36:39], v[156:159]
    v_mfma_f32_16x16x32_bf16 v[172:175], v[76:79], v[40:43], v[172:175]
    v_mfma_f32_16x16x32_bf16 v[188:191], v[76:79], v[44:47], v[188:191]
    v_mfma_f32_16x16x32_bf16 v[192:195], v[120:123], v[32:35], v[192:195]
    v_mfma_f32_16x16x32_bf16 v[200:203], v[32:35], v[32:35], v[200:203]
    v_mfma_f32_16x16x32_bf16 v[208:211], v[64:67], v[120:123], v[208:211]
    v_mfma_f32_16x16x32_bf16 v[196:199], v[120:123], v[36:39], v[196:199]
    v_mfma_f32_16x16x32_bf16 v[204:207], v[36:39], v[36:39], v[204:207]
    v_mfma_f32_16x16x32_bf16 v[212:215], v[68:71], v[120:123], v[212:215]
    s_waitcnt lgkmcnt(0)
    v_mfma_f32_16x16x32_bf16 v[128:131], v[80:83], v[48:51], v[128:131]
    v_mfma_f32_16x16x32_bf16 v[144:147], v[80:83], v[52:55], v[144:147]
    v_mfma_f32_16x16x32_bf16 v[160:163], v[80:83], v[56:59], v[160:163]
    v_mfma_f32_16x16x32_bf16 v[176:179], v[80:83], v[60:63], v[176:179]
    v_mfma_f32_16x16x32_bf16 v[132:135], v[84:87], v[48:51], v[132:135]
    v_mfma_f32_16x16x32_bf16 v[148:151], v[84:87], v[52:55], v[148:151]
    v_mfma_f32_16x16x32_bf16 v[164:167], v[84:87], v[56:59], v[164:167]
    v_mfma_f32_16x16x32_bf16 v[180:183], v[84:87], v[60:63], v[180:183]
    v_mfma_f32_16x16x32_bf16 v[136:139], v[88:91], v[48:51], v[136:139]
    v_mfma_f32_16x16x32_bf16 v[152:155], v[88:91], v[52:55], v[152:155]
    v_mfma_f32_16x16x32_bf16 v[168:171], v[88:91], v[56:59], v[168:171]
    v_mfma_f32_16x16x32_bf16 v[184:187], v[88:91], v[60:63], v[184:187]
    v_mfma_f32_16x16x32_bf16 v[140:143], v[92:95], v[48:51], v[140:143]
    v_mfma_f32_16x16x32_bf16 v[156:159], v[92:95], v[52:55], v[156:159]
    v_mfma_f32_16x16x32_bf16 v[172:175], v[92:95], v[56:59], v[172:175]
    v_mfma_f32_16x16x32_bf16 v[188:191], v[92:95], v[60:63], v[188:191]
    v_mfma_f32_16x16x32_bf16 v[192:195], v[120:123], v[48:51], v[192:195]
    v_mfma_f32_16x16x32_bf16 v[200:203], v[48:51], v[48:51], v[200:203]
    v_mfma_f32_16x16x32_bf16 v[208:211], v[80:83], v[120:123], v[208:211]
    v_mfma_f32_16x16x32_bf16 v[196:199], v[120:123], v[52:55], v[196:199]
    v_mfma_f32_16x16x32_bf16 v[204:207], v[52:55], v[52:55], v[204:207]
    v_mfma_f32_16x16x32_bf16 v[212:215], v[84:87], v[120:123], v[212:215]
    s_nop 7
    v_and_b32 v28, 3, v2
    v_lshrrev_b32 v29, 2, v2
    v_mov_b32 v120, v192
    v_mov_b32 v121, v200
    v_cmp_eq_u32 vcc, 1, v28
    s_nop 1
    v_cndmask_b32 v121, v121, v201, vcc
    v_cmp_eq_u32 vcc, 2, v28
    s_nop 1
    v_cndmask_b32 v121, v121, v202, vcc
    v_cmp_eq_u32 vcc, 3, v28
    s_nop 1
    v_cndmask_b32 v121, v121, v203, vcc
    v_cmp_eq_u32 vcc, v29, v3
    v_mov_b32 v52, 0
    s_nop 1
    v_cndmask_b32 v121, v52, v121, vcc
    v_mov_b32 v30, v121
    v_mov_b32 v31, v121
    s_nop 1
    v_permlane16_swap_b32 v30, v31
    s_nop 1
    v_add_f32 v121, v30, v31
    s_nop 0
    v_mov_b32 v30, v121
    v_mov_b32 v31, v121
    s_nop 1
    v_permlane32_swap_b32 v30, v31
    s_nop 1
    v_add_f32 v121, v30, v31
    v_mov_b32 v122, v196
    v_mov_b32 v123, v204
    v_cmp_eq_u32 vcc, 1, v28
    s_nop 1
    v_cndmask_b32 v123, v123, v205, vcc
    v_cmp_eq_u32 vcc, 2, v28
    s_nop 1
    v_cndmask_b32 v123, v123, v206, vcc
    v_cmp_eq_u32 vcc, 3, v28
    s_nop 1
    v_cndmask_b32 v123, v123, v207, vcc
    v_cmp_eq_u32 vcc, v29, v3
    v_mov_b32 v52, 0
    s_nop 1
    v_cndmask_b32 v123, v52, v123, vcc
    v_mov_b32 v30, v123
    v_mov_b32 v31, v123
    s_nop 1
    v_permlane16_swap_b32 v30, v31
    s_nop 1
    v_add_f32 v123, v30, v31
    s_nop 0
    v_mov_b32 v30, v123
    v_mov_b32 v31, v123
    s_nop 1
    v_permlane32_swap_b32 v30, v31
    s_nop 1
    v_add_f32 v123, v30, v31
    s_lshl_b32 s34, s31, 6
    s_lshl_b32 s35, s32, 5
    s_add_u32 s34, s34, s35
    v_add_u32 v28, s34, v2
    v_lshlrev_b32 v28, 3, v28
    v_add_u32 v28, 0x20000, v28
    v_mul_f32 v32, 0x3b000000, v120
    v_mul_f32 v30, 0x3b000000, v121
    v_fma_f32 v30, -v32, v32, v30
    v_max_f32 v30, 0, v30
    v_add_f32 v30, 0x3727c5ac, v30
    v_rsq_f32 v33, v30
    s_nop 0
    ds_write_b64 v28, v[32:33] offset:0
    v_mul_f32 v34, 0x3b000000, v122
    v_mul_f32 v30, 0x3b000000, v123
    v_fma_f32 v30, -v34, v34, v30
    v_max_f32 v30, 0, v30
    v_add_f32 v30, 0x3727c5ac, v30
    v_rsq_f32 v35, v30
    s_nop 0
    ds_write_b64 v28, v[34:35] offset:128
    s_lshl_b32 s34, s32, 8
    s_lshl_b32 s35, s31, 7
    s_add_u32 s34, s34, s35
    v_lshlrev_b32 v29, 4, v3
    v_add_u32 v29, s34, v29
    v_add_u32 v29, 0x20400, v29
    ds_write_b128 v29, v[208:211] offset:0
    ds_write_b128 v29, v[212:215] offset:64
    s_waitcnt lgkmcnt(0)
    s_barrier
    s_lshl_b32 s34, s31, 6
    v_add_u32 v28, s34, v2
    v_lshlrev_b32 v28, 3, v28
    v_add_u32 v28, 0x20000, v28
    s_lshl_b32 s35, s32, 8
    v_add_u32 v30, s35, v28
    v_subrev_u32 v31, s35, v28
    ds_read_b64 v[96:97], v30 offset:0
    ds_read_b64 v[98:99], v30 offset:128
    ds_read_b64 v[100:101], v31 offset:256
    ds_read_b64 v[102:103], v31 offset:384
    s_lshl_b32 s34, s32, 8
    v_lshlrev_b32 v28, 4, v3
    v_add_u32 v28, s34, v28
    v_add_u32 v28, 0x20400, v28
    s_lshl_b32 s35, s31, 7
    v_add_u32 v30, s35, v28
    v_subrev_u32 v31, s35, v28
    ds_read_b128 v[64:67], v30 offset:0
    ds_read_b128 v[68:71], v30 offset:64
    ds_read_b128 v[72:75], v31 offset:128
    ds_read_b128 v[76:79], v31 offset:192
    s_lshl_b32 s34, s31, 6
    s_add_u32 s34, s34, s28
    s_lshl_b32 s35, s32, 5
    s_add_u32 s38, s34, s35
    s_add_u32 s38, s38, 0
    v_add_u32 v28, s38, v2
    v_subrev_u32 v28, s34, v28
    v_mul_u32_u24 v28, 144, v28
    v_lshl_add_u32 v104, v3, 3, v28
    s_add_u32 s38, s34, s35
    s_add_u32 s38, s38, 16
    v_add_u32 v28, s38, v2
    v_subrev_u32 v28, s34, v28
    v_mul_u32_u24 v28, 144, v28
    v_lshl_add_u32 v105, v3, 3, v28
    s_sub_u32 s38, s34, s35
    s_add_u32 s38, s38, 32
    v_add_u32 v28, s38, v2
    v_subrev_u32 v28, s34, v28
    v_mul_u32_u24 v28, 144, v28
    v_lshl_add_u32 v106, v3, 3, v28
    s_sub_u32 s38, s34, s35
    s_add_u32 s38, s38, 48
    v_add_u32 v28, s38, v2
    v_subrev_u32 v28, s34, v28
    v_mul_u32_u24 v28, 144, v28
    v_lshl_add_u32 v107, v3, 3, v28
    s_waitcnt vmcnt(0) lgkmcnt(0)
    s_mov_b32 s40, 0xbdd2d3e8
    s_mov_b32 s41, 0xbdd2d3e8
    v_mov_b32 v108, 0xc0135761
    v_mov_b32 v109, 0xc0135761
    v_mov_b32 v110, 1.0
    v_mov_b32 v111, 1.0
    s_lshl_b32 s34, s31, 1
    s_xor_b32 s34, s34, 0
    s_lshl_b32 s34, s34, 4
    s_lshl_b32 s35, s32, 6
    s_add_u32 s34, s34, s35
    s_add_u32 s34, s34, s29
    s_mul_i32 s57, s30, 9216
    s_lshl_b32 s56, s31, 1
    s_xor_b32 s56, s56, 0
    s_lshl_b32 s56, s56, 5
    s_add_u32 s56, s56, s57
    v_lshlrev_b32 v48, 16, v112
    v_and_b32 v49, 0xffff0000, v112
    v_lshlrev_b32 v50, 16, v113
    v_and_b32 v51, 0xffff0000, v113
    v_pk_fma_f32 v[128:129], v[64:65], v[96:97], v[128:129] op_sel_hi:[1,0,1] neg_lo:[0,1,0] neg_hi:[0,1,0]
    v_pk_fma_f32 v[130:131], v[66:67], v[96:97], v[130:131] op_sel_hi:[1,0,1] neg_lo:[0,1,0] neg_hi:[0,1,0]
    v_pk_fma_f32 v[144:145], v[64:65], v[98:99], v[144:145] op_sel_hi:[1,0,1] neg_lo:[0,1,0] neg_hi:[0,1,0]
    v_pk_fma_f32 v[146:147], v[66:67], v[98:99], v[146:147] op_sel_hi:[1,0,1] neg_lo:[0,1,0] neg_hi:[0,1,0]
    v_pk_fma_f32 v[160:161], v[64:65], v[100:101], v[160:161] op_sel_hi:[1,0,1] neg_lo:[0,1,0] neg_hi:[0,1,0]
    v_pk_fma_f32 v[162:163], v[66:67], v[100:101], v[162:163] op_sel_hi:[1,0,1] neg_lo:[0,1,0] neg_hi:[0,1,0]
    v_pk_fma_f32 v[176:177], v[64:65], v[102:103], v[176:177] op_sel_hi:[1,0,1] neg_lo:[0,1,0] neg_hi:[0,1,0]
    v_pk_fma_f32 v[178:179], v[66:67], v[102:103], v[178:179] op_sel_hi:[1,0,1] neg_lo:[0,1,0] neg_hi:[0,1,0]
    v_pk_fma_f32 v[128:129], v[128:129], v[96:97], v[48:49] op_sel:[0,1,0] op_sel_hi:[1,1,1]
    v_pk_fma_f32 v[130:131], v[130:131], v[96:97], v[50:51] op_sel:[0,1,0] op_sel_hi:[1,1,1]
    v_pk_fma_f32 v[144:145], v[144:145], v[98:99], v[48:49] op_sel:[0,1,0] op_sel_hi:[1,1,1]
    v_pk_fma_f32 v[146:147], v[146:147], v[98:99], v[50:51] op_sel:[0,1,0] op_sel_hi:[1,1,1]
    v_pk_fma_f32 v[160:161], v[160:161], v[100:101], v[48:49] op_sel:[0,1,0] op_sel_hi:[1,1,1]
    v_pk_fma_f32 v[162:163], v[162:163], v[100:101], v[50:51] op_sel:[0,1,0] op_sel_hi:[1,1,1]
    v_pk_fma_f32 v[176:177], v[176:177], v[102:103], v[48:49] op_sel:[0,1,0] op_sel_hi:[1,1,1]
    v_pk_fma_f32 v[178:179], v[178:179], v[102:103], v[50:51] op_sel:[0,1,0] op_sel_hi:[1,1,1]
    v_pk_mul_f32 v[32:33], v[128:129], v[128:129]
    v_pk_mul_f32 v[34:35], v[130:131], v[130:131]
    v_pk_mul_f32 v[36:37], v[144:145], v[144:145]
    v_pk_mul_f32 v[38:39], v[146:147], v[146:147]
    v_pk_mul_f32 v[40:41], v[160:161], v[160:161]
    v_pk_mul_f32 v[42:43], v[162:163], v[162:163]
    v_pk_mul_f32 v[44:45], v[176:177], v[176:177]
    v_pk_mul_f32 v[46:47], v[178:179], v[178:179]
    v_pk_fma_f32 v[32:33], v[32:33], s[40:41], v[108:109]
    v_pk_fma_f32 v[34:35], v[34:35], s[40:41], v[108:109]
    v_pk_fma_f32 v[36:37], v[36:37], s[40:41], v[108:109]
    v_pk_fma_f32 v[38:39], v[38:39], s[40:41], v[108:109]
    v_pk_fma_f32 v[40:41], v[40:41], s[40:41], v[108:109]
    v_pk_fma_f32 v[42:43], v[42:43], s[40:41], v[108:109]
    v_pk_fma_f32 v[44:45], v[44:45], s[40:41], v[108:109]
    v_pk_fma_f32 v[46:47], v[46:47], s[40:41], v[108:109]
    v_pk_mul_f32 v[32:33], v[32:33], v[128:129]
    v_pk_mul_f32 v[34:35], v[34:35], v[130:131]
    v_pk_mul_f32 v[36:37], v[36:37], v[144:145]
    v_pk_mul_f32 v[38:39], v[38:39], v[146:147]
    v_pk_mul_f32 v[40:41], v[40:41], v[160:161]
    v_pk_mul_f32 v[42:43], v[42:43], v[162:163]
    v_pk_mul_f32 v[44:45], v[44:45], v[176:177]
    v_pk_mul_f32 v[46:47], v[46:47], v[178:179]
    v_exp_f32 v32, v32
    v_exp_f32 v33, v33
    v_exp_f32 v34, v34
    v_exp_f32 v35, v35
    v_exp_f32 v36, v36
    v_exp_f32 v37, v37
    v_exp_f32 v38, v38
    v_exp_f32 v39, v39
    v_exp_f32 v40, v40
    v_exp_f32 v41, v41
    v_exp_f32 v42, v42
    v_exp_f32 v43, v43
    v_exp_f32 v44, v44
    v_exp_f32 v45, v45
    v_exp_f32 v46, v46
    v_exp_f32 v47, v47
    v_pk_add_f32 v[32:33], v[32:33], v[110:111]
    v_pk_add_f32 v[34:35], v[34:35], v[110:111]
    v_pk_add_f32 v[36:37], v[36:37], v[110:111]
    v_pk_add_f32 v[38:39], v[38:39], v[110:111]
    v_pk_add_f32 v[40:41], v[40:41], v[110:111]
    v_pk_add_f32 v[42:43], v[42:43], v[110:111]
    v_pk_add_f32 v[44:45], v[44:45], v[110:111]
    v_pk_add_f32 v[46:47], v[46:47], v[110:111]
    v_rcp_f32 v32, v32
    v_rcp_f32 v33, v33
    v_rcp_f32 v34, v34
    v_rcp_f32 v35, v35
    v_rcp_f32 v36, v36
    v_rcp_f32 v37, v37
    v_rcp_f32 v38, v38
    v_rcp_f32 v39, v39
    v_rcp_f32 v40, v40
    v_rcp_f32 v41, v41
    v_rcp_f32 v42, v42
    v_rcp_f32 v43, v43
    v_rcp_f32 v44, v44
    v_rcp_f32 v45, v45
    v_rcp_f32 v46, v46
    v_rcp_f32 v47, v47
    v_pk_mul_f32 v[128:129], v[128:129], v[32:33]
    v_pk_mul_f32 v[130:131], v[130:131], v[34:35]
    v_pk_mul_f32 v[144:145], v[144:145], v[36:37]
    v_pk_mul_f32 v[146:147], v[146:147], v[38:39]
    v_pk_mul_f32 v[160:161], v[160:161], v[40:41]
    v_pk_mul_f32 v[162:163], v[162:163], v[42:43]
    v_pk_mul_f32 v[176:177], v[176:177], v[44:45]
    v_pk_mul_f32 v[178:179], v[178:179], v[46:47]
    v_cvt_pk_bf16_f32 v52, v128, v129
    v_cvt_pk_bf16_f32 v53, v130, v131
    v_add_u32 v60, s56, v104
    v_cvt_pk_bf16_f32 v54, v144, v145
    v_cvt_pk_bf16_f32 v55, v146, v147
    v_add_u32 v61, s56, v105
    v_cvt_pk_bf16_f32 v56, v160, v161
    v_cvt_pk_bf16_f32 v57, v162, v163
    v_add_u32 v62, s56, v106
    v_cvt_pk_bf16_f32 v58, v176, v177
    v_cvt_pk_bf16_f32 v59, v178, v179
    v_add_u32 v63, s56, v107
    ds_write_b64 v60, v[52:53]
    ds_write_b64 v61, v[54:55]
    ds_write_b64 v62, v[56:57]
    ds_write_b64 v63, v[58:59]
    s_lshl_b32 s34, s31, 1
    s_xor_b32 s34, s34, 1
    s_lshl_b32 s34, s34, 4
    s_lshl_b32 s35, s32, 6
    s_add_u32 s34, s34, s35
    s_add_u32 s34, s34, s29
    s_mul_i32 s57, s30, 9216
    s_lshl_b32 s56, s31, 1
    s_xor_b32 s56, s56, 1
    s_lshl_b32 s56, s56, 5
    s_add_u32 s56, s56, s57
    v_lshlrev_b32 v48, 16, v114
    v_and_b32 v49, 0xffff0000, v114
    v_lshlrev_b32 v50, 16, v115
    v_and_b32 v51, 0xffff0000, v115
    v_pk_fma_f32 v[132:133], v[68:69], v[96:97], v[132:133] op_sel_hi:[1,0,1] neg_lo:[0,1,0] neg_hi:[0,1,0]
    v_pk_fma_f32 v[134:135], v[70:71], v[96:97], v[134:135] op_sel_hi:[1,0,1] neg_lo:[0,1,0] neg_hi:[0,1,0]
    v_pk_fma_f32 v[148:149], v[68:69], v[98:99], v[148:149] op_sel_hi:[1,0,1] neg_lo:[0,1,0] neg_hi:[0,1,0]
    v_pk_fma_f32 v[150:151], v[70:71], v[98:99], v[150:151] op_sel_hi:[1,0,1] neg_lo:[0,1,0] neg_hi:[0,1,0]
    v_pk_fma_f32 v[164:165], v[68:69], v[100:101], v[164:165] op_sel_hi:[1,0,1] neg_lo:[0,1,0] neg_hi:[0,1,0]
    v_pk_fma_f32 v[166:167], v[70:71], v[100:101], v[166:167] op_sel_hi:[1,0,1] neg_lo:[0,1,0] neg_hi:[0,1,0]
    v_pk_fma_f32 v[180:181], v[68:69], v[102:103], v[180:181] op_sel_hi:[1,0,1] neg_lo:[0,1,0] neg_hi:[0,1,0]
    v_pk_fma_f32 v[182:183], v[70:71], v[102:103], v[182:183] op_sel_hi:[1,0,1] neg_lo:[0,1,0] neg_hi:[0,1,0]
    v_pk_fma_f32 v[132:133], v[132:133], v[96:97], v[48:49] op_sel:[0,1,0] op_sel_hi:[1,1,1]
    v_pk_fma_f32 v[134:135], v[134:135], v[96:97], v[50:51] op_sel:[0,1,0] op_sel_hi:[1,1,1]
    v_pk_fma_f32 v[148:149], v[148:149], v[98:99], v[48:49] op_sel:[0,1,0] op_sel_hi:[1,1,1]
    v_pk_fma_f32 v[150:151], v[150:151], v[98:99], v[50:51] op_sel:[0,1,0] op_sel_hi:[1,1,1]
    v_pk_fma_f32 v[164:165], v[164:165], v[100:101], v[48:49] op_sel:[0,1,0] op_sel_hi:[1,1,1]
    v_pk_fma_f32 v[166:167], v[166:167], v[100:101], v[50:51] op_sel:[0,1,0] op_sel_hi:[1,1,1]
    v_pk_fma_f32 v[180:181], v[180:181], v[102:103], v[48:49] op_sel:[0,1,0] op_sel_hi:[1,1,1]
    v_pk_fma_f32 v[182:183], v[182:183], v[102:103], v[50:51] op_sel:[0,1,0] op_sel_hi:[1,1,1]
    v_pk_mul_f32 v[32:33], v[132:133], v[132:133]
    v_pk_mul_f32 v[34:35], v[134:135], v[134:135]
    v_pk_mul_f32 v[36:37], v[148:149], v[148:149]
    v_pk_mul_f32 v[38:39], v[150:151], v[150:151]
    v_pk_mul_f32 v[40:41], v[164:165], v[164:165]
    v_pk_mul_f32 v[42:43], v[166:167], v[166:167]
    v_pk_mul_f32 v[44:45], v[180:181], v[180:181]
    v_pk_mul_f32 v[46:47], v[182:183], v[182:183]
    v_pk_fma_f32 v[32:33], v[32:33], s[40:41], v[108:109]
    v_pk_fma_f32 v[34:35], v[34:35], s[40:41], v[108:109]
    v_pk_fma_f32 v[36:37], v[36:37], s[40:41], v[108:109]
    v_pk_fma_f32 v[38:39], v[38:39], s[40:41], v[108:109]
    v_pk_fma_f32 v[40:41], v[40:41], s[40:41], v[108:109]
    v_pk_fma_f32 v[42:43], v[42:43], s[40:41], v[108:109]
    v_pk_fma_f32 v[44:45], v[44:45], s[40:41], v[108:109]
    v_pk_fma_f32 v[46:47], v[46:47], s[40:41], v[108:109]
    v_pk_mul_f32 v[32:33], v[32:33], v[132:133]
    v_pk_mul_f32 v[34:35], v[34:35], v[134:135]
    v_pk_mul_f32 v[36:37], v[36:37], v[148:149]
    v_pk_mul_f32 v[38:39], v[38:39], v[150:151]
    v_pk_mul_f32 v[40:41], v[40:41], v[164:165]
    v_pk_mul_f32 v[42:43], v[42:43], v[166:167]
    v_pk_mul_f32 v[44:45], v[44:45], v[180:181]
    v_pk_mul_f32 v[46:47], v[46:47], v[182:183]
    v_exp_f32 v32, v32
    v_exp_f32 v33, v33
    v_exp_f32 v34, v34
    v_exp_f32 v35, v35
    v_exp_f32 v36, v36
    v_exp_f32 v37, v37
    v_exp_f32 v38, v38
    v_exp_f32 v39, v39
    v_exp_f32 v40, v40
    v_exp_f32 v41, v41
    v_exp_f32 v42, v42
    v_exp_f32 v43, v43
    v_exp_f32 v44, v44
    v_exp_f32 v45, v45
    v_exp_f32 v46, v46
    v_exp_f32 v47, v47
    v_pk_add_f32 v[32:33], v[32:33], v[110:111]
    v_pk_add_f32 v[34:35], v[34:35], v[110:111]
    v_pk_add_f32 v[36:37], v[36:37], v[110:111]
    v_pk_add_f32 v[38:39], v[38:39], v[110:111]
    v_pk_add_f32 v[40:41], v[40:41], v[110:111]
    v_pk_add_f32 v[42:43], v[42:43], v[110:111]
    v_pk_add_f32 v[44:45], v[44:45], v[110:111]
    v_pk_add_f32 v[46:47], v[46:47], v[110:111]
    v_rcp_f32 v32, v32
    v_rcp_f32 v33, v33
    v_rcp_f32 v34, v34
    v_rcp_f32 v35, v35
    v_rcp_f32 v36, v36
    v_rcp_f32 v37, v37
    v_rcp_f32 v38, v38
    v_rcp_f32 v39, v39
    v_rcp_f32 v40, v40
    v_rcp_f32 v41, v41
    v_rcp_f32 v42, v42
    v_rcp_f32 v43, v43
    v_rcp_f32 v44, v44
    v_rcp_f32 v45, v45
    v_rcp_f32 v46, v46
    v_rcp_f32 v47, v47
    v_pk_mul_f32 v[132:133], v[132:133], v[32:33]
    v_pk_mul_f32 v[134:135], v[134:135], v[34:35]
    v_pk_mul_f32 v[148:149], v[148:149], v[36:37]
    v_pk_mul_f32 v[150:151], v[150:151], v[38:39]
    v_pk_mul_f32 v[164:165], v[164:165], v[40:41]
    v_pk_mul_f32 v[166:167], v[166:167], v[42:43]
    v_pk_mul_f32 v[180:181], v[180:181], v[44:45]
    v_pk_mul_f32 v[182:183], v[182:183], v[46:47]
    v_cvt_pk_bf16_f32 v52, v132, v133
    v_cvt_pk_bf16_f32 v53, v134, v135
    v_add_u32 v60, s56, v104
    v_cvt_pk_bf16_f32 v54, v148, v149
    v_cvt_pk_bf16_f32 v55, v150, v151
    v_add_u32 v61, s56, v105
    v_cvt_pk_bf16_f32 v56, v164, v165
    v_cvt_pk_bf16_f32 v57, v166, v167
    v_add_u32 v62, s56, v106
    v_cvt_pk_bf16_f32 v58, v180, v181
    v_cvt_pk_bf16_f32 v59, v182, v183
    v_add_u32 v63, s56, v107
    ds_write_b64 v60, v[52:53]
    ds_write_b64 v61, v[54:55]
    ds_write_b64 v62, v[56:57]
    ds_write_b64 v63, v[58:59]
    s_lshl_b32 s34, s31, 1
    s_xor_b32 s34, s34, 2
    s_lshl_b32 s34, s34, 4
    s_lshl_b32 s35, s32, 6
    s_add_u32 s34, s34, s35
    s_add_u32 s34, s34, s29
    s_mul_i32 s57, s30, 9216
    s_lshl_b32 s56, s31, 1
    s_xor_b32 s56, s56, 2
    s_lshl_b32 s56, s56, 5
    s_add_u32 s56, s56, s57
    v_lshlrev_b32 v48, 16, v116
    v_and_b32 v49, 0xffff0000, v116
    v_lshlrev_b32 v50, 16, v117
    v_and_b32 v51, 0xffff0000, v117
    v_pk_fma_f32 v[136:137], v[72:73], v[96:97], v[136:137] op_sel_hi:[1,0,1] neg_lo:[0,1,0] neg_hi:[0,1,0]
    v_pk_fma_f32 v[138:139], v[74:75], v[96:97], v[138:139] op_sel_hi:[1,0,1] neg_lo:[0,1,0] neg_hi:[0,1,0]
    v_pk_fma_f32 v[152:153], v[72:73], v[98:99], v[152:153] op_sel_hi:[1,0,1] neg_lo:[0,1,0] neg_hi:[0,1,0]
    v_pk_fma_f32 v[154:155], v[74:75], v[98:99], v[154:155] op_sel_hi:[1,0,1] neg_lo:[0,1,0] neg_hi:[0,1,0]
    v_pk_fma_f32 v[168:169], v[72:73], v[100:101], v[168:169] op_sel_hi:[1,0,1] neg_lo:[0,1,0] neg_hi:[0,1,0]
    v_pk_fma_f32 v[170:171], v[74:75], v[100:101], v[170:171] op_sel_hi:[1,0,1] neg_lo:[0,1,0] neg_hi:[0,1,0]
    v_pk_fma_f32 v[184:185], v[72:73], v[102:103], v[184:185] op_sel_hi:[1,0,1] neg_lo:[0,1,0] neg_hi:[0,1,0]
    v_pk_fma_f32 v[186:187], v[74:75], v[102:103], v[186:187] op_sel_hi:[1,0,1] neg_lo:[0,1,0] neg_hi:[0,1,0]
    v_pk_fma_f32 v[136:137], v[136:137], v[96:97], v[48:49] op_sel:[0,1,0] op_sel_hi:[1,1,1]
    v_pk_fma_f32 v[138:139], v[138:139], v[96:97], v[50:51] op_sel:[0,1,0] op_sel_hi:[1,1,1]
    v_pk_fma_f32 v[152:153], v[152:153], v[98:99], v[48:49] op_sel:[0,1,0] op_sel_hi:[1,1,1]
    v_pk_fma_f32 v[154:155], v[154:155], v[98:99], v[50:51] op_sel:[0,1,0] op_sel_hi:[1,1,1]
    v_pk_fma_f32 v[168:169], v[168:169], v[100:101], v[48:49] op_sel:[0,1,0] op_sel_hi:[1,1,1]
    v_pk_fma_f32 v[170:171], v[170:171], v[100:101], v[50:51] op_sel:[0,1,0] op_sel_hi:[1,1,1]
    v_pk_fma_f32 v[184:185], v[184:185], v[102:103], v[48:49] op_sel:[0,1,0] op_sel_hi:[1,1,1]
    v_pk_fma_f32 v[186:187], v[186:187], v[102:103], v[50:51] op_sel:[0,1,0] op_sel_hi:[1,1,1]
    v_pk_mul_f32 v[32:33], v[136:137], v[136:137]
    v_pk_mul_f32 v[34:35], v[138:139], v[138:139]
    v_pk_mul_f32 v[36:37], v[152:153], v[152:153]
    v_pk_mul_f32 v[38:39], v[154:155], v[154:155]
    v_pk_mul_f32 v[40:41], v[168:169], v[168:169]
    v_pk_mul_f32 v[42:43], v[170:171], v[170:171]
    v_pk_mul_f32 v[44:45], v[184:185], v[184:185]
    v_pk_mul_f32 v[46:47], v[186:187], v[186:187]
    v_pk_fma_f32 v[32:33], v[32:33], s[40:41], v[108:109]
    v_pk_fma_f32 v[34:35], v[34:35], s[40:41], v[108:109]
    v_pk_fma_f32 v[36:37], v[36:37], s[40:41], v[108:109]
    v_pk_fma_f32 v[38:39], v[38:39], s[40:41], v[108:109]
    v_pk_fma_f32 v[40:41], v[40:41], s[40:41], v[108:109]
    v_pk_fma_f32 v[42:43], v[42:43], s[40:41], v[108:109]
    v_pk_fma_f32 v[44:45], v[44:45], s[40:41], v[108:109]
    v_pk_fma_f32 v[46:47], v[46:47], s[40:41], v[108:109]
    v_pk_mul_f32 v[32:33], v[32:33], v[136:137]
    v_pk_mul_f32 v[34:35], v[34:35], v[138:139]
    v_pk_mul_f32 v[36:37], v[36:37], v[152:153]
    v_pk_mul_f32 v[38:39], v[38:39], v[154:155]
    v_pk_mul_f32 v[40:41], v[40:41], v[168:169]
    v_pk_mul_f32 v[42:43], v[42:43], v[170:171]
    v_pk_mul_f32 v[44:45], v[44:45], v[184:185]
    v_pk_mul_f32 v[46:47], v[46:47], v[186:187]
    v_exp_f32 v32, v32
    v_exp_f32 v33, v33
    v_exp_f32 v34, v34
    v_exp_f32 v35, v35
    v_exp_f32 v36, v36
    v_exp_f32 v37, v37
    v_exp_f32 v38, v38
    v_exp_f32 v39, v39
    v_exp_f32 v40, v40
    v_exp_f32 v41, v41
    v_exp_f32 v42, v42
    v_exp_f32 v43, v43
    v_exp_f32 v44, v44
    v_exp_f32 v45, v45
    v_exp_f32 v46, v46
    v_exp_f32 v47, v47
    v_pk_add_f32 v[32:33], v[32:33], v[110:111]
    v_pk_add_f32 v[34:35], v[34:35], v[110:111]
    v_pk_add_f32 v[36:37], v[36:37], v[110:111]
    v_pk_add_f32 v[38:39], v[38:39], v[110:111]
    v_pk_add_f32 v[40:41], v[40:41], v[110:111]
    v_pk_add_f32 v[42:43], v[42:43], v[110:111]
    v_pk_add_f32 v[44:45], v[44:45], v[110:111]
    v_pk_add_f32 v[46:47], v[46:47], v[110:111]
    v_rcp_f32 v32, v32
    v_rcp_f32 v33, v33
    v_rcp_f32 v34, v34
    v_rcp_f32 v35, v35
    v_rcp_f32 v36, v36
    v_rcp_f32 v37, v37
    v_rcp_f32 v38, v38
    v_rcp_f32 v39, v39
    v_rcp_f32 v40, v40
    v_rcp_f32 v41, v41
    v_rcp_f32 v42, v42
    v_rcp_f32 v43, v43
    v_rcp_f32 v44, v44
    v_rcp_f32 v45, v45
    v_rcp_f32 v46, v46
    v_rcp_f32 v47, v47
    v_pk_mul_f32 v[136:137], v[136:137], v[32:33]
    v_pk_mul_f32 v[138:139], v[138:139], v[34:35]
    v_pk_mul_f32 v[152:153], v[152:153], v[36:37]
    v_pk_mul_f32 v[154:155], v[154:155], v[38:39]
    v_pk_mul_f32 v[168:169], v[168:169], v[40:41]
    v_pk_mul_f32 v[170:171], v[170:171], v[42:43]
    v_pk_mul_f32 v[184:185], v[184:185], v[44:45]
    v_pk_mul_f32 v[186:187], v[186:187], v[46:47]
    v_cvt_pk_bf16_f32 v52, v136, v137
    v_cvt_pk_bf16_f32 v53, v138, v139
    v_add_u32 v60, s56, v104
    v_cvt_pk_bf16_f32 v54, v152, v153
    v_cvt_pk_bf16_f32 v55, v154, v155
    v_add_u32 v61, s56, v105
    v_cvt_pk_bf16_f32 v56, v168, v169
    v_cvt_pk_bf16_f32 v57, v170, v171
    v_add_u32 v62, s56, v106
    v_cvt_pk_bf16_f32 v58, v184, v185
    v_cvt_pk_bf16_f32 v59, v186, v187
    v_add_u32 v63, s56, v107
    ds_write_b64 v60, v[52:53]
    ds_write_b64 v61, v[54:55]
    ds_write_b64 v62, v[56:57]
    ds_write_b64 v63, v[58:59]
    s_lshl_b32 s34, s31, 1
    s_xor_b32 s34, s34, 3
    s_lshl_b32 s34, s34, 4
    s_lshl_b32 s35, s32, 6
    s_add_u32 s34, s34, s35
    s_add_u32 s34, s34, s29
    s_mul_i32 s57, s30, 9216
    s_lshl_b32 s56, s31, 1
    s_xor_b32 s56, s56, 3
    s_lshl_b32 s56, s56, 5
    s_add_u32 s56, s56, s57
    v_lshlrev_b32 v48, 16, v118
    v_and_b32 v49, 0xffff0000, v118
    v_lshlrev_b32 v50, 16, v119
    v_and_b32 v51, 0xffff0000, v119
    v_pk_fma_f32 v[140:141], v[76:77], v[96:97], v[140:141] op_sel_hi:[1,0,1] neg_lo:[0,1,0] neg_hi:[0,1,0]
    v_pk_fma_f32 v[142:143], v[78:79], v[96:97], v[142:143] op_sel_hi:[1,0,1] neg_lo:[0,1,0] neg_hi:[0,1,0]
    v_pk_fma_f32 v[156:157], v[76:77], v[98:99], v[156:157] op_sel_hi:[1,0,1] neg_lo:[0,1,0] neg_hi:[0,1,0]
    v_pk_fma_f32 v[158:159], v[78:79], v[98:99], v[158:159] op_sel_hi:[1,0,1] neg_lo:[0,1,0] neg_hi:[0,1,0]
    v_pk_fma_f32 v[172:173], v[76:77], v[100:101], v[172:173] op_sel_hi:[1,0,1] neg_lo:[0,1,0] neg_hi:[0,1,0]
    v_pk_fma_f32 v[174:175], v[78:79], v[100:101], v[174:175] op_sel_hi:[1,0,1] neg_lo:[0,1,0] neg_hi:[0,1,0]
    v_pk_fma_f32 v[188:189], v[76:77], v[102:103], v[188:189] op_sel_hi:[1,0,1] neg_lo:[0,1,0] neg_hi:[0,1,0]
    v_pk_fma_f32 v[190:191], v[78:79], v[102:103], v[190:191] op_sel_hi:[1,0,1] neg_lo:[0,1,0] neg_hi:[0,1,0]
    v_pk_fma_f32 v[140:141], v[140:141], v[96:97], v[48:49] op_sel:[0,1,0] op_sel_hi:[1,1,1]
    v_pk_fma_f32 v[142:143], v[142:143], v[96:97], v[50:51] op_sel:[0,1,0] op_sel_hi:[1,1,1]
    v_pk_fma_f32 v[156:157], v[156:157], v[98:99], v[48:49] op_sel:[0,1,0] op_sel_hi:[1,1,1]
    v_pk_fma_f32 v[158:159], v[158:159], v[98:99], v[50:51] op_sel:[0,1,0] op_sel_hi:[1,1,1]
    v_pk_fma_f32 v[172:173], v[172:173], v[100:101], v[48:49] op_sel:[0,1,0] op_sel_hi:[1,1,1]
    v_pk_fma_f32 v[174:175], v[174:175], v[100:101], v[50:51] op_sel:[0,1,0] op_sel_hi:[1,1,1]
    v_pk_fma_f32 v[188:189], v[188:189], v[102:103], v[48:49] op_sel:[0,1,0] op_sel_hi:[1,1,1]
    v_pk_fma_f32 v[190:191], v[190:191], v[102:103], v[50:51] op_sel:[0,1,0] op_sel_hi:[1,1,1]
    v_pk_mul_f32 v[32:33], v[140:141], v[140:141]
    v_pk_mul_f32 v[34:35], v[142:143], v[142:143]
    v_pk_mul_f32 v[36:37], v[156:157], v[156:157]
    v_pk_mul_f32 v[38:39], v[158:159], v[158:159]
    v_pk_mul_f32 v[40:41], v[172:173], v[172:173]
    v_pk_mul_f32 v[42:43], v[174:175], v[174:175]
    v_pk_mul_f32 v[44:45], v[188:189], v[188:189]
    v_pk_mul_f32 v[46:47], v[190:191], v[190:191]
    v_pk_fma_f32 v[32:33], v[32:33], s[40:41], v[108:109]
    v_pk_fma_f32 v[34:35], v[34:35], s[40:41], v[108:109]
    v_pk_fma_f32 v[36:37], v[36:37], s[40:41], v[108:109]
    v_pk_fma_f32 v[38:39], v[38:39], s[40:41], v[108:109]
    v_pk_fma_f32 v[40:41], v[40:41], s[40:41], v[108:109]
    v_pk_fma_f32 v[42:43], v[42:43], s[40:41], v[108:109]
    v_pk_fma_f32 v[44:45], v[44:45], s[40:41], v[108:109]
    v_pk_fma_f32 v[46:47], v[46:47], s[40:41], v[108:109]
    v_pk_mul_f32 v[32:33], v[32:33], v[140:141]
    v_pk_mul_f32 v[34:35], v[34:35], v[142:143]
    v_pk_mul_f32 v[36:37], v[36:37], v[156:157]
    v_pk_mul_f32 v[38:39], v[38:39], v[158:159]
    v_pk_mul_f32 v[40:41], v[40:41], v[172:173]
    v_pk_mul_f32 v[42:43], v[42:43], v[174:175]
    v_pk_mul_f32 v[44:45], v[44:45], v[188:189]
    v_pk_mul_f32 v[46:47], v[46:47], v[190:191]
    v_exp_f32 v32, v32
    v_exp_f32 v33, v33
    v_exp_f32 v34, v34
    v_exp_f32 v35, v35
    v_exp_f32 v36, v36
    v_exp_f32 v37, v37
    v_exp_f32 v38, v38
    v_exp_f32 v39, v39
    v_exp_f32 v40, v40
    v_exp_f32 v41, v41
    v_exp_f32 v42, v42
    v_exp_f32 v43, v43
    v_exp_f32 v44, v44
    v_exp_f32 v45, v45
    v_exp_f32 v46, v46
    v_exp_f32 v47, v47
    v_pk_add_f32 v[32:33], v[32:33], v[110:111]
    v_pk_add_f32 v[34:35], v[34:35], v[110:111]
    v_pk_add_f32 v[36:37], v[36:37], v[110:111]
    v_pk_add_f32 v[38:39], v[38:39], v[110:111]
    v_pk_add_f32 v[40:41], v[40:41], v[110:111]
    v_pk_add_f32 v[42:43], v[42:43], v[110:111]
    v_pk_add_f32 v[44:45], v[44:45], v[110:111]
    v_pk_add_f32 v[46:47], v[46:47], v[110:111]
    v_rcp_f32 v32, v32
    v_rcp_f32 v33, v33
    v_rcp_f32 v34, v34
    v_rcp_f32 v35, v35
    v_rcp_f32 v36, v36
    v_rcp_f32 v37, v37
    v_rcp_f32 v38, v38
    v_rcp_f32 v39, v39
    v_rcp_f32 v40, v40
    v_rcp_f32 v41, v41
    v_rcp_f32 v42, v42
    v_rcp_f32 v43, v43
    v_rcp_f32 v44, v44
    v_rcp_f32 v45, v45
    v_rcp_f32 v46, v46
    v_rcp_f32 v47, v47
    v_pk_mul_f32 v[140:141], v[140:141], v[32:33]
    v_pk_mul_f32 v[142:143], v[142:143], v[34:35]
    v_pk_mul_f32 v[156:157], v[156:157], v[36:37]
    v_pk_mul_f32 v[158:159], v[158:159], v[38:39]
    v_pk_mul_f32 v[172:173], v[172:173], v[40:41]
    v_pk_mul_f32 v[174:175], v[174:175], v[42:43]
    v_pk_mul_f32 v[188:189], v[188:189], v[44:45]
    v_pk_mul_f32 v[190:191], v[190:191], v[46:47]
    v_cvt_pk_bf16_f32 v52, v140, v141
    v_cvt_pk_bf16_f32 v53, v142, v143
    v_add_u32 v60, s56, v104
    v_cvt_pk_bf16_f32 v54, v156, v157
    v_cvt_pk_bf16_f32 v55, v158, v159
    v_add_u32 v61, s56, v105
    v_cvt_pk_bf16_f32 v56, v172, v173
    v_cvt_pk_bf16_f32 v57, v174, v175
    v_add_u32 v62, s56, v106
    v_cvt_pk_bf16_f32 v58, v188, v189
    v_cvt_pk_bf16_f32 v59, v190, v191
    v_add_u32 v63, s56, v107
    ds_write_b64 v60, v[52:53]
    ds_write_b64 v61, v[54:55]
    ds_write_b64 v62, v[56:57]
    ds_write_b64 v63, v[58:59]
    v_lshrrev_b32 v28, 3, v1
    v_and_b32 v29, 7, v1
    v_mul_u32_u24 v30, 144, v28
    v_lshl_add_u32 v30, v29, 4, v30
    v_add_u32 v30, s57, v30
    s_lshl_b32 s34, s31, 6
    s_add_u32 s34, s34, s28
    v_add_u32 v28, s34, v28
    v_mul_u32_u24 v28, 0xe00, v28
    v_lshl_add_u32 v28, v29, 4, v28
    s_lshl_b32 s34, s29, 1
    s_lshl_b32 s35, s32, 7
    s_add_u32 s34, s34, s35
    s_waitcnt lgkmcnt(0)
    ds_read_b128 v[128:131], v30 offset:0
    ds_read_b128 v[132:135], v30 offset:1152
    ds_read_b128 v[136:139], v30 offset:2304
    ds_read_b128 v[140:143], v30 offset:3456
    ds_read_b128 v[144:147], v30 offset:4608
    ds_read_b128 v[148:151], v30 offset:5760
    ds_read_b128 v[152:155], v30 offset:6912
    ds_read_b128 v[156:159], v30 offset:8064
    s_waitcnt lgkmcnt(7)
    s_add_u32 s35, s34, 0
    buffer_store_dwordx4 v[128:131], v28, s[20:23], s35 offen sc1
    s_waitcnt lgkmcnt(6)
    s_add_u32 s35, s34, 28672
    buffer_store_dwordx4 v[132:135], v28, s[20:23], s35 offen sc1
    s_waitcnt lgkmcnt(5)
    s_add_u32 s35, s34, 57344
    buffer_store_dwordx4 v[136:139], v28, s[20:23], s35 offen sc1
    s_waitcnt lgkmcnt(4)
    s_add_u32 s35, s34, 86016
    buffer_store_dwordx4 v[140:143], v28, s[20:23], s35 offen sc1
    s_waitcnt lgkmcnt(3)
    s_add_u32 s35, s34, 114688
    buffer_store_dwordx4 v[144:147], v28, s[20:23], s35 offen sc1
    s_waitcnt lgkmcnt(2)
    s_add_u32 s35, s34, 143360
    buffer_store_dwordx4 v[148:151], v28, s[20:23], s35 offen sc1
    s_waitcnt lgkmcnt(1)
    s_add_u32 s35, s34, 172032
    buffer_store_dwordx4 v[152:155], v28, s[20:23], s35 offen sc1
    s_waitcnt lgkmcnt(0)
    s_add_u32 s35, s34, 200704
    buffer_store_dwordx4 v[156:159], v28, s[20:23], s35 offen sc1
L_ffn1_kernel_end:
    s_endpgm
.p2align 8
.globl ffn2a_kernel
.type ffn2a_kernel,@function
ffn2a_kernel:
    s_cmp_ge_u32 s2, 256
    s_cbranch_scc1 L_ffn2a_kernel_end
    s_load_dwordx2 s[6:7], s[0:1], 48
    s_load_dwordx2 s[8:9], s[0:1], 80
    s_load_dwordx2 s[10:11], s[0:1], 56
    v_and_b32 v1, 63, v0
    v_and_b32 v2, 15, v0
    v_bfe_u32 v3, v0, 4, 2
    v_lshrrev_b32 v28, 6, v0
    s_nop 0
    v_readfirstlane_b32 s30, v28
    s_and_b32 s34, s2, 7
    s_lshr_b32 s35, s2, 3
    s_lshr_b32 s55, s30, 2
    s_and_b32 s30, s30, 3
    s_lshr_b32 s36, s35, 3
    s_lshl_b32 s34, s34, 2
    s_add_u32 s34, s34, s36
    s_and_b32 s35, s35, 7
    s_lshl_b32 s28, s34, 6
    s_lshl_b32 s29, s35, 6
    s_lshr_b32 s31, s30, 1
    s_and_b32 s32, s30, 1
    s_waitcnt lgkmcnt(0)
    s_add_u32 s12, s8, 0xa00000
    s_addc_u32 s13, s9, 0
    s_and_b32 s13, s13, 0xffff
    s_mov_b32 s14, 0x700000
    s_mov_b32 s15, 0x20000
    s_mov_b32 s16, s6
    s_and_b32 s17, s7, 0xffff
    s_mov_b32 s18, 0x1c0000
    s_mov_b32 s19, 0x20000
    s_add_u32 s20, s8, 0x1200000
    s_addc_u32 s21, s9, 0
    s_and_b32 s21, s21, 0xffff
    s_mov_b32 s22, 0x200000
    s_mov_b32 s23, 0x20000
    s_add_u32 s24, s8, 0x800000
    s_addc_u32 s25, s9, 0
    s_and_b32 s25, s25, 0xffff
    s_mov_b32 s26, 0x200000
    s_mov_b32 s27, 0x20000
    s_mov_b32 s44, s10
    s_and_b32 s45, s11, 0xffff
    s_mov_b32 s46, 0x400
    s_mov_b32 s47, 0x20000
    v_xor_b32 v29, v2, v3
    v_mul_u32_u24 v28, 0xe00, v3
    v_xor_b32 v30, 0, v29
    v_lshl_add_u32 v4, v30, 4, v28
    v_xor_b32 v30, 4, v29
    v_lshl_add_u32 v5, v30, 4, v28
    v_xor_b32 v30, 8, v29
    v_lshl_add_u32 v6, v30, 4, v28
    v_xor_b32 v30, 12, v29
    v_lshl_add_u32 v7, v30, 4, v28
    v_lshrrev_b32 v28, 3, v1
    v_bfe_u32 v29, v1, 4, 1
    v_bfe_u32 v30, v1, 1, 2
    v_xor_b32 v30, v30, v29
    v_and_b32 v31, 1, v1
    v_lshl_add_u32 v31, v30, 1, v31
    v_mul_u32_u24 v28, 0x400, v28
    v_lshl_add_u32 v8, v31, 4, v28
    v_xor_b32 v31, 4, v31
    v_lshl_add_u32 v9, v31, 4, v28
    s_mul_i32 s33, s30, 16
    s_add_u32 s34, s28, s33
    s_mul_i32 s50, s34, 3584
    s_mul_i32 s51, s33, 256
    s_mul_i32 s33, s30, 32
    s_mul_i32 s52, s33, 1024
    s_lshl_b32 s34, s29, 1
    s_add_u32 s52, s52, s34
    s_mul_i32 s53, s33, 128
    s_add_u32 s53, s53, 16384
    s_cmp_eq_u32 s55, 0
    s_cbranch_scc1 L_ffn2a_kernel_comp
    s_setprio 3
    s_add_u32 s34, s50, 0x0
    s_add_u32 m0, s51, 0x0
    s_nop 0
    buffer_load_dwordx4 v4, s[12:15], s34 offen lds
    s_add_u32 s34, s50, 0x3800
    s_add_u32 m0, s51, 0x400
    s_nop 0
    buffer_load_dwordx4 v5, s[12:15], s34 offen lds
    s_add_u32 s34, s50, 0x7000
    s_add_u32 m0, s51, 0x800
    s_nop 0
    buffer_load_dwordx4 v6, s[12:15], s34 offen lds
    s_add_u32 s34, s50, 0xa800
    s_add_u32 m0, s51, 0xc00
    s_nop 0
    buffer_load_dwordx4 v7, s[12:15], s34 offen lds
    s_add_u32 s34, s52, 0x0
    s_add_u32 m0, s53, 0x0
    s_nop 0
    buffer_load_dwordx4 v8, s[16:19], s34 offen lds
    s_add_u32 s34, s52, 0x2000
    s_add_u32 m0, s53, 0x400
    s_nop 0
    buffer_load_dwordx4 v9, s[16:19], s34 offen lds
    s_add_u32 s34, s52, 0x4000
    s_add_u32 m0, s53, 0x800
    s_nop 0
    buffer_load_dwordx4 v8, s[16:19], s34 offen lds
    s_add_u32 s34, s52, 0x6000
    s_add_u32 m0, s53, 0xc00
    s_nop 0
    buffer_load_dwordx4 v9, s[16:19], s34 offen lds
    s_add_u32 s34, s50, 0x100
    s_add_u32 m0, s51, 0x8000
    s_nop 0
    buffer_load_dwordx4 v4, s[12:15], s34 offen lds
    s_add_u32 s34, s50, 0x3900
    s_add_u32 m0, s51, 0x8400
    s_nop 0
    buffer_load_dwordx4 v5, s[12:15], s34 offen lds
    s_add_u32 s34, s50, 0x7100
    s_add_u32 m0, s51, 0x8800
    s_nop 0
    buffer_load_dwordx4 v6, s[12:15], s34 offen lds
    s_add_u32 s34, s50, 0xa900
    s_add_u32 m0, s51, 0x8c00
    s_nop 0
    buffer_load_dwordx4 v7, s[12:15], s34 offen lds
    s_add_u32 s34, s52, 0x20000
    s_add_u32 m0, s53, 0x8000
    s_nop 0
    buffer_load_dwordx4 v8, s[16:19], s34 offen lds
    s_add_u32 s34, s52, 0x22000
    s_add_u32 m0, s53, 0x8400
    s_nop 0
    buffer_load_dwordx4 v9, s[16:19], s34 offen lds
    s_add_u32 s34, s52, 0x24000
    s_add_u32 m0, s53, 0x8800
    s_nop 0
    buffer_load_dwordx4 v8, s[16:19], s34 offen lds
    s_add_u32 s34, s52, 0x26000
    s_add_u32 m0, s53, 0x8c00
    s_nop 0
    buffer_load_dwordx4 v9, s[16:19], s34 offen lds
    s_waitcnt vmcnt(8)
    s_barrier
    s_add_u32 s34, s50, 0x200
    s_add_u32 m0, s51, 0x10000
    s_nop 0
    buffer_load_dwordx4 v4, s[12:15], s34 offen lds
    s_add_u32 s34, s50, 0x3a00
    s_add_u32 m0, s51, 0x10400
    s_nop 0
    buffer_load_dwordx4 v5, s[12:15], s34 offen lds
    s_add_u32 s34, s50, 0x7200
    s_add_u32 m0, s51, 0x10800
    s_nop 0
    buffer_load_dwordx4 v6, s[12:15], s34 offen lds
    s_add_u32 s34, s50, 0xaa00
    s_add_u32 m0, s51, 0x10c00
    s_nop 0
    buffer_load_dwordx4 v7, s[12:15], s34 offen lds
    s_add_u32 s34, s52, 0x40000
    s_add_u32 m0, s53, 0x10000
    s_nop 0
    buffer_load_dwordx4 v8, s[16:19], s34 offen lds
    s_add_u32 s34, s52, 0x42000
    s_add_u32 m0, s53, 0x10400
    s_nop 0
    buffer_load_dwordx4 v9, s[16:19], s34 offen lds
    s_add_u32 s34, s52, 0x44000
    s_add_u32 m0, s53, 0x10800
    s_nop 0
    buffer_load_dwordx4 v8, s[16:19], s34 offen lds
    s_add_u32 s34, s52, 0x46000
    s_add_u32 m0, s53, 0x10c00
    s_nop 0
    buffer_load_dwordx4 v9, s[16:19], s34 offen lds
    s_add_u32 s34, s50, 0x300
    s_add_u32 m0, s51, 0x18000
    s_nop 0
    buffer_load_dwordx4 v4, s[12:15], s34 offen lds
    s_add_u32 s34, s50, 0x3b00
    s_add_u32 m0, s51, 0x18400
    s_nop 0
    buffer_load_dwordx4 v5, s[12:15], s34 offen lds
    s_add_u32 s34, s50, 0x7300
    s_add_u32 m0, s51, 0x18800
    s_nop 0
    buffer_load_dwordx4 v6, s[12:15], s34 offen lds
    s_add_u32 s34, s50, 0xab00
    s_add_u32 m0, s51, 0x18c00
    s_nop 0
    buffer_load_dwordx4 v7, s[12:15], s34 offen lds
    s_add_u32 s34, s52, 0x60000
    s_add_u32 m0, s53, 0x18000
    s_nop 0
    buffer_load_dwordx4 v8, s[16:19], s34 offen lds
    s_add_u32 s34, s52, 0x62000
    s_add_u32 m0, s53, 0x18400
    s_nop 0
    buffer_load_dwordx4 v9, s[16:19], s34 offen lds
    s_add_u32 s34, s52, 0x64000
    s_add_u32 m0, s53, 0x18800
    s_nop 0
    buffer_load_dwordx4 v8, s[16:19], s34 offen lds
    s_add_u32 s34, s52, 0x66000
    s_add_u32 m0, s53, 0x18c00
    s_nop 0
    buffer_load_dwordx4 v9, s[16:19], s34 offen lds
    s_waitcnt vmcnt(16)
    s_barrier
    s_add_u32 s34, s50, 0x400
    s_add_u32 m0, s51, 0x0
    s_nop 0
    buffer_load_dwordx4 v4, s[12:15], s34 offen lds
    s_add_u32 s34, s50, 0x3c00
    s_add_u32 m0, s51, 0x400
    s_nop 0
    buffer_load_dwordx4 v5, s[12:15], s34 offen lds
    s_add_u32 s34, s50, 0x7400
    s_add_u32 m0, s51, 0x800
    s_nop 0
    buffer_load_dwordx4 v6, s[12:15], s34 offen lds
    s_add_u32 s34, s50, 0xac00
    s_add_u32 m0, s51, 0xc00
    s_nop 0
    buffer_load_dwordx4 v7, s[12:15], s34 offen lds
    s_add_u32 s34, s52, 0x80000
    s_add_u32 m0, s53, 0x0
    s_nop 0
    buffer_load_dwordx4 v8, s[16:19], s34 offen lds
    s_add_u32 s34, s52, 0x82000
    s_add_u32 m0, s53, 0x400
    s_nop 0
    buffer_load_dwordx4 v9, s[16:19], s34 offen lds
    s_add_u32 s34, s52, 0x84000
    s_add_u32 m0, s53, 0x800
    s_nop 0
    buffer_load_dwordx4 v8, s[16:19], s34 offen lds
    s_add_u32 s34, s52, 0x86000
    s_add_u32 m0, s53, 0xc00
    s_nop 0
    buffer_load_dwordx4 v9, s[16:19], s34 offen lds
    s_waitcnt vmcnt(16)
    s_barrier
    s_add_u32 s34, s50, 0x500
    s_add_u32 m0, s51, 0x8000
    s_nop 0
    buffer_load_dwordx4 v4, s[12:15], s34 offen lds
    s_add_u32 s34, s50, 0x3d00
    s_add_u32 m0, s51, 0x8400
    s_nop 0
    buffer_load_dwordx4 v5, s[12:15], s34 offen lds
    s_add_u32 s34, s50, 0x7500
    s_add_u32 m0, s51, 0x8800
    s_nop 0
    buffer_load_dwordx4 v6, s[12:15], s34 offen lds
    s_add_u32 s34, s50, 0xad00
    s_add_u32 m0, s51, 0x8c00
    s_nop 0
    buffer_load_dwordx4 v7, s[12:15], s34 offen lds
    s_add_u32 s34, s52, 0xa0000
    s_add_u32 m0, s53, 0x8000
    s_nop 0
    buffer_load_dwordx4 v8, s[16:19], s34 offen lds
    s_add_u32 s34, s52, 0xa2000
    s_add_u32 m0, s53, 0x8400
    s_nop 0
    buffer_load_dwordx4 v9, s[16:19], s34 offen lds
    s_add_u32 s34, s52, 0xa4000
    s_add_u32 m0, s53, 0x8800
    s_nop 0
    buffer_load_dwordx4 v8, s[16:19], s34 offen lds
    s_add_u32 s34, s52, 0xa6000
    s_add_u32 m0, s53, 0x8c00
    s_nop 0
    buffer_load_dwordx4 v9, s[16:19], s34 offen lds
    s_waitcnt vmcnt(16)
    s_barrier
    s_add_u32 s34, s50, 0x600
    s_add_u32 m0, s51, 0x10000
    s_nop 0
    buffer_load_dwordx4 v4, s[12:15], s34 offen lds
    s_add_u32 s34, s50, 0x3e00
    s_add_u32 m0, s51, 0x10400
    s_nop 0
    buffer_load_dwordx4 v5, s[12:15], s34 offen lds
    s_add_u32 s34, s50, 0x7600
    s_add_u32 m0, s51, 0x10800
    s_nop 0
    buffer_load_dwordx4 v6, s[12:15], s34 offen lds
    s_add_u32 s34, s50, 0xae00
    s_add_u32 m0, s51, 0x10c00
    s_nop 0
    buffer_load_dwordx4 v7, s[12:15], s34 offen lds
    s_add_u32 s34, s52, 0xc0000
    s_add_u32 m0, s53, 0x10000
    s_nop 0
    buffer_load_dwordx4 v8, s[16:19], s34 offen lds
    s_add_u32 s34, s52, 0xc2000
    s_add_u32 m0, s53, 0x10400
    s_nop 0
    buffer_load_dwordx4 v9, s[16:19], s34 offen lds
    s_add_u32 s34, s52, 0xc4000
    s_add_u32 m0, s53, 0x10800
    s_nop 0
    buffer_load_dwordx4 v8, s[16:19], s34 offen lds
    s_add_u32 s34, s52, 0xc6000
    s_add_u32 m0, s53, 0x10c00
    s_nop 0
    buffer_load_dwordx4 v9, s[16:19], s34 offen lds
    s_waitcnt vmcnt(16)
    s_barrier
    s_add_u32 s34, s50, 0x700
    s_add_u32 m0, s51, 0x18000
    s_nop 0
    buffer_load_dwordx4 v4, s[12:15], s34 offen lds
    s_add_u32 s34, s50, 0x3f00
    s_add_u32 m0, s51, 0x18400
    s_nop 0
    buffer_load_dwordx4 v5, s[12:15], s34 offen lds
    s_add_u32 s34, s50, 0x7700
    s_add_u32 m0, s51, 0x18800
    s_nop 0
    buffer_load_dwordx4 v6, s[12:15], s34 offen lds
    s_add_u32 s34, s50, 0xaf00
    s_add_u32 m0, s51, 0x18c00
    s_nop 0
    buffer_load_dwordx4 v7, s[12:15], s34 offen lds
    s_add_u32 s34, s52, 0xe0000
    s_add_u32 m0, s53, 0x18000
    s_nop 0
    buffer_load_dwordx4 v8, s[16:19], s34 offen lds
    s_add_u32 s34, s52, 0xe2000
    s_add_u32 m0, s53, 0x18400
    s_nop 0
    buffer_load_dwordx4 v9, s[16:19], s34 offen lds
    s_add_u32 s34, s52, 0xe4000
    s_add_u32 m0, s53, 0x18800
    s_nop 0
    buffer_load_dwordx4 v8, s[16:19], s34 offen lds
    s_add_u32 s34, s52, 0xe6000
    s_add_u32 m0, s53, 0x18c00
    s_nop 0
    buffer_load_dwordx4 v9, s[16:19], s34 offen lds
    s_waitcnt vmcnt(16)
    s_barrier
    s_add_u32 s34, s50, 0x800
    s_add_u32 m0, s51, 0x0
    s_nop 0
    buffer_load_dwordx4 v4, s[12:15], s34 offen lds
    s_add_u32 s34, s50, 0x4000
    s_add_u32 m0, s51, 0x400
    s_nop 0
    buffer_load_dwordx4 v5, s[12:15], s34 offen lds
    s_add_u32 s34, s50, 0x7800
    s_add_u32 m0, s51, 0x800
    s_nop 0
    buffer_load_dwordx4 v6, s[12:15], s34 offen lds
    s_add_u32 s34, s50, 0xb000
    s_add_u32 m0, s51, 0xc00
    s_nop 0
    buffer_load_dwordx4 v7, s[12:15], s34 offen lds
    s_add_u32 s34, s52, 0x100000
    s_add_u32 m0, s53, 0x0
    s_nop 0
    buffer_load_dwordx4 v8, s[16:19], s34 offen lds
    s_add_u32 s34, s52, 0x102000
    s_add_u32 m0, s53, 0x400
    s_nop 0
    buffer_load_dwordx4 v9, s[16:19], s34 offen lds
    s_add_u32 s34, s52, 0x104000
    s_add_u32 m0, s53, 0x800
    s_nop 0
    buffer_load_dwordx4 v8, s[16:19], s34 offen lds
    s_add_u32 s34, s52, 0x106000
    s_add_u32 m0, s53, 0xc00
    s_nop 0
    buffer_load_dwordx4 v9, s[16:19], s34 offen lds
    s_waitcnt vmcnt(16)
    s_barrier
    s_add_u32 s34, s50, 0x900
    s_add_u32 m0, s51, 0x8000
    s_nop 0
    buffer_load_dwordx4 v4, s[12:15], s34 offen lds
    s_add_u32 s34, s50, 0x4100
    s_add_u32 m0, s51, 0x8400
    s_nop 0
    buffer_load_dwordx4 v5, s[12:15], s34 offen lds
    s_add_u32 s34, s50, 0x7900
    s_add_u32 m0, s51, 0x8800
    s_nop 0
    buffer_load_dwordx4 v6, s[12:15], s34 offen lds
    s_add_u32 s34, s50, 0xb100
    s_add_u32 m0, s51, 0x8c00
    s_nop 0
    buffer_load_dwordx4 v7, s[12:15], s34 offen lds
    s_add_u32 s34, s52, 0x120000
    s_add_u32 m0, s53, 0x8000
    s_nop 0
    buffer_load_dwordx4 v8, s[16:19], s34 offen lds
    s_add_u32 s34, s52, 0x122000
    s_add_u32 m0, s53, 0x8400
    s_nop 0
    buffer_load_dwordx4 v9, s[16:19], s34 offen lds
    s_add_u32 s34, s52, 0x124000
    s_add_u32 m0, s53, 0x8800
    s_nop 0
    buffer_load_dwordx4 v8, s[16:19], s34 offen lds
    s_add_u32 s34, s52, 0x126000
    s_add_u32 m0, s53, 0x8c00
    s_nop 0
    buffer_load_dwordx4 v9, s[16:19], s34 offen lds
    s_waitcnt vmcnt(16)
    s_barrier
    s_add_u32 s34, s50, 0xa00
    s_add_u32 m0, s51, 0x10000
    s_nop 0
    buffer_load_dwordx4 v4, s[12:15], s34 offen lds
    s_add_u32 s34, s50, 0x4200
    s_add_u32 m0, s51, 0x10400
    s_nop 0
    buffer_load_dwordx4 v5, s[12:15], s34 offen lds
    s_add_u32 s34, s50, 0x7a00
    s_add_u32 m0, s51, 0x10800
    s_nop 0
    buffer_load_dwordx4 v6, s[12:15], s34 offen lds
    s_add_u32 s34, s50, 0xb200
    s_add_u32 m0, s51, 0x10c00
    s_nop 0
    buffer_load_dwordx4 v7, s[12:15], s34 offen lds
    s_add_u32 s34, s52, 0x140000
    s_add_u32 m0, s53, 0x10000
    s_nop 0
    buffer_load_dwordx4 v8, s[16:19], s34 offen lds
    s_add_u32 s34, s52, 0x142000
    s_add_u32 m0, s53, 0x10400
    s_nop 0
    buffer_load_dwordx4 v9, s[16:19], s34 offen lds
    s_add_u32 s34, s52, 0x144000
    s_add_u32 m0, s53, 0x10800
    s_nop 0
    buffer_load_dwordx4 v8, s[16:19], s34 offen lds
    s_add_u32 s34, s52, 0x146000
    s_add_u32 m0, s53, 0x10c00
    s_nop 0
    buffer_load_dwordx4 v9, s[16:19], s34 offen lds
    s_waitcnt vmcnt(16)
    s_barrier
    s_add_u32 s34, s50, 0xb00
    s_add_u32 m0, s51, 0x18000
    s_nop 0
    buffer_load_dwordx4 v4, s[12:15], s34 offen lds
    s_add_u32 s34, s50, 0x4300
    s_add_u32 m0, s51, 0x18400
    s_nop 0
    buffer_load_dwordx4 v5, s[12:15], s34 offen lds
    s_add_u32 s34, s50, 0x7b00
    s_add_u32 m0, s51, 0x18800
    s_nop 0
    buffer_load_dwordx4 v6, s[12:15], s34 offen lds
    s_add_u32 s34, s50, 0xb300
    s_add_u32 m0, s51, 0x18c00
    s_nop 0
    buffer_load_dwordx4 v7, s[12:15], s34 offen lds
    s_add_u32 s34, s52, 0x160000
    s_add_u32 m0, s53, 0x18000
    s_nop 0
    buffer_load_dwordx4 v8, s[16:19], s34 offen lds
    s_add_u32 s34, s52, 0x162000
    s_add_u32 m0, s53, 0x18400
    s_nop 0
    buffer_load_dwordx4 v9, s[16:19], s34 offen lds
    s_add_u32 s34, s52, 0x164000
    s_add_u32 m0, s53, 0x18800
    s_nop 0
    buffer_load_dwordx4 v8, s[16:19], s34 offen lds
    s_add_u32 s34, s52, 0x166000
    s_add_u32 m0, s53, 0x18c00
    s_nop 0
    buffer_load_dwordx4 v9, s[16:19], s34 offen lds
    s_waitcnt vmcnt(16)
    s_barrier
    s_add_u32 s34, s50, 0xc00
    s_add_u32 m0, s51, 0x0
    s_nop 0
    buffer_load_dwordx4 v4, s[12:15], s34 offen lds
    s_add_u32 s34, s50, 0x4400
    s_add_u32 m0, s51, 0x400
    s_nop 0
    buffer_load_dwordx4 v5, s[12:15], s34 offen lds
    s_add_u32 s34, s50, 0x7c00
    s_add_u32 m0, s51, 0x800
    s_nop 0
    buffer_load_dwordx4 v6, s[12:15], s34 offen lds
    s_add_u32 s34, s50, 0xb400
    s_add_u32 m0, s51, 0xc00
    s_nop 0
    buffer_load_dwordx4 v7, s[12:15], s34 offen lds
    s_add_u32 s34, s52, 0x180000
    s_add_u32 m0, s53, 0x0
    s_nop 0
    buffer_load_dwordx4 v8, s[16:19], s34 offen lds
    s_add_u32 s34, s52, 0x182000
    s_add_u32 m0, s53, 0x400
    s_nop 0
    buffer_load_dwordx4 v9, s[16:19], s34 offen lds
    s_add_u32 s34, s52, 0x184000
    s_add_u32 m0, s53, 0x800
    s_nop 0
    buffer_load_dwordx4 v8, s[16:19], s34 offen lds
    s_add_u32 s34, s52, 0x186000
    s_add_u32 m0, s53, 0xc00
    s_nop 0
    buffer_load_dwordx4 v9, s[16:19], s34 offen lds
    s_waitcnt vmcnt(16)
    s_barrier
    s_add_u32 s34, s50, 0xd00
    s_add_u32 m0, s51, 0x8000
    s_nop 0
    buffer_load_dwordx4 v4, s[12:15], s34 offen lds
    s_add_u32 s34, s50, 0x4500
    s_add_u32 m0, s51, 0x8400
    s_nop 0
    buffer_load_dwordx4 v5, s[12:15], s34 offen lds
    s_add_u32 s34, s50, 0x7d00
    s_add_u32 m0, s51, 0x8800
    s_nop 0
    buffer_load_dwordx4 v6, s[12:15], s34 offen lds
    s_add_u32 s34, s50, 0xb500
    s_add_u32 m0, s51, 0x8c00
    s_nop 0
    buffer_load_dwordx4 v7, s[12:15], s34 offen lds
    s_add_u32 s34, s52, 0x1a0000
    s_add_u32 m0, s53, 0x8000
    s_nop 0
    buffer_load_dwordx4 v8, s[16:19], s34 offen lds
    s_add_u32 s34, s52, 0x1a2000
    s_add_u32 m0, s53, 0x8400
    s_nop 0
    buffer_load_dwordx4 v9, s[16:19], s34 offen lds
    s_add_u32 s34, s52, 0x1a4000
    s_add_u32 m0, s53, 0x8800
    s_nop 0
    buffer_load_dwordx4 v8, s[16:19], s34 offen lds
    s_add_u32 s34, s52, 0x1a6000
    s_add_u32 m0, s53, 0x8c00
    s_nop 0
    buffer_load_dwordx4 v9, s[16:19], s34 offen lds
    s_waitcnt vmcnt(16)
    s_barrier
    s_waitcnt vmcnt(8)
    s_barrier
    s_waitcnt vmcnt(0)
    s_barrier
    s_endpgm
L_ffn2a_kernel_comp:
    s_lshl_b32 s34, s31, 5
    s_add_u32 s34, s34, s28
    v_add_u32 v12, s34, v2
    v_lshlrev_b32 v12, 10, v12
    v_lshl_add_u32 v12, v3, 3, v12
    s_lshl_b32 s54, s29, 1
    s_lshl_b32 s34, s32, 6
    s_add_u32 s54, s54, s34
    v_add_u32 v13, 0x4000, v12
    buffer_load_dwordx2 v[96:97], v12, s[24:27], s54 offen offset:0
    buffer_load_dwordx2 v[98:99], v12, s[24:27], s54 offen offset:32
    buffer_load_dwordx2 v[100:101], v13, s[24:27], s54 offen offset:0
    buffer_load_dwordx2 v[102:103], v13, s[24:27], s54 offen offset:32
    v_lshlrev_b32 v28, 3, v3
    buffer_load_dwordx2 v[112:113], v28, s[44:47], s54 offen offset:0
    buffer_load_dwordx2 v[114:115], v28, s[44:47], s54 offen offset:32
    s_mul_i32 s34, s31, 32
    v_add_u32 v28, s34, v2
    v_lshlrev_b32 v28, 8, v28
    v_xor_b32 v29, v2, v3
    v_xor_b32 v30, 0, v29
    v_lshl_add_u32 v30, v30, 4, v28
    v_mov_b32 v14, v30
    v_xor_b32 v30, 4, v29
    v_lshl_add_u32 v30, v30, 4, v28
    v_mov_b32 v15, v30
    v_xor_b32 v30, 8, v29
    v_lshl_add_u32 v30, v30, 4, v28
    v_mov_b32 v16, v30
    v_xor_b32 v30, 12, v29
    v_lshl_add_u32 v30, v30, 4, v28
    v_mov_b32 v17, v30
    v_bfe_u32 v28, v0, 2, 2
    v_lshl_add_u32 v29, v3, 3, v28
    v_lshlrev_b32 v29, 7, v29
    v_and_b32 v30, 3, v0
    v_lshl_add_u32 v29, v30, 3, v29
    v_add_u32 v29, 16384, v29
    v_and_b32 v30, 1, v3
    v_lshrrev_b32 v28, 1, v28
    v_lshl_add_u32 v28, v30, 1, v28
    s_mul_i32 s34, s32, 2
    s_add_u32 s34, s34, 0
    v_xor_b32 v30, s34, v28
    v_lshl_add_u32 v22, v30, 5, v29
    s_mul_i32 s34, s32, 2
    s_add_u32 s34, s34, 1
    v_xor_b32 v30, s34, v28
    v_lshl_add_u32 v23, v30, 5, v29
    s_barrier
    ds_read_b128 v[32:35], v14 offset:0
    ds_read_b128 v[36:39], v14 offset:4096
    ds_read_b64_tr_b16 v[64:65], v22 offset:0
    ds_read_b64_tr_b16 v[66:67], v22 offset:512
    ds_read_b64_tr_b16 v[68:69], v23 offset:0
    ds_read_b64_tr_b16 v[70:71], v23 offset:512
    s_waitcnt lgkmcnt(0)
    v_mfma_f32_16x16x32_bf16 v[128:131], v[64:67], v[32:35], 0
    ds_read_b128 v[48:51], v15 offset:0
    ds_read_b128 v[52:55], v15 offset:4096
    v_mfma_f32_16x16x32_bf16 v[136:139], v[64:67], v[36:39], 0
    ds_read_b64_tr_b16 v[80:81], v22 offset:4096
    ds_read_b64_tr_b16 v[82:83], v22 offset:4608
    v_mfma_f32_16x16x32_bf16 v[132:135], v[68:71], v[32:35], 0
    ds_read_b64_tr_b16 v[84:85], v23 offset:4096
    ds_read_b64_tr_b16 v[86:87], v23 offset:4608
    v_mfma_f32_16x16x32_bf16 v[140:143], v[68:71], v[36:39], 0
    s_waitcnt lgkmcnt(0)
    v_mfma_f32_16x16x32_bf16 v[128:131], v[80:83], v[48:51], v[128:131]
    ds_read_b128 v[32:35], v16 offset:0
    ds_read_b128 v[36:39], v16 offset:4096
    v_mfma_f32_16x16x32_bf16 v[136:139], v[80:83], v[52:55], v[136:139]
    ds_read_b64_tr_b16 v[64:65], v22 offset:8192
    ds_read_b64_tr_b16 v[66:67], v22 offset:8704
    v_mfma_f32_16x16x32_bf16 v[132:135], v[84:87], v[48:51], v[132:135]
    ds_read_b64_tr_b16 v[68:69], v23 offset:8192
    ds_read_b64_tr_b16 v[70:71], v23 offset:8704
    v_mfma_f32_16x16x32_bf16 v[140:143], v[84:87], v[52:55], v[140:143]
    s_waitcnt lgkmcnt(0)
    v_mfma_f32_16x16x32_bf16 v[128:131], v[64:67], v[32:35], v[128:131]
    ds_read_b128 v[48:51], v17 offset:0
    ds_read_b128 v[52:55], v17 offset:4096
    v_mfma_f32_16x16x32_bf16 v[136:139], v[64:67], v[36:39], v[136:139]
    ds_read_b64_tr_b16 v[80:81], v22 offset:12288
    ds_read_b64_tr_b16 v[82:83], v22 offset:12800
    v_mfma_f32_16x16x32_bf16 v[132:135], v[68:71], v[32:35], v[132:135]
    ds_read_b64_tr_b16 v[84:85], v23 offset:12288
    ds_read_b64_tr_b16 v[86:87], v23 offset:12800
    v_mfma_f32_16x16x32_bf16 v[140:143], v[68:71], v[36:39], v[140:143]
    s_waitcnt lgkmcnt(0)
    s_barrier
    v_mfma_f32_16x16x32_bf16 v[128:131], v[80:83], v[48:51], v[128:131]
    ds_read_b128 v[32:35], v14 offset:32768
    ds_read_b128 v[36:39], v14 offset:36864
    v_mfma_f32_16x16x32_bf16 v[136:139], v[80:83], v[52:55], v[136:139]
    ds_read_b64_tr_b16 v[64:65], v22 offset:32768
    ds_read_b64_tr_b16 v[66:67], v22 offset:33280
    v_mfma_f32_16x16x32_bf16 v[132:135], v[84:87], v[48:51], v[132:135]
    ds_read_b64_tr_b16 v[68:69], v23 offset:32768
    ds_read_b64_tr_b16 v[70:71], v23 offset:33280
    v_mfma_f32_16x16x32_bf16 v[140:143], v[84:87], v[52:55], v[140:143]
    s_waitcnt lgkmcnt(0)
    v_mfma_f32_16x16x32_bf16 v[128:131], v[64:67], v[32:35], v[128:131]
    ds_read_b128 v[48:51], v15 offset:32768
    ds_read_b128 v[52:55], v15 offset:36864
    v_mfma_f32_16x16x32_bf16 v[136:139], v[64:67], v[36:39], v[136:139]
    ds_read_b64_tr_b16 v[80:81], v22 offset:36864
    ds_read_b64_tr_b16 v[82:83], v22 offset:37376
    v_mfma_f32_16x16x32_bf16 v[132:135], v[68:71], v[32:35], v[132:135]
    ds_read_b64_tr_b16 v[84:85], v23 offset:36864
    ds_read_b64_tr_b16 v[86:87], v23 offset:37376
    v_mfma_f32_16x16x32_bf16 v[140:143], v[68:71], v[36:39], v[140:143]
    s_waitcnt lgkmcnt(0)
    v_mfma_f32_16x16x32_bf16 v[128:131], v[80:83], v[48:51], v[128:131]
    ds_read_b128 v[32:35], v16 offset:32768
    ds_read_b128 v[36:39], v16 offset:36864
    v_mfma_f32_16x16x32_bf16 v[136:139], v[80:83], v[52:55], v[136:139]
    ds_read_b64_tr_b16 v[64:65], v22 offset:40960
    ds_read_b64_tr_b16 v[66:67], v22 offset:41472
    v_mfma_f32_16x16x32_bf16 v[132:135], v[84:87], v[48:51], v[132:135]
    ds_read_b64_tr_b16 v[68:69], v23 offset:40960
    ds_read_b64_tr_b16 v[70:71], v23 offset:41472
    v_mfma_f32_16x16x32_bf16 v[140:143], v[84:87], v[52:55], v[140:143]
    s_waitcnt lgkmcnt(0)
    v_mfma_f32_16x16x32_bf16 v[128:131], v[64:67], v[32:35], v[128:131]
    ds_read_b128 v[48:51], v17 offset:32768
    ds_read_b128 v[52:55], v17 offset:36864
    v_mfma_f32_16x16x32_bf16 v[136:139], v[64:67], v[36:39], v[136:139]
    ds_read_b64_tr_b16 v[80:81], v22 offset:45056
    ds_read_b64_tr_b16 v[82:83], v22 offset:45568
    v_mfma_f32_16x16x32_bf16 v[132:135], v[68:71], v[32:35], v[132:135]
    ds_read_b64_tr_b16 v[84:85], v23 offset:45056
    ds_read_b64_tr_b16 v[86:87], v23 offset:45568
    v_mfma_f32_16x16x32_bf16 v[140:143], v[68:71], v[36:39], v[140:143]
    s_waitcnt lgkmcnt(0)
    s_barrier
    v_mfma_f32_16x16x32_bf16 v[128:131], v[80:83], v[48:51], v[128:131]
    v_add_u32 v14, 0x10000, v14
    v_add_u32 v15, 0x10000, v15
    v_add_u32 v16, 0x10000, v16
    v_add_u32 v17, 0x10000, v17
    v_mfma_f32_16x16x32_bf16 v[136:139], v[80:83], v[52:55], v[136:139]
    v_add_u32 v22, 0x10000, v22
    v_add_u32 v23, 0x10000, v23
    ds_read_b128 v[32:35], v14 offset:0
    ds_read_b128 v[36:39], v14 offset:4096
    v_mfma_f32_16x16x32_bf16 v[132:135], v[84:87], v[48:51], v[132:135]
    ds_read_b64_tr_b16 v[64:65], v22 offset:0
    ds_read_b64_tr_b16 v[66:67], v22 offset:512
    ds_read_b64_tr_b16 v[68:69], v23 offset:0
    ds_read_b64_tr_b16 v[70:71], v23 offset:512
    v_mfma_f32_16x16x32_bf16 v[140:143], v[84:87], v[52:55], v[140:143]
    s_waitcnt lgkmcnt(0)
    v_mfma_f32_16x16x32_bf16 v[128:131], v[64:67], v[32:35], v[128:131]
    ds_read_b128 v[48:51], v15 offset:0
    ds_read_b128 v[52:55], v15 offset:4096
    v_mfma_f32_16x16x32_bf16 v[136:139], v[64:67], v[36:39], v[136:139]
    ds_read_b64_tr_b16 v[80:81], v22 offset:4096
    ds_read_b64_tr_b16 v[82:83], v22 offset:4608
    v_mfma_f32_16x16x32_bf16 v[132:135], v[68:71], v[32:35], v[132:135]
    ds_read_b64_tr_b16 v[84:85], v23 offset:4096
    ds_read_b64_tr_b16 v[86:87], v23 offset:4608
    v_mfma_f32_16x16x32_bf16 v[140:143], v[68:71], v[36:39], v[140:143]
    s_waitcnt lgkmcnt(0)
    v_mfma_f32_16x16x32_bf16 v[128:131], v[80:83], v[48:51], v[128:131]
    ds_read_b128 v[32:35], v16 offset:0
    ds_read_b128 v[36:39], v16 offset:4096
    v_mfma_f32_16x16x32_bf16 v[136:139], v[80:83], v[52:55], v[136:139]
    ds_read_b64_tr_b16 v[64:65], v22 offset:8192
    ds_read_b64_tr_b16 v[66:67], v22 offset:8704
    v_mfma_f32_16x16x32_bf16 v[132:135], v[84:87], v[48:51], v[132:135]
    ds_read_b64_tr_b16 v[68:69], v23 offset:8192
    ds_read_b64_tr_b16 v[70:71], v23 offset:8704
    v_mfma_f32_16x16x32_bf16 v[140:143], v[84:87], v[52:55], v[140:143]
    s_waitcnt lgkmcnt(0)
    v_mfma_f32_16x16x32_bf16 v[128:131], v[64:67], v[32:35], v[128:131]
    ds_read_b128 v[48:51], v17 offset:0
    ds_read_b128 v[52:55], v17 offset:4096
    v_mfma_f32_16x16x32_bf16 v[136:139], v[64:67], v[36:39], v[136:139]
    ds_read_b64_tr_b16 v[80:81], v22 offset:12288
    ds_read_b64_tr_b16 v[82:83], v22 offset:12800
    v_mfma_f32_16x16x32_bf16 v[132:135], v[68:71], v[32:35], v[132:135]
    ds_read_b64_tr_b16 v[84:85], v23 offset:12288
    ds_read_b64_tr_b16 v[86:87], v23 offset:12800
    v_mfma_f32_16x16x32_bf16 v[140:143], v[68:71], v[36:39], v[140:143]
    s_waitcnt lgkmcnt(0)
    s_barrier
    v_mfma_f32_16x16x32_bf16 v[128:131], v[80:83], v[48:51], v[128:131]
    ds_read_b128 v[32:35], v14 offset:32768
    ds_read_b128 v[36:39], v14 offset:36864
    v_mfma_f32_16x16x32_bf16 v[136:139], v[80:83], v[52:55], v[136:139]
    ds_read_b64_tr_b16 v[64:65], v22 offset:32768
    ds_read_b64_tr_b16 v[66:67], v22 offset:33280
    v_mfma_f32_16x16x32_bf16 v[132:135], v[84:87], v[48:51], v[132:135]
    ds_read_b64_tr_b16 v[68:69], v23 offset:32768
    ds_read_b64_tr_b16 v[70:71], v23 offset:33280
    v_mfma_f32_16x16x32_bf16 v[140:143], v[84:87], v[52:55], v[140:143]
    s_waitcnt lgkmcnt(0)
    v_mfma_f32_16x16x32_bf16 v[128:131], v[64:67], v[32:35], v[128:131]
    ds_read_b128 v[48:51], v15 offset:32768
    ds_read_b128 v[52:55], v15 offset:36864
    v_mfma_f32_16x16x32_bf16 v[136:139], v[64:67], v[36:39], v[136:139]
    ds_read_b64_tr_b16 v[80:81], v22 offset:36864
    ds_read_b64_tr_b16 v[82:83], v22 offset:37376
    v_mfma_f32_16x16x32_bf16 v[132:135], v[68:71], v[32:35], v[132:135]
    ds_read_b64_tr_b16 v[84:85], v23 offset:36864
    ds_read_b64_tr_b16 v[86:87], v23 offset:37376
    v_mfma_f32_16x16x32_bf16 v[140:143], v[68:71], v[36:39], v[140:143]
    s_waitcnt lgkmcnt(0)
    v_mfma_f32_16x16x32_bf16 v[128:131], v[80:83], v[48:51], v[128:131]
    ds_read_b128 v[32:35], v16 offset:32768
    ds_read_b128 v[36:39], v16 offset:36864
    v_mfma_f32_16x16x32_bf16 v[136:139], v[80:83], v[52:55], v[136:139]
    ds_read_b64_tr_b16 v[64:65], v22 offset:40960
    ds_read_b64_tr_b16 v[66:67], v22 offset:41472
    v_mfma_f32_16x16x32_bf16 v[132:135], v[84:87], v[48:51], v[132:135]
    ds_read_b64_tr_b16 v[68:69], v23 offset:40960
    ds_read_b64_tr_b16 v[70:71], v23 offset:41472
    v_mfma_f32_16x16x32_bf16 v[140:143], v[84:87], v[52:55], v[140:143]
    s_waitcnt lgkmcnt(0)
    v_mfma_f32_16x16x32_bf16 v[128:131], v[64:67], v[32:35], v[128:131]
    ds_read_b128 v[48:51], v17 offset:32768
    ds_read_b128 v[52:55], v17 offset:36864
    v_mfma_f32_16x16x32_bf16 v[136:139], v[64:67], v[36:39], v[136:139]
    ds_read_b64_tr_b16 v[80:81], v22 offset:45056
    ds_read_b64_tr_b16 v[82:83], v22 offset:45568
    v_mfma_f32_16x16x32_bf16 v[132:135], v[68:71], v[32:35], v[132:135]
    ds_read_b64_tr_b16 v[84:85], v23 offset:45056
    ds_read_b64_tr_b16 v[86:87], v23 offset:45568
    v_mfma_f32_16x16x32_bf16 v[140:143], v[68:71], v[36:39], v[140:143]
    s_waitcnt lgkmcnt(0)
    s_barrier
    v_mfma_f32_16x16x32_bf16 v[128:131], v[80:83], v[48:51], v[128:131]
    v_add_u32 v14, 0xffff0000, v14
    v_add_u32 v15, 0xffff0000, v15
    v_add_u32 v16, 0xffff0000, v16
    v_add_u32 v17, 0xffff0000, v17
    v_mfma_f32_16x16x32_bf16 v[136:139], v[80:83], v[52:55], v[136:139]
    v_add_u32 v22, 0xffff0000, v22
    v_add_u32 v23, 0xffff0000, v23
    ds_read_b128 v[32:35], v14 offset:0
    ds_read_b128 v[36:39], v14 offset:4096
    v_mfma_f32_16x16x32_bf16 v[132:135], v[84:87], v[48:51], v[132:135]
    ds_read_b64_tr_b16 v[64:65], v22 offset:0
    ds_read_b64_tr_b16 v[66:67], v22 offset:512
    ds_read_b64_tr_b16 v[68:69], v23 offset:0
    ds_read_b64_tr_b16 v[70:71], v23 offset:512
    v_mfma_f32_16x16x32_bf16 v[140:143], v[84:87], v[52:55], v[140:143]
    s_waitcnt lgkmcnt(0)
    v_mfma_f32_16x16x32_bf16 v[128:131], v[64:67], v[32:35], v[128:131]
    ds_read_b128 v[48:51], v15 offset:0
    ds_read_b128 v[52:55], v15 offset:4096
    v_mfma_f32_16x16x32_bf16 v[136:139], v[64:67], v[36:39], v[136:139]
    ds_read_b64_tr_b16 v[80:81], v22 offset:4096
    ds_read_b64_tr_b16 v[82:83], v22 offset:4608
    v_mfma_f32_16x16x32_bf16 v[132:135], v[68:71], v[32:35], v[132:135]
    ds_read_b64_tr_b16 v[84:85], v23 offset:4096
    ds_read_b64_tr_b16 v[86:87], v23 offset:4608
    v_mfma_f32_16x16x32_bf16 v[140:143], v[68:71], v[36:39], v[140:143]
    s_waitcnt lgkmcnt(0)
    v_mfma_f32_16x16x32_bf16 v[128:131], v[80:83], v[48:51], v[128:131]
    ds_read_b128 v[32:35], v16 offset:0
    ds_read_b128 v[36:39], v16 offset:4096
    v_mfma_f32_16x16x32_bf16 v[136:139], v[80:83], v[52:55], v[136:139]
    ds_read_b64_tr_b16 v[64:65], v22 offset:8192
    ds_read_b64_tr_b16 v[66:67], v22 offset:8704
    v_mfma_f32_16x16x32_bf16 v[132:135], v[84:87], v[48:51], v[132:135]
    ds_read_b64_tr_b16 v[68:69], v23 offset:8192
    ds_read_b64_tr_b16 v[70:71], v23 offset:8704
    v_mfma_f32_16x16x32_bf16 v[140:143], v[84:87], v[52:55], v[140:143]
    s_waitcnt lgkmcnt(0)
    v_mfma_f32_16x16x32_bf16 v[128:131], v[64:67], v[32:35], v[128:131]
    ds_read_b128 v[48:51], v17 offset:0
    ds_read_b128 v[52:55], v17 offset:4096
    v_mfma_f32_16x16x32_bf16 v[136:139], v[64:67], v[36:39], v[136:139]
    ds_read_b64_tr_b16 v[80:81], v22 offset:12288
    ds_read_b64_tr_b16 v[82:83], v22 offset:12800
    v_mfma_f32_16x16x32_bf16 v[132:135], v[68:71], v[32:35], v[132:135]
    ds_read_b64_tr_b16 v[84:85], v23 offset:12288
    ds_read_b64_tr_b16 v[86:87], v23 offset:12800
    v_mfma_f32_16x16x32_bf16 v[140:143], v[68:71], v[36:39], v[140:143]
    s_waitcnt lgkmcnt(0)
    s_barrier
    v_mfma_f32_16x16x32_bf16 v[128:131], v[80:83], v[48:51], v[128:131]
    ds_read_b128 v[32:35], v14 offset:32768
    ds_read_b128 v[36:39], v14 offset:36864
    v_mfma_f32_16x16x32_bf16 v[136:139], v[80:83], v[52:55], v[136:139]
    ds_read_b64_tr_b16 v[64:65], v22 offset:32768
    ds_read_b64_tr_b16 v[66:67], v22 offset:33280
    v_mfma_f32_16x16x32_bf16 v[132:135], v[84:87], v[48:51], v[132:135]
    ds_read_b64_tr_b16 v[68:69], v23 offset:32768
    ds_read_b64_tr_b16 v[70:71], v23 offset:33280
    v_mfma_f32_16x16x32_bf16 v[140:143], v[84:87], v[52:55], v[140:143]
    s_waitcnt lgkmcnt(0)
    v_mfma_f32_16x16x32_bf16 v[128:131], v[64:67], v[32:35], v[128:131]
    ds_read_b128 v[48:51], v15 offset:32768
    ds_read_b128 v[52:55], v15 offset:36864
    v_mfma_f32_16x16x32_bf16 v[136:139], v[64:67], v[36:39], v[136:139]
    ds_read_b64_tr_b16 v[80:81], v22 offset:36864
    ds_read_b64_tr_b16 v[82:83], v22 offset:37376
    v_mfma_f32_16x16x32_bf16 v[132:135], v[68:71], v[32:35], v[132:135]
    ds_read_b64_tr_b16 v[84:85], v23 offset:36864
    ds_read_b64_tr_b16 v[86:87], v23 offset:37376
    v_mfma_f32_16x16x32_bf16 v[140:143], v[68:71], v[36:39], v[140:143]
    s_waitcnt lgkmcnt(0)
    v_mfma_f32_16x16x32_bf16 v[128:131], v[80:83], v[48:51], v[128:131]
    ds_read_b128 v[32:35], v16 offset:32768
    ds_read_b128 v[36:39], v16 offset:36864
    v_mfma_f32_16x16x32_bf16 v[136:139], v[80:83], v[52:55], v[136:139]
    ds_read_b64_tr_b16 v[64:65], v22 offset:40960
    ds_read_b64_tr_b16 v[66:67], v22 offset:41472
    v_mfma_f32_16x16x32_bf16 v[132:135], v[84:87], v[48:51], v[132:135]
    ds_read_b64_tr_b16 v[68:69], v23 offset:40960
    ds_read_b64_tr_b16 v[70:71], v23 offset:41472
    v_mfma_f32_16x16x32_bf16 v[140:143], v[84:87], v[52:55], v[140:143]
    s_waitcnt lgkmcnt(0)
    v_mfma_f32_16x16x32_bf16 v[128:131], v[64:67], v[32:35], v[128:131]
    ds_read_b128 v[48:51], v17 offset:32768
    ds_read_b128 v[52:55], v17 offset:36864
    v_mfma_f32_16x16x32_bf16 v[136:139], v[64:67], v[36:39], v[136:139]
    ds_read_b64_tr_b16 v[80:81], v22 offset:45056
    ds_read_b64_tr_b16 v[82:83], v22 offset:45568
    v_mfma_f32_16x16x32_bf16 v[132:135], v[68:71], v[32:35], v[132:135]
    ds_read_b64_tr_b16 v[84:85], v23 offset:45056
    ds_read_b64_tr_b16 v[86:87], v23 offset:45568
    v_mfma_f32_16x16x32_bf16 v[140:143], v[68:71], v[36:39], v[140:143]
    s_waitcnt lgkmcnt(0)
    s_barrier
    v_mfma_f32_16x16x32_bf16 v[128:131], v[80:83], v[48:51], v[128:131]
    v_add_u32 v14, 0x10000, v14
    v_add_u32 v15, 0x10000, v15
    v_add_u32 v16, 0x10000, v16
    v_add_u32 v17, 0x10000, v17
    v_mfma_f32_16x16x32_bf16 v[136:139], v[80:83], v[52:55], v[136:139]
    v_add_u32 v22, 0x10000, v22
    v_add_u32 v23, 0x10000, v23
    ds_read_b128 v[32:35], v14 offset:0
    ds_read_b128 v[36:39], v14 offset:4096
    v_mfma_f32_16x16x32_bf16 v[132:135], v[84:87], v[48:51], v[132:135]
    ds_read_b64_tr_b16 v[64:65], v22 offset:0
    ds_read_b64_tr_b16 v[66:67], v22 offset:512
    ds_read_b64_tr_b16 v[68:69], v23 offset:0
    ds_read_b64_tr_b16 v[70:71], v23 offset:512
    v_mfma_f32_16x16x32_bf16 v[140:143], v[84:87], v[52:55], v[140:143]
    s_waitcnt lgkmcnt(0)
    v_mfma_f32_16x16x32_bf16 v[128:131], v[64:67], v[32:35], v[128:131]
    ds_read_b128 v[48:51], v15 offset:0
    ds_read_b128 v[52:55], v15 offset:4096
    v_mfma_f32_16x16x32_bf16 v[136:139], v[64:67], v[36:39], v[136:139]
    ds_read_b64_tr_b16 v[80:81], v22 offset:4096
    ds_read_b64_tr_b16 v[82:83], v22 offset:4608
    v_mfma_f32_16x16x32_bf16 v[132:135], v[68:71], v[32:35], v[132:135]
    ds_read_b64_tr_b16 v[84:85], v23 offset:4096
    ds_read_b64_tr_b16 v[86:87], v23 offset:4608
    v_mfma_f32_16x16x32_bf16 v[140:143], v[68:71], v[36:39], v[140:143]
    s_waitcnt lgkmcnt(0)
    v_mfma_f32_16x16x32_bf16 v[128:131], v[80:83], v[48:51], v[128:131]
    ds_read_b128 v[32:35], v16 offset:0
    ds_read_b128 v[36:39], v16 offset:4096
    v_mfma_f32_16x16x32_bf16 v[136:139], v[80:83], v[52:55], v[136:139]
    ds_read_b64_tr_b16 v[64:65], v22 offset:8192
    ds_read_b64_tr_b16 v[66:67], v22 offset:8704
    v_mfma_f32_16x16x32_bf16 v[132:135], v[84:87], v[48:51], v[132:135]
    ds_read_b64_tr_b16 v[68:69], v23 offset:8192
    ds_read_b64_tr_b16 v[70:71], v23 offset:8704
    v_mfma_f32_16x16x32_bf16 v[140:143], v[84:87], v[52:55], v[140:143]
    s_waitcnt lgkmcnt(0)
    v_mfma_f32_16x16x32_bf16 v[128:131], v[64:67], v[32:35], v[128:131]
    ds_read_b128 v[48:51], v17 offset:0
    ds_read_b128 v[52:55], v17 offset:4096
    v_mfma_f32_16x16x32_bf16 v[136:139], v[64:67], v[36:39], v[136:139]
    ds_read_b64_tr_b16 v[80:81], v22 offset:12288
    ds_read_b64_tr_b16 v[82:83], v22 offset:12800
    v_mfma_f32_16x16x32_bf16 v[132:135], v[68:71], v[32:35], v[132:135]
    ds_read_b64_tr_b16 v[84:85], v23 offset:12288
    ds_read_b64_tr_b16 v[86:87], v23 offset:12800
    v_mfma_f32_16x16x32_bf16 v[140:143], v[68:71], v[36:39], v[140:143]
    s_waitcnt lgkmcnt(0)
    s_barrier
    v_mfma_f32_16x16x32_bf16 v[128:131], v[80:83], v[48:51], v[128:131]
    ds_read_b128 v[32:35], v14 offset:32768
    ds_read_b128 v[36:39], v14 offset:36864
    v_mfma_f32_16x16x32_bf16 v[136:139], v[80:83], v[52:55], v[136:139]
    ds_read_b64_tr_b16 v[64:65], v22 offset:32768
    ds_read_b64_tr_b16 v[66:67], v22 offset:33280
    v_mfma_f32_16x16x32_bf16 v[132:135], v[84:87], v[48:51], v[132:135]
    ds_read_b64_tr_b16 v[68:69], v23 offset:32768
    ds_read_b64_tr_b16 v[70:71], v23 offset:33280
    v_mfma_f32_16x16x32_bf16 v[140:143], v[84:87], v[52:55], v[140:143]
    s_waitcnt lgkmcnt(0)
    v_mfma_f32_16x16x32_bf16 v[128:131], v[64:67], v[32:35], v[128:131]
    ds_read_b128 v[48:51], v15 offset:32768
    ds_read_b128 v[52:55], v15 offset:36864
    v_mfma_f32_16x16x32_bf16 v[136:139], v[64:67], v[36:39], v[136:139]
    ds_read_b64_tr_b16 v[80:81], v22 offset:36864
    ds_read_b64_tr_b16 v[82:83], v22 offset:37376
    v_mfma_f32_16x16x32_bf16 v[132:135], v[68:71], v[32:35], v[132:135]
    ds_read_b64_tr_b16 v[84:85], v23 offset:36864
    ds_read_b64_tr_b16 v[86:87], v23 offset:37376
    v_mfma_f32_16x16x32_bf16 v[140:143], v[68:71], v[36:39], v[140:143]
    s_waitcnt lgkmcnt(0)
    v_mfma_f32_16x16x32_bf16 v[128:131], v[80:83], v[48:51], v[128:131]
    ds_read_b128 v[32:35], v16 offset:32768
    ds_read_b128 v[36:39], v16 offset:36864
    v_mfma_f32_16x16x32_bf16 v[136:139], v[80:83], v[52:55], v[136:139]
    ds_read_b64_tr_b16 v[64:65], v22 offset:40960
    ds_read_b64_tr_b16 v[66:67], v22 offset:41472
    v_mfma_f32_16x16x32_bf16 v[132:135], v[84:87], v[48:51], v[132:135]
    ds_read_b64_tr_b16 v[68:69], v23 offset:40960
    ds_read_b64_tr_b16 v[70:71], v23 offset:41472
    v_mfma_f32_16x16x32_bf16 v[140:143], v[84:87], v[52:55], v[140:143]
    s_waitcnt lgkmcnt(0)
    v_mfma_f32_16x16x32_bf16 v[128:131], v[64:67], v[32:35], v[128:131]
    ds_read_b128 v[48:51], v17 offset:32768
    ds_read_b128 v[52:55], v17 offset:36864
    v_mfma_f32_16x16x32_bf16 v[136:139], v[64:67], v[36:39], v[136:139]
    ds_read_b64_tr_b16 v[80:81], v22 offset:45056
    ds_read_b64_tr_b16 v[82:83], v22 offset:45568
    v_mfma_f32_16x16x32_bf16 v[132:135], v[68:71], v[32:35], v[132:135]
    ds_read_b64_tr_b16 v[84:85], v23 offset:45056
    ds_read_b64_tr_b16 v[86:87], v23 offset:45568
    v_mfma_f32_16x16x32_bf16 v[140:143], v[68:71], v[36:39], v[140:143]
    s_waitcnt lgkmcnt(0)
    s_barrier
    v_mfma_f32_16x16x32_bf16 v[128:131], v[80:83], v[48:51], v[128:131]
    v_add_u32 v14, 0xffff0000, v14
    v_add_u32 v15, 0xffff0000, v15
    v_add_u32 v16, 0xffff0000, v16
    v_add_u32 v17, 0xffff0000, v17
    v_mfma_f32_16x16x32_bf16 v[136:139], v[80:83], v[52:55], v[136:139]
    v_add_u32 v22, 0xffff0000, v22
    v_add_u32 v23, 0xffff0000, v23
    ds_read_b128 v[32:35], v14 offset:0
    ds_read_b128 v[36:39], v14 offset:4096
    v_mfma_f32_16x16x32_bf16 v[132:135], v[84:87], v[48:51], v[132:135]
    ds_read_b64_tr_b16 v[64:65], v22 offset:0
    ds_read_b64_tr_b16 v[66:67], v22 offset:512
    ds_read_b64_tr_b16 v[68:69], v23 offset:0
    ds_read_b64_tr_b16 v[70:71], v23 offset:512
    v_mfma_f32_16x16x32_bf16 v[140:143], v[84:87], v[52:55], v[140:143]
    s_waitcnt lgkmcnt(0)
    v_mfma_f32_16x16x32_bf16 v[128:131], v[64:67], v[32:35], v[128:131]
    ds_read_b128 v[48:51], v15 offset:0
    ds_read_b128 v[52:55], v15 offset:4096
    v_mfma_f32_16x16x32_bf16 v[136:139], v[64:67], v[36:39], v[136:139]
    ds_read_b64_tr_b16 v[80:81], v22 offset:4096
    ds_read_b64_tr_b16 v[82:83], v22 offset:4608
    v_mfma_f32_16x16x32_bf16 v[132:135], v[68:71], v[32:35], v[132:135]
    ds_read_b64_tr_b16 v[84:85], v23 offset:4096
    ds_read_b64_tr_b16 v[86:87], v23 offset:4608
    v_mfma_f32_16x16x32_bf16 v[140:143], v[68:71], v[36:39], v[140:143]
    s_waitcnt lgkmcnt(0)
    v_mfma_f32_16x16x32_bf16 v[128:131], v[80:83], v[48:51], v[128:131]
    ds_read_b128 v[32:35], v16 offset:0
    ds_read_b128 v[36:39], v16 offset:4096
    v_mfma_f32_16x16x32_bf16 v[136:139], v[80:83], v[52:55], v[136:139]
    ds_read_b64_tr_b16 v[64:65], v22 offset:8192
    ds_read_b64_tr_b16 v[66:67], v22 offset:8704
    v_mfma_f32_16x16x32_bf16 v[132:135], v[84:87], v[48:51], v[132:135]
    ds_read_b64_tr_b16 v[68:69], v23 offset:8192
    ds_read_b64_tr_b16 v[70:71], v23 offset:8704
    v_mfma_f32_16x16x32_bf16 v[140:143], v[84:87], v[52:55], v[140:143]
    s_waitcnt lgkmcnt(0)
    v_mfma_f32_16x16x32_bf16 v[128:131], v[64:67], v[32:35], v[128:131]
    ds_read_b128 v[48:51], v17 offset:0
    ds_read_b128 v[52:55], v17 offset:4096
    v_mfma_f32_16x16x32_bf16 v[136:139], v[64:67], v[36:39], v[136:139]
    ds_read_b64_tr_b16 v[80:81], v22 offset:12288
    ds_read_b64_tr_b16 v[82:83], v22 offset:12800
    v_mfma_f32_16x16x32_bf16 v[132:135], v[68:71], v[32:35], v[132:135]
    ds_read_b64_tr_b16 v[84:85], v23 offset:12288
    ds_read_b64_tr_b16 v[86:87], v23 offset:12800
    v_mfma_f32_16x16x32_bf16 v[140:143], v[68:71], v[36:39], v[140:143]
    s_waitcnt lgkmcnt(0)
    s_barrier
    v_mfma_f32_16x16x32_bf16 v[128:131], v[80:83], v[48:51], v[128:131]
    ds_read_b128 v[32:35], v14 offset:32768
    ds_read_b128 v[36:39], v14 offset:36864
    v_mfma_f32_16x16x32_bf16 v[136:139], v[80:83], v[52:55], v[136:139]
    ds_read_b64_tr_b16 v[64:65], v22 offset:32768
    ds_read_b64_tr_b16 v[66:67], v22 offset:33280
    v_mfma_f32_16x16x32_bf16 v[132:135], v[84:87], v[48:51], v[132:135]
    ds_read_b64_tr_b16 v[68:69], v23 offset:32768
    ds_read_b64_tr_b16 v[70:71], v23 offset:33280
    v_mfma_f32_16x16x32_bf16 v[140:143], v[84:87], v[52:55], v[140:143]
    s_waitcnt lgkmcnt(0)
    v_mfma_f32_16x16x32_bf16 v[128:131], v[64:67], v[32:35], v[128:131]
    ds_read_b128 v[48:51], v15 offset:32768
    ds_read_b128 v[52:55], v15 offset:36864
    v_mfma_f32_16x16x32_bf16 v[136:139], v[64:67], v[36:39], v[136:139]
    ds_read_b64_tr_b16 v[80:81], v22 offset:36864
    ds_read_b64_tr_b16 v[82:83], v22 offset:37376
    v_mfma_f32_16x16x32_bf16 v[132:135], v[68:71], v[32:35], v[132:135]
    ds_read_b64_tr_b16 v[84:85], v23 offset:36864
    ds_read_b64_tr_b16 v[86:87], v23 offset:37376
    v_mfma_f32_16x16x32_bf16 v[140:143], v[68:71], v[36:39], v[140:143]
    s_waitcnt lgkmcnt(0)
    v_mfma_f32_16x16x32_bf16 v[128:131], v[80:83], v[48:51], v[128:131]
    ds_read_b128 v[32:35], v16 offset:32768
    ds_read_b128 v[36:39], v16 offset:36864
    v_mfma_f32_16x16x32_bf16 v[136:139], v[80:83], v[52:55], v[136:139]
    ds_read_b64_tr_b16 v[64:65], v22 offset:40960
    ds_read_b64_tr_b16 v[66:67], v22 offset:41472
    v_mfma_f32_16x16x32_bf16 v[132:135], v[84:87], v[48:51], v[132:135]
    ds_read_b64_tr_b16 v[68:69], v23 offset:40960
    ds_read_b64_tr_b16 v[70:71], v23 offset:41472
    v_mfma_f32_16x16x32_bf16 v[140:143], v[84:87], v[52:55], v[140:143]
    s_waitcnt lgkmcnt(0)
    v_mfma_f32_16x16x32_bf16 v[128:131], v[64:67], v[32:35], v[128:131]
    ds_read_b128 v[48:51], v17 offset:32768
    ds_read_b128 v[52:55], v17 offset:36864
    v_mfma_f32_16x16x32_bf16 v[136:139], v[64:67], v[36:39], v[136:139]
    ds_read_b64_tr_b16 v[80:81], v22 offset:45056
    ds_read_b64_tr_b16 v[82:83], v22 offset:45568
    v_mfma_f32_16x16x32_bf16 v[132:135], v[68:71], v[32:35], v[132:135]
    ds_read_b64_tr_b16 v[84:85], v23 offset:45056
    ds_read_b64_tr_b16 v[86:87], v23 offset:45568
    v_mfma_f32_16x16x32_bf16 v[140:143], v[68:71], v[36:39], v[140:143]
    s_waitcnt lgkmcnt(0)
    s_barrier
    v_mfma_f32_16x16x32_bf16 v[128:131], v[80:83], v[48:51], v[128:131]
    v_add_u32 v14, 0x10000, v14
    v_add_u32 v15, 0x10000, v15
    v_add_u32 v16, 0x10000, v16
    v_add_u32 v17, 0x10000, v17
    v_mfma_f32_16x16x32_bf16 v[136:139], v[80:83], v[52:55], v[136:139]
    v_add_u32 v22, 0x10000, v22
    v_add_u32 v23, 0x10000, v23
    ds_read_b128 v[32:35], v14 offset:0
    ds_read_b128 v[36:39], v14 offset:4096
    v_mfma_f32_16x16x32_bf16 v[132:135], v[84:87], v[48:51], v[132:135]
    ds_read_b64_tr_b16 v[64:65], v22 offset:0
    ds_read_b64_tr_b16 v[66:67], v22 offset:512
    ds_read_b64_tr_b16 v[68:69], v23 offset:0
    ds_read_b64_tr_b16 v[70:71], v23 offset:512
    v_mfma_f32_16x16x32_bf16 v[140:143], v[84:87], v[52:55], v[140:143]
    s_waitcnt lgkmcnt(0)
    v_mfma_f32_16x16x32_bf16 v[128:131], v[64:67], v[32:35], v[128:131]
    ds_read_b128 v[48:51], v15 offset:0
    ds_read_b128 v[52:55], v15 offset:4096
    v_mfma_f32_16x16x32_bf16 v[136:139], v[64:67], v[36:39], v[136:139]
    ds_read_b64_tr_b16 v[80:81], v22 offset:4096
    ds_read_b64_tr_b16 v[82:83], v22 offset:4608
    v_mfma_f32_16x16x32_bf16 v[132:135], v[68:71], v[32:35], v[132:135]
    ds_read_b64_tr_b16 v[84:85], v23 offset:4096
    ds_read_b64_tr_b16 v[86:87], v23 offset:4608
    v_mfma_f32_16x16x32_bf16 v[140:143], v[68:71], v[36:39], v[140:143]
    s_waitcnt lgkmcnt(0)
    v_mfma_f32_16x16x32_bf16 v[128:131], v[80:83], v[48:51], v[128:131]
    ds_read_b128 v[32:35], v16 offset:0
    ds_read_b128 v[36:39], v16 offset:4096
    v_mfma_f32_16x16x32_bf16 v[136:139], v[80:83], v[52:55], v[136:139]
    ds_read_b64_tr_b16 v[64:65], v22 offset:8192
    ds_read_b64_tr_b16 v[66:67], v22 offset:8704
    v_mfma_f32_16x16x32_bf16 v[132:135], v[84:87], v[48:51], v[132:135]
    ds_read_b64_tr_b16 v[68:69], v23 offset:8192
    ds_read_b64_tr_b16 v[70:71], v23 offset:8704
    v_mfma_f32_16x16x32_bf16 v[140:143], v[84:87], v[52:55], v[140:143]
    s_waitcnt lgkmcnt(0)
    v_mfma_f32_16x16x32_bf16 v[128:131], v[64:67], v[32:35], v[128:131]
    ds_read_b128 v[48:51], v17 offset:0
    ds_read_b128 v[52:55], v17 offset:4096
    v_mfma_f32_16x16x32_bf16 v[136:139], v[64:67], v[36:39], v[136:139]
    ds_read_b64_tr_b16 v[80:81], v22 offset:12288
    ds_read_b64_tr_b16 v[82:83], v22 offset:12800
    v_mfma_f32_16x16x32_bf16 v[132:135], v[68:71], v[32:35], v[132:135]
    ds_read_b64_tr_b16 v[84:85], v23 offset:12288
    ds_read_b64_tr_b16 v[86:87], v23 offset:12800
    v_mfma_f32_16x16x32_bf16 v[140:143], v[68:71], v[36:39], v[140:143]
    s_waitcnt lgkmcnt(0)
    s_barrier
    v_mfma_f32_16x16x32_bf16 v[128:131], v[80:83], v[48:51], v[128:131]
    ds_read_b128 v[32:35], v14 offset:32768
    ds_read_b128 v[36:39], v14 offset:36864
    v_mfma_f32_16x16x32_bf16 v[136:139], v[80:83], v[52:55], v[136:139]
    ds_read_b64_tr_b16 v[64:65], v22 offset:32768
    ds_read_b64_tr_b16 v[66:67], v22 offset:33280
    v_mfma_f32_16x16x32_bf16 v[132:135], v[84:87], v[48:51], v[132:135]
    ds_read_b64_tr_b16 v[68:69], v23 offset:32768
    ds_read_b64_tr_b16 v[70:71], v23 offset:33280
    v_mfma_f32_16x16x32_bf16 v[140:143], v[84:87], v[52:55], v[140:143]
    s_waitcnt lgkmcnt(0)
    v_mfma_f32_16x16x32_bf16 v[128:131], v[64:67], v[32:35], v[128:131]
    ds_read_b128 v[48:51], v15 offset:32768
    ds_read_b128 v[52:55], v15 offset:36864
    v_mfma_f32_16x16x32_bf16 v[136:139], v[64:67], v[36:39], v[136:139]
    ds_read_b64_tr_b16 v[80:81], v22 offset:36864
    ds_read_b64_tr_b16 v[82:83], v22 offset:37376
    v_mfma_f32_16x16x32_bf16 v[132:135], v[68:71], v[32:35], v[132:135]
    ds_read_b64_tr_b16 v[84:85], v23 offset:36864
    ds_read_b64_tr_b16 v[86:87], v23 offset:37376
    v_mfma_f32_16x16x32_bf16 v[140:143], v[68:71], v[36:39], v[140:143]
    s_waitcnt lgkmcnt(0)
    v_mfma_f32_16x16x32_bf16 v[128:131], v[80:83], v[48:51], v[128:131]
    ds_read_b128 v[32:35], v16 offset:32768
    ds_read_b128 v[36:39], v16 offset:36864
    v_mfma_f32_16x16x32_bf16 v[136:139], v[80:83], v[52:55], v[136:139]
    ds_read_b64_tr_b16 v[64:65], v22 offset:40960
    ds_read_b64_tr_b16 v[66:67], v22 offset:41472
    v_mfma_f32_16x16x32_bf16 v[132:135], v[84:87], v[48:51], v[132:135]
    ds_read_b64_tr_b16 v[68:69], v23 offset:40960
    ds_read_b64_tr_b16 v[70:71], v23 offset:41472
    v_mfma_f32_16x16x32_bf16 v[140:143], v[84:87], v[52:55], v[140:143]
    s_waitcnt lgkmcnt(0)
    v_mfma_f32_16x16x32_bf16 v[128:131], v[64:67], v[32:35], v[128:131]
    ds_read_b128 v[48:51], v17 offset:32768
    ds_read_b128 v[52:55], v17 offset:36864
    v_mfma_f32_16x16x32_bf16 v[136:139], v[64:67], v[36:39], v[136:139]
    ds_read_b64_tr_b16 v[80:81], v22 offset:45056
    ds_read_b64_tr_b16 v[82:83], v22 offset:45568
    v_mfma_f32_16x16x32_bf16 v[132:135], v[68:71], v[32:35], v[132:135]
    ds_read_b64_tr_b16 v[84:85], v23 offset:45056
    ds_read_b64_tr_b16 v[86:87], v23 offset:45568
    v_mfma_f32_16x16x32_bf16 v[140:143], v[68:71], v[36:39], v[140:143]
    s_waitcnt lgkmcnt(0)
    s_barrier
    v_mfma_f32_16x16x32_bf16 v[128:131], v[80:83], v[48:51], v[128:131]
    v_add_u32 v14, 0xffff0000, v14
    v_add_u32 v15, 0xffff0000, v15
    v_add_u32 v16, 0xffff0000, v16
    v_add_u32 v17, 0xffff0000, v17
    v_mfma_f32_16x16x32_bf16 v[136:139], v[80:83], v[52:55], v[136:139]
    v_add_u32 v22, 0xffff0000, v22
    v_add_u32 v23, 0xffff0000, v23
    ds_read_b128 v[32:35], v14 offset:0
    ds_read_b128 v[36:39], v14 offset:4096
    v_mfma_f32_16x16x32_bf16 v[132:135], v[84:87], v[48:51], v[132:135]
    ds_read_b64_tr_b16 v[64:65], v22 offset:0
    ds_read_b64_tr_b16 v[66:67], v22 offset:512
    ds_read_b64_tr_b16 v[68:69], v23 offset:0
    ds_read_b64_tr_b16 v[70:71], v23 offset:512
    v_mfma_f32_16x16x32_bf16 v[140:143], v[84:87], v[52:55], v[140:143]
    s_waitcnt lgkmcnt(0)
    v_mfma_f32_16x16x32_bf16 v[128:131], v[64:67], v[32:35], v[128:131]
    ds_read_b128 v[48:51], v15 offset:0
    ds_read_b128 v[52:55], v15 offset:4096
    v_mfma_f32_16x16x32_bf16 v[136:139], v[64:67], v[36:39], v[136:139]
    ds_read_b64_tr_b16 v[80:81], v22 offset:4096
    ds_read_b64_tr_b16 v[82:83], v22 offset:4608
    v_mfma_f32_16x16x32_bf16 v[132:135], v[68:71], v[32:35], v[132:135]
    ds_read_b64_tr_b16 v[84:85], v23 offset:4096
    ds_read_b64_tr_b16 v[86:87], v23 offset:4608
    v_mfma_f32_16x16x32_bf16 v[140:143], v[68:71], v[36:39], v[140:143]
    s_waitcnt lgkmcnt(0)
    v_mfma_f32_16x16x32_bf16 v[128:131], v[80:83], v[48:51], v[128:131]
    ds_read_b128 v[32:35], v16 offset:0
    ds_read_b128 v[36:39], v16 offset:4096
    v_mfma_f32_16x16x32_bf16 v[136:139], v[80:83], v[52:55], v[136:139]
    ds_read_b64_tr_b16 v[64:65], v22 offset:8192
    ds_read_b64_tr_b16 v[66:67], v22 offset:8704
    v_mfma_f32_16x16x32_bf16 v[132:135], v[84:87], v[48:51], v[132:135]
    ds_read_b64_tr_b16 v[68:69], v23 offset:8192
    ds_read_b64_tr_b16 v[70:71], v23 offset:8704
    v_mfma_f32_16x16x32_bf16 v[140:143], v[84:87], v[52:55], v[140:143]
    s_waitcnt lgkmcnt(0)
    v_mfma_f32_16x16x32_bf16 v[128:131], v[64:67], v[32:35], v[128:131]
    ds_read_b128 v[48:51], v17 offset:0
    ds_read_b128 v[52:55], v17 offset:4096
    v_mfma_f32_16x16x32_bf16 v[136:139], v[64:67], v[36:39], v[136:139]
    ds_read_b64_tr_b16 v[80:81], v22 offset:12288
    ds_read_b64_tr_b16 v[82:83], v22 offset:12800
    v_mfma_f32_16x16x32_bf16 v[132:135], v[68:71], v[32:35], v[132:135]
    ds_read_b64_tr_b16 v[84:85], v23 offset:12288
    ds_read_b64_tr_b16 v[86:87], v23 offset:12800
    v_mfma_f32_16x16x32_bf16 v[140:143], v[68:71], v[36:39], v[140:143]
    s_waitcnt lgkmcnt(0)
    s_barrier
    v_mfma_f32_16x16x32_bf16 v[128:131], v[80:83], v[48:51], v[128:131]
    ds_read_b128 v[32:35], v14 offset:32768
    ds_read_b128 v[36:39], v14 offset:36864
    v_mfma_f32_16x16x32_bf16 v[136:139], v[80:83], v[52:55], v[136:139]
    ds_read_b64_tr_b16 v[64:65], v22 offset:32768
    ds_read_b64_tr_b16 v[66:67], v22 offset:33280
    v_mfma_f32_16x16x32_bf16 v[132:135], v[84:87], v[48:51], v[132:135]
    ds_read_b64_tr_b16 v[68:69], v23 offset:32768
    ds_read_b64_tr_b16 v[70:71], v23 offset:33280
    v_mfma_f32_16x16x32_bf16 v[140:143], v[84:87], v[52:55], v[140:143]
    s_waitcnt lgkmcnt(0)
    v_mfma_f32_16x16x32_bf16 v[128:131], v[64:67], v[32:35], v[128:131]
    ds_read_b128 v[48:51], v15 offset:32768
    ds_read_b128 v[52:55], v15 offset:36864
    v_mfma_f32_16x16x32_bf16 v[136:139], v[64:67], v[36:39], v[136:139]
    ds_read_b64_tr_b16 v[80:81], v22 offset:36864
    ds_read_b64_tr_b16 v[82:83], v22 offset:37376
    v_mfma_f32_16x16x32_bf16 v[132:135], v[68:71], v[32:35], v[132:135]
    ds_read_b64_tr_b16 v[84:85], v23 offset:36864
    ds_read_b64_tr_b16 v[86:87], v23 offset:37376
    v_mfma_f32_16x16x32_bf16 v[140:143], v[68:71], v[36:39], v[140:143]
    s_waitcnt lgkmcnt(0)
    v_mfma_f32_16x16x32_bf16 v[128:131], v[80:83], v[48:51], v[128:131]
    ds_read_b128 v[32:35], v16 offset:32768
    ds_read_b128 v[36:39], v16 offset:36864
    v_mfma_f32_16x16x32_bf16 v[136:139], v[80:83], v[52:55], v[136:139]
    ds_read_b64_tr_b16 v[64:65], v22 offset:40960
    ds_read_b64_tr_b16 v[66:67], v22 offset:41472
    v_mfma_f32_16x16x32_bf16 v[132:135], v[84:87], v[48:51], v[132:135]
    ds_read_b64_tr_b16 v[68:69], v23 offset:40960
    ds_read_b64_tr_b16 v[70:71], v23 offset:41472
    v_mfma_f32_16x16x32_bf16 v[140:143], v[84:87], v[52:55], v[140:143]
    s_waitcnt lgkmcnt(0)
    v_mfma_f32_16x16x32_bf16 v[128:131], v[64:67], v[32:35], v[128:131]
    ds_read_b128 v[48:51], v17 offset:32768
    ds_read_b128 v[52:55], v17 offset:36864
    v_mfma_f32_16x16x32_bf16 v[136:139], v[64:67], v[36:39], v[136:139]
    ds_read_b64_tr_b16 v[80:81], v22 offset:45056
    ds_read_b64_tr_b16 v[82:83], v22 offset:45568
    v_mfma_f32_16x16x32_bf16 v[132:135], v[68:71], v[32:35], v[132:135]
    ds_read_b64_tr_b16 v[84:85], v23 offset:45056
    ds_read_b64_tr_b16 v[86:87], v23 offset:45568
    v_mfma_f32_16x16x32_bf16 v[140:143], v[68:71], v[36:39], v[140:143]
    s_waitcnt lgkmcnt(0)
    v_mfma_f32_16x16x32_bf16 v[128:131], v[80:83], v[48:51], v[128:131]
    v_mfma_f32_16x16x32_bf16 v[136:139], v[80:83], v[52:55], v[136:139]
    v_mfma_f32_16x16x32_bf16 v[132:135], v[84:87], v[48:51], v[132:135]
    v_mfma_f32_16x16x32_bf16 v[140:143], v[84:87], v[52:55], v[140:143]
    s_nop 7
    s_waitcnt vmcnt(0)
    v_lshlrev_b32 v32, 16, v96
    v_and_b32 v33, 0xffff0000, v96
    v_lshlrev_b32 v34, 16, v97
    v_and_b32 v35, 0xffff0000, v97
    v_add_f32 v40, v128, v32
    v_add_f32 v41, v129, v33
    v_add_f32 v42, v130, v34
    v_add_f32 v43, v131, v35
    v_lshlrev_b32 v32, 16, v112
    v_and_b32 v33, 0xffff0000, v112
    v_lshlrev_b32 v34, 16, v113
    v_and_b32 v35, 0xffff0000, v113
    v_add_f32 v40, v40, v32
    v_add_f32 v41, v41, v33
    v_add_f32 v42, v42, v34
    v_add_f32 v43, v43, v35
    v_cvt_pk_bf16_f32 v48, v40, v41
    v_cvt_pk_bf16_f32 v49, v42, v43
    buffer_store_dwordx2 v[48:49], v12, s[20:23], s54 offen offset:0
    v_lshlrev_b32 v32, 16, v98
    v_and_b32 v33, 0xffff0000, v98
    v_lshlrev_b32 v34, 16, v99
    v_and_b32 v35, 0xffff0000, v99
    v_add_f32 v40, v132, v32
    v_add_f32 v41, v133, v33
    v_add_f32 v42, v134, v34
    v_add_f32 v43, v135, v35
    v_lshlrev_b32 v32, 16, v114
    v_and_b32 v33, 0xffff0000, v114
    v_lshlrev_b32 v34, 16, v115
    v_and_b32 v35, 0xffff0000, v115
    v_add_f32 v40, v40, v32
    v_add_f32 v41, v41, v33
    v_add_f32 v42, v42, v34
    v_add_f32 v43, v43, v35
    v_cvt_pk_bf16_f32 v50, v40, v41
    v_cvt_pk_bf16_f32 v51, v42, v43
    buffer_store_dwordx2 v[50:51], v12, s[20:23], s54 offen offset:32
    v_lshlrev_b32 v32, 16, v100
    v_and_b32 v33, 0xffff0000, v100
    v_lshlrev_b32 v34, 16, v101
    v_and_b32 v35, 0xffff0000, v101
    v_add_f32 v40, v136, v32
    v_add_f32 v41, v137, v33
    v_add_f32 v42, v138, v34
    v_add_f32 v43, v139, v35
    v_lshlrev_b32 v32, 16, v112
    v_and_b32 v33, 0xffff0000, v112
    v_lshlrev_b32 v34, 16, v113
    v_and_b32 v35, 0xffff0000, v113
    v_add_f32 v40, v40, v32
    v_add_f32 v41, v41, v33
    v_add_f32 v42, v42, v34
    v_add_f32 v43, v43, v35
    v_cvt_pk_bf16_f32 v52, v40, v41
    v_cvt_pk_bf16_f32 v53, v42, v43
    buffer_store_dwordx2 v[52:53], v13, s[20:23], s54 offen offset:0
    v_lshlrev_b32 v32, 16, v102
    v_and_b32 v33, 0xffff0000, v102
    v_lshlrev_b32 v34, 16, v103
    v_and_b32 v35, 0xffff0000, v103
    v_add_f32 v40, v140, v32
    v_add_f32 v41, v141, v33
    v_add_f32 v42, v142, v34
    v_add_f32 v43, v143, v35
    v_lshlrev_b32 v32, 16, v114
    v_and_b32 v33, 0xffff0000, v114
    v_lshlrev_b32 v34, 16, v115
    v_and_b32 v35, 0xffff0000, v115
    v_add_f32 v40, v40, v32
    v_add_f32 v41, v41, v33
    v_add_f32 v42, v42, v34
    v_add_f32 v43, v43, v35
    v_cvt_pk_bf16_f32 v54, v40, v41
    v_cvt_pk_bf16_f32 v55, v42, v43
    buffer_store_dwordx2 v[54:55], v13, s[20:23], s54 offen offset:32
L_ffn2a_kernel_end:
    s_endpgm
.p2align 8
.globl qkv1_kernel
.type qkv1_kernel,@function
qkv1_kernel:
    s_cmp_ge_u32 s2, 192
    s_cbranch_scc1 L_qkv1_kernel_end
    s_load_dwordx2 s[6:7], s[0:1], 8
    s_load_dwordx2 s[8:9], s[0:1], 80
    v_and_b32 v1, 63, v0
    v_and_b32 v2, 15, v0
    v_bfe_u32 v3, v0, 4, 2
    v_lshrrev_b32 v28, 6, v0
    s_nop 0
    v_readfirstlane_b32 s30, v28
    s_and_b32 s34, s2, 7
    s_lshr_b32 s35, s2, 3
    s_lshr_b32 s55, s30, 2
    s_and_b32 s30, s30, 3
    s_mul_i32 s36, s35, 43
    s_lshr_b32 s36, s36, 8
    s_mul_i32 s37, s36, 6
    s_sub_u32 s37, s35, s37
    s_lshr_b32 s38, s34, 1
    s_lshl_b32 s38, s38, 2
    s_add_u32 s38, s38, s36
    s_and_b32 s39, s34, 1
    s_mul_i32 s39, s39, 6
    s_add_u32 s39, s39, s37
    s_lshl_b32 s28, s38, 7
    s_lshl_b32 s29, s39, 7
    s_lshr_b32 s31, s30, 1
    s_and_b32 s32, s30, 1
    s_waitcnt lgkmcnt(0)
    s_add_u32 s12, s8, 0x1200000
    s_addc_u32 s13, s9, 0
    s_and_b32 s13, s13, 0xffff
    s_mov_b32 s14, 0x200000
    s_mov_b32 s15, 0x20000
    s_mov_b32 s16, s6
    s_and_b32 s17, s7, 0xffff
    s_mov_b32 s18, 0x180000
    s_mov_b32 s19, 0x20000
    s_mov_b32 s20, s8
    s_and_b32 s21, s9, 0xffff
    s_mov_b32 s22, 0x600000
    s_mov_b32 s23, 0x20000
    v_lshrrev_b32 v28, 3, v1
    v_and_b32 v29, 7, v1
    v_lshrrev_b32 v30, 1, v28
    v_xor_b32 v29, v29, v30
    v_mul_u32_u24 v28, 0x400, v28
    v_lshl_add_u32 v4, v29, 4, v28
    v_xor_b32 v29, 4, v29
    v_lshl_add_u32 v5, v29, 4, v28
    v_lshrrev_b32 v29, 1, v2
    v_xor_b32 v29, v29, v3
    v_and_b32 v30, 1, v2
    v_lshl_add_u32 v29, v29, 1, v30
    v_mul_u32_u24 v28, 0xc00, v3
    v_lshl_add_u32 v8, v29, 4, v28
    v_xor_b32 v29, 8, v29
    v_lshl_add_u32 v9, v29, 4, v28
    s_mul_i32 s33, s30, 32
    s_add_u32 s34, s28, s33
    s_mul_i32 s50, s34, 1024
    s_mul_i32 s51, s33, 128
    s_mul_i32 s33, s30, 16
    s_mul_i32 s52, s33, 3072
    s_lshl_b32 s34, s29, 1
    s_add_u32 s52, s52, s34
    s_mul_i32 s53, s33, 256
    s_add_u32 s53, s53, 16384
    s_cmp_eq_u32 s55, 0
    s_cbranch_scc1 L_qkv1_kernel_comp
    s_setprio 3
    s_add_u32 s34, s50, 0x0
    s_add_u32 m0, s51, 0x0
    s_nop 0
    buffer_load_dwordx4 v4, s[12:15], s34 offen lds
    s_add_u32 s34, s50, 0x2000
    s_add_u32 m0, s51, 0x400
    s_nop 0
    buffer_load_dwordx4 v5, s[12:15], s34 offen lds
    s_add_u32 s34, s50, 0x4000
    s_add_u32 m0, s51, 0x800
    s_nop 0
    buffer_load_dwordx4 v4, s[12:15], s34 offen lds
    s_add_u32 s34, s50, 0x6000
    s_add_u32 m0, s51, 0xc00
    s_nop 0
    buffer_load_dwordx4 v5, s[12:15], s34 offen lds
    s_add_u32 s34, s52, 0x0
    s_add_u32 m0, s53, 0x0
    s_nop 0
    buffer_load_dwordx4 v8, s[16:19], s34 offen lds
    s_add_u32 s34, s52, 0x3000
    s_add_u32 m0, s53, 0x400
    s_nop 0
    buffer_load_dwordx4 v8, s[16:19], s34 offen lds
    s_add_u32 s34, s52, 0x6000
    s_add_u32 m0, s53, 0x800
    s_nop 0
    buffer_load_dwordx4 v9, s[16:19], s34 offen lds
    s_add_u32 s34, s52, 0x9000
    s_add_u32 m0, s53, 0xc00
    s_nop 0
    buffer_load_dwordx4 v9, s[16:19], s34 offen lds
    s_add_u32 s34, s50, 0x80
    s_add_u32 m0, s51, 0x8000
    s_nop 0
    buffer_load_dwordx4 v4, s[12:15], s34 offen lds
    s_add_u32 s34, s50, 0x2080
    s_add_u32 m0, s51, 0x8400
    s_nop 0
    buffer_load_dwordx4 v5, s[12:15], s34 offen lds
    s_add_u32 s34, s50, 0x4080
    s_add_u32 m0, s51, 0x8800
    s_nop 0
    buffer_load_dwordx4 v4, s[12:15], s34 offen lds
    s_add_u32 s34, s50, 0x6080
    s_add_u32 m0, s51, 0x8c00
    s_nop 0
    buffer_load_dwordx4 v5, s[12:15], s34 offen lds
    s_add_u32 s34, s52, 0x30000
    s_add_u32 m0, s53, 0x8000
    s_nop 0
    buffer_load_dwordx4 v8, s[16:19], s34 offen lds
    s_add_u32 s34, s52, 0x33000
    s_add_u32 m0, s53, 0x8400
    s_nop 0
    buffer_load_dwordx4 v8, s[16:19], s34 offen lds
    s_add_u32 s34, s52, 0x36000
    s_add_u32 m0, s53, 0x8800
    s_nop 0
    buffer_load_dwordx4 v9, s[16:19], s34 offen lds
    s_add_u32 s34, s52, 0x39000
    s_add_u32 m0, s53, 0x8c00
    s_nop 0
    buffer_load_dwordx4 v9, s[16:19], s34 offen lds
    s_waitcnt vmcnt(8)
    s_barrier
    s_add_u32 s34, s50, 0x100
    s_add_u32 m0, s51, 0x10000
    s_nop 0
    buffer_load_dwordx4 v4, s[12:15], s34 offen lds
    s_add_u32 s34, s50, 0x2100
    s_add_u32 m0, s51, 0x10400
    s_nop 0
    buffer_load_dwordx4 v5, s[12:15], s34 offen lds
    s_add_u32 s34, s50, 0x4100
    s_add_u32 m0, s51, 0x10800
    s_nop 0
    buffer_load_dwordx4 v4, s[12:15], s34 offen lds
    s_add_u32 s34, s50, 0x6100
    s_add_u32 m0, s51, 0x10c00
    s_nop 0
    buffer_load_dwordx4 v5, s[12:15], s34 offen lds
    s_add_u32 s34, s52, 0x60000
    s_add_u32 m0, s53, 0x10000
    s_nop 0
    buffer_load_dwordx4 v8, s[16:19], s34 offen lds
    s_add_u32 s34, s52, 0x63000
    s_add_u32 m0, s53, 0x10400
    s_nop 0
    buffer_load_dwordx4 v8, s[16:19], s34 offen lds
    s_add_u32 s34, s52, 0x66000
    s_add_u32 m0, s53, 0x10800
    s_nop 0
    buffer_load_dwordx4 v9, s[16:19], s34 offen lds
    s_add_u32 s34, s52, 0x69000
    s_add_u32 m0, s53, 0x10c00
    s_nop 0
    buffer_load_dwordx4 v9, s[16:19], s34 offen lds
    s_add_u32 s34, s50, 0x180
    s_add_u32 m0, s51, 0x18000
    s_nop 0
    buffer_load_dwordx4 v4, s[12:15], s34 offen lds
    s_add_u32 s34, s50, 0x2180
    s_add_u32 m0, s51, 0x18400
    s_nop 0
    buffer_load_dwordx4 v5, s[12:15], s34 offen lds
    s_add_u32 s34, s50, 0x4180
    s_add_u32 m0, s51, 0x18800
    s_nop 0
    buffer_load_dwordx4 v4, s[12:15], s34 offen lds
    s_add_u32 s34, s50, 0x6180
    s_add_u32 m0, s51, 0x18c00
    s_nop 0
    buffer_load_dwordx4 v5, s[12:15], s34 offen lds
    s_add_u32 s34, s52, 0x90000
    s_add_u32 m0, s53, 0x18000
    s_nop 0
    buffer_load_dwordx4 v8, s[16:19], s34 offen lds
    s_add_u32 s34, s52, 0x93000
    s_add_u32 m0, s53, 0x18400
    s_nop 0
    buffer_load_dwordx4 v8, s[16:19], s34 offen lds
    s_add_u32 s34, s52, 0x96000
    s_add_u32 m0, s53, 0x18800
    s_nop 0
    buffer_load_dwordx4 v9, s[16:19], s34 offen lds
    s_add_u32 s34, s52, 0x99000
    s_add_u32 m0, s53, 0x18c00
    s_nop 0
    buffer_load_dwordx4 v9, s[16:19], s34 offen lds
    s_waitcnt vmcnt(16)
    s_barrier
    s_add_u32 s34, s50, 0x200
    s_add_u32 m0, s51, 0x0
    s_nop 0
    buffer_load_dwordx4 v4, s[12:15], s34 offen lds
    s_add_u32 s34, s50, 0x2200
    s_add_u32 m0, s51, 0x400
    s_nop 0
    buffer_load_dwordx4 v5, s[12:15], s34 offen lds
    s_add_u32 s34, s50, 0x4200
    s_add_u32 m0, s51, 0x800
    s_nop 0
    buffer_load_dwordx4 v4, s[12:15], s34 offen lds
    s_add_u32 s34, s50, 0x6200
    s_add_u32 m0, s51, 0xc00
    s_nop 0
    buffer_load_dwordx4 v5, s[12:15], s34 offen lds
    s_add_u32 s34, s52, 0xc0000
    s_add_u32 m0, s53, 0x0
    s_nop 0
    buffer_load_dwordx4 v8, s[16:19], s34 offen lds
    s_add_u32 s34, s52, 0xc3000
    s_add_u32 m0, s53, 0x400
    s_nop 0
    buffer_load_dwordx4 v8, s[16:19], s34 offen lds
    s_add_u32 s34, s52, 0xc6000
    s_add_u32 m0, s53, 0x800
    s_nop 0
    buffer_load_dwordx4 v9, s[16:19], s34 offen lds
    s_add_u32 s34, s52, 0xc9000
    s_add_u32 m0, s53, 0xc00
    s_nop 0
    buffer_load_dwordx4 v9, s[16:19], s34 offen lds
    s_waitcnt vmcnt(16)
    s_barrier
    s_add_u32 s34, s50, 0x280
    s_add_u32 m0, s51, 0x8000
    s_nop 0
    buffer_load_dwordx4 v4, s[12:15], s34 offen lds
    s_add_u32 s34, s50, 0x2280
    s_add_u32 m0, s51, 0x8400
    s_nop 0
    buffer_load_dwordx4 v5, s[12:15], s34 offen lds
    s_add_u32 s34, s50, 0x4280
    s_add_u32 m0, s51, 0x8800
    s_nop 0
    buffer_load_dwordx4 v4, s[12:15], s34 offen lds
    s_add_u32 s34, s50, 0x6280
    s_add_u32 m0, s51, 0x8c00
    s_nop 0
    buffer_load_dwordx4 v5, s[12:15], s34 offen lds
    s_add_u32 s34, s52, 0xf0000
    s_add_u32 m0, s53, 0x8000
    s_nop 0
    buffer_load_dwordx4 v8, s[16:19], s34 offen lds
    s_add_u32 s34, s52, 0xf3000
    s_add_u32 m0, s53, 0x8400
    s_nop 0
    buffer_load_dwordx4 v8, s[16:19], s34 offen lds
    s_add_u32 s34, s52, 0xf6000
    s_add_u32 m0, s53, 0x8800
    s_nop 0
    buffer_load_dwordx4 v9, s[16:19], s34 offen lds
    s_add_u32 s34, s52, 0xf9000
    s_add_u32 m0, s53, 0x8c00
    s_nop 0
    buffer_load_dwordx4 v9, s[16:19], s34 offen lds
    s_waitcnt vmcnt(16)
    s_barrier
    s_add_u32 s34, s50, 0x300
    s_add_u32 m0, s51, 0x10000
    s_nop 0
    buffer_load_dwordx4 v4, s[12:15], s34 offen lds
    s_add_u32 s34, s50, 0x2300
    s_add_u32 m0, s51, 0x10400
    s_nop 0
    buffer_load_dwordx4 v5, s[12:15], s34 offen lds
    s_add_u32 s34, s50, 0x4300
    s_add_u32 m0, s51, 0x10800
    s_nop 0
    buffer_load_dwordx4 v4, s[12:15], s34 offen lds
    s_add_u32 s34, s50, 0x6300
    s_add_u32 m0, s51, 0x10c00
    s_nop 0
    buffer_load_dwordx4 v5, s[12:15], s34 offen lds
    s_add_u32 s34, s52, 0x120000
    s_add_u32 m0, s53, 0x10000
    s_nop 0
    buffer_load_dwordx4 v8, s[16:19], s34 offen lds
    s_add_u32 s34, s52, 0x123000
    s_add_u32 m0, s53, 0x10400
    s_nop 0
    buffer_load_dwordx4 v8, s[16:19], s34 offen lds
    s_add_u32 s34, s52, 0x126000
    s_add_u32 m0, s53, 0x10800
    s_nop 0
    buffer_load_dwordx4 v9, s[16:19], s34 offen lds
    s_add_u32 s34, s52, 0x129000
    s_add_u32 m0, s53, 0x10c00
    s_nop 0
    buffer_load_dwordx4 v9, s[16:19], s34 offen lds
    s_waitcnt vmcnt(16)
    s_barrier
    s_add_u32 s34, s50, 0x380
    s_add_u32 m0, s51, 0x18000
    s_nop 0
    buffer_load_dwordx4 v4, s[12:15], s34 offen lds
    s_add_u32 s34, s50, 0x2380
    s_add_u32 m0, s51, 0x18400
    s_nop 0
    buffer_load_dwordx4 v5, s[12:15], s34 offen lds
    s_add_u32 s34, s50, 0x4380
    s_add_u32 m0, s51, 0x18800
    s_nop 0
    buffer_load_dwordx4 v4, s[12:15], s34 offen lds
    s_add_u32 s34, s50, 0x6380
    s_add_u32 m0, s51, 0x18c00
    s_nop 0
    buffer_load_dwordx4 v5, s[12:15], s34 offen lds
    s_add_u32 s34, s52, 0x150000
    s_add_u32 m0, s53, 0x18000
    s_nop 0
    buffer_load_dwordx4 v8, s[16:19], s34 offen lds
    s_add_u32 s34, s52, 0x153000
    s_add_u32 m0, s53, 0x18400
    s_nop 0
    buffer_load_dwordx4 v8, s[16:19], s34 offen lds
    s_add_u32 s34, s52, 0x156000
    s_add_u32 m0, s53, 0x18800
    s_nop 0
    buffer_load_dwordx4 v9, s[16:19], s34 offen lds
    s_add_u32 s34, s52, 0x159000
    s_add_u32 m0, s53, 0x18c00
    s_nop 0
    buffer_load_dwordx4 v9, s[16:19], s34 offen lds
    s_waitcnt vmcnt(16)
    s_barrier
    s_waitcnt vmcnt(8)
    s_barrier
    s_waitcnt vmcnt(0)
    s_barrier
    s_endpgm
L_qkv1_kernel_comp:
    s_mul_i32 s34, s31, 64
    v_add_u32 v28, s34, v2
    v_lshlrev_b32 v28, 7, v28
    v_lshrrev_b32 v29, 1, v2
    v_xor_b32 v29, v29, v3
    s_lshl_b32 s35, s32, 12
    v_xor_b32 v30, 0, v29
    v_lshl_add_u32 v30, v30, 4, v28
    v_add_u32 v14, s35, v30
    v_subrev_u32 v15, s35, v30
    v_xor_b32 v30, 4, v29
    v_lshl_add_u32 v30, v30, 4, v28
    v_add_u32 v16, s35, v30
    v_subrev_u32 v17, s35, v30
    v_bfe_u32 v28, v0, 2, 2
    v_lshl_add_u32 v29, v3, 3, v28
    v_lshlrev_b32 v29, 8, v29
    v_and_b32 v30, 3, v0
    v_lshl_add_u32 v29, v30, 3, v29
    v_add_u32 v29, 16384, v29
    v_and_b32 v30, 1, v3
    v_lshl_add_u32 v28, v30, 2, v28
    s_mul_i32 s34, s32, 4
    s_lshl_b32 s35, s31, 1
    s_xor_b32 s35, s35, 0
    s_add_u32 s34, s34, s35
    v_xor_b32 v30, s34, v28
    v_lshl_add_u32 v22, v30, 5, v29
    s_mul_i32 s34, s32, 4
    s_lshl_b32 s35, s31, 1
    s_xor_b32 s35, s35, 1
    s_add_u32 s34, s34, s35
    v_xor_b32 v30, s34, v28
    v_lshl_add_u32 v23, v30, 5, v29
    s_mul_i32 s34, s32, 4
    s_lshl_b32 s35, s31, 1
    s_xor_b32 s35, s35, 2
    s_add_u32 s34, s34, s35
    v_xor_b32 v30, s34, v28
    v_lshl_add_u32 v24, v30, 5, v29
    s_mul_i32 s34, s32, 4
    s_lshl_b32 s35, s31, 1
    s_xor_b32 s35, s35, 3
    s_add_u32 s34, s34, s35
    v_xor_b32 v30, s34, v28
    v_lshl_add_u32 v25, v30, 5, v29
    v_mov_b32 v120, 0x3f803f80
    v_mov_b32 v121, 0x3f803f80
    v_mov_b32 v122, 0x3f803f80
    v_mov_b32 v123, 0x3f803f80
    s_barrier
    ds_read_b128 v[32:35], v14 offset:0
    ds_read_b128 v[36:39], v14 offset:2048
    ds_read_b128 v[40:43], v15 offset:4096
    ds_read_b128 v[44:47], v15 offset:6144
    ds_read_b64_tr_b16 v[64:65], v22 offset:0
    ds_read_b64_tr_b16 v[66:67], v22 offset:1024
    ds_read_b64_tr_b16 v[68:69], v23 offset:0
    ds_read_b64_tr_b16 v[70:71], v23 offset:1024
    ds_read_b64_tr_b16 v[72:73], v24 offset:0
    ds_read_b64_tr_b16 v[74:75], v24 offset:1024
    ds_read_b64_tr_b16 v[76:77], v25 offset:0
    ds_read_b64_tr_b16 v[78:79], v25 offset:1024
    s_waitcnt lgkmcnt(0)
    v_mfma_f32_16x16x32_bf16 v[128:131], v[64:67], v[32:35], 0
    ds_read_b128 v[48:51], v16 offset:0
    v_mfma_f32_16x16x32_bf16 v[144:147], v[64:67], v[36:39], 0
    ds_read_b128 v[52:55], v16 offset:2048
    v_mfma_f32_16x16x32_bf16 v[160:163], v[64:67], v[40:43], 0
    ds_read_b128 v[56:59], v17 offset:4096
    v_mfma_f32_16x16x32_bf16 v[176:179], v[64:67], v[44:47], 0
    ds_read_b128 v[60:63], v17 offset:6144
    v_mfma_f32_16x16x32_bf16 v[132:135], v[68:71], v[32:35], 0
    ds_read_b64_tr_b16 v[80:81], v22 offset:8192
    v_mfma_f32_16x16x32_bf16 v[148:151], v[68:71], v[36:39], 0
    ds_read_b64_tr_b16 v[82:83], v22 offset:9216
    v_mfma_f32_16x16x32_bf16 v[164:167], v[68:71], v[40:43], 0
    ds_read_b64_tr_b16 v[84:85], v23 offset:8192
    v_mfma_f32_16x16x32_bf16 v[180:183], v[68:71], v[44:47], 0
    ds_read_b64_tr_b16 v[86:87], v23 offset:9216
    v_mfma_f32_16x16x32_bf16 v[136:139], v[72:75], v[32:35], 0
    ds_read_b64_tr_b16 v[88:89], v24 offset:8192
    v_mfma_f32_16x16x32_bf16 v[152:155], v[72:75], v[36:39], 0
    ds_read_b64_tr_b16 v[90:91], v24 offset:9216
    v_mfma_f32_16x16x32_bf16 v[168:171], v[72:75], v[40:43], 0
    ds_read_b64_tr_b16 v[92:93], v25 offset:8192
    v_mfma_f32_16x16x32_bf16 v[184:187], v[72:75], v[44:47], 0
    ds_read_b64_tr_b16 v[94:95], v25 offset:9216
    v_mfma_f32_16x16x32_bf16 v[140:143], v[76:79], v[32:35], 0
    v_mfma_f32_16x16x32_bf16 v[156:159], v[76:79], v[36:39], 0
    v_mfma_f32_16x16x32_bf16 v[172:175], v[76:79], v[40:43], 0
    v_mfma_f32_16x16x32_bf16 v[188:191], v[76:79], v[44:47], 0
    v_mfma_f32_16x16x32_bf16 v[192:195], v[120:123], v[32:35], 0
    v_mfma_f32_16x16x32_bf16 v[200:203], v[32:35], v[32:35], 0
    v_mfma_f32_16x16x32_bf16 v[208:211], v[64:67], v[120:123], 0
    v_mfma_f32_16x16x32_bf16 v[196:199], v[120:123], v[36:39], 0
    v_mfma_f32_16x16x32_bf16 v[204:207], v[36:39], v[36:39], 0
    v_mfma_f32_16x16x32_bf16 v[212:215], v[68:71], v[120:123], 0
    s_waitcnt lgkmcnt(0)
    s_barrier
    v_mfma_f32_16x16x32_bf16 v[128:131], v[80:83], v[48:51], v[128:131]
    ds_read_b128 v[32:35], v14 offset:32768
    v_mfma_f32_16x16x32_bf16 v[144:147], v[80:83], v[52:55], v[144:147]
    ds_read_b128 v[36:39], v14 offset:34816
    v_mfma_f32_16x16x32_bf16 v[160:163], v[80:83], v[56:59], v[160:163]
    ds_read_b128 v[40:43], v15 offset:36864
    v_mfma_f32_16x16x32_bf16 v[176:179], v[80:83], v[60:63], v[176:179]
    ds_read_b128 v[44:47], v15 offset:38912
    v_mfma_f32_16x16x32_bf16 v[132:135], v[84:87], v[48:51], v[132:135]
    ds_read_b64_tr_b16 v[64:65], v22 offset:32768
    v_mfma_f32_16x16x32_bf16 v[148:151], v[84:87], v[52:55], v[148:151]
    ds_read_b64_tr_b16 v[66:67], v22 offset:33792
    v_mfma_f32_16x16x32_bf16 v[164:167], v[84:87], v[56:59], v[164:167]
    ds_read_b64_tr_b16 v[68:69], v23 offset:32768
    v_mfma_f32_16x16x32_bf16 v[180:183], v[84:87], v[60:63], v[180:183]
    ds_read_b64_tr_b16 v[70:71], v23 offset:33792
    v_mfma_f32_16x16x32_bf16 v[136:139], v[88:91], v[48:51], v[136:139]
    ds_read_b64_tr_b16 v[72:73], v24 offset:32768
    v_mfma_f32_16x16x32_bf16 v[152:155], v[88:91], v[52:55], v[152:155]
    ds_read_b64_tr_b16 v[74:75], v24 offset:33792
    v_mfma_f32_16x16x32_bf16 v[168:171], v[88:91], v[56:59], v[168:171]
    ds_read_b64_tr_b16 v[76:77], v25 offset:32768
    v_mfma_f32_16x16x32_bf16 v[184:187], v[88:91], v[60:63], v[184:187]
    ds_read_b64_tr_b16 v[78:79], v25 offset:33792
    v_mfma_f32_16x16x32_bf16 v[140:143], v[92:95], v[48:51], v[140:143]
    v_mfma_f32_16x16x32_bf16 v[156:159], v[92:95], v[52:55], v[156:159]
    v_mfma_f32_16x16x32_bf16 v[172:175], v[92:95], v[56:59], v[172:175]
    v_mfma_f32_16x16x32_bf16 v[188:191], v[92:95], v[60:63], v[188:191]
    v_mfma_f32_16x16x32_bf16 v[192:195], v[120:123], v[48:51], v[192:195]
    v_mfma_f32_16x16x32_bf16 v[200:203], v[48:51], v[48:51], v[200:203]
    v_mfma_f32_16x16x32_bf16 v[208:211], v[80:83], v[120:123], v[208:211]
    v_mfma_f32_16x16x32_bf16 v[196:199], v[120:123], v[52:55], v[196:199]
    v_mfma_f32_16x16x32_bf16 v[204:207], v[52:55], v[52:55], v[204:207]
    v_mfma_f32_16x16x32_bf16 v[212:215], v[84:87], v[120:123], v[212:215]
    s_waitcnt lgkmcnt(0)
    v_mfma_f32_16x16x32_bf16 v[128:131], v[64:67], v[32:35], v[128:131]
    ds_read_b128 v[48:51], v16 offset:32768
    v_mfma_f32_16x16x32_bf16 v[144:147], v[64:67], v[36:39], v[144:147]
    ds_read_b128 v[52:55], v16 offset:34816
    v_mfma_f32_16x16x32_bf16 v[160:163], v[64:67], v[40:43], v[160:163]
    ds_read_b128 v[56:59], v17 offset:36864
    v_mfma_f32_16x16x32_bf16 v[176:179], v[64:67], v[44:47], v[176:179]
    ds_read_b128 v[60:63], v17 offset:38912
    v_mfma_f32_16x16x32_bf16 v[132:135], v[68:71], v[32:35], v[132:135]
    ds_read_b64_tr_b16 v[80:81], v22 offset:40960
    v_mfma_f32_16x16x32_bf16 v[148:151], v[68:71], v[36:39], v[148:151]
    ds_read_b64_tr_b16 v[82:83], v22 offset:41984
    v_mfma_f32_16x16x32_bf16 v[164:167], v[68:71], v[40:43], v[164:167]
    ds_read_b64_tr_b16 v[84:85], v23 offset:40960
    v_mfma_f32_16x16x32_bf16 v[180:183], v[68:71], v[44:47], v[180:183]
    ds_read_b64_tr_b16 v[86:87], v23 offset:41984
    v_mfma_f32_16x16x32_bf16 v[136:139], v[72:75], v[32:35], v[136:139]
    ds_read_b64_tr_b16 v[88:89], v24 offset:40960
    v_mfma_f32_16x16x32_bf16 v[152:155], v[72:75], v[36:39], v[152:155]
    ds_read_b64_tr_b16 v[90:91], v24 offset:41984
    v_mfma_f32_16x16x32_bf16 v[168:171], v[72:75], v[40:43], v[168:171]
    ds_read_b64_tr_b16 v[92:93], v25 offset:40960
    v_mfma_f32_16x16x32_bf16 v[184:187], v[72:75], v[44:47], v[184:187]
    ds_read_b64_tr_b16 v[94:95], v25 offset:41984
    v_mfma_f32_16x16x32_bf16 v[140:143], v[76:79], v[32:35], v[140:143]
    v_mfma_f32_16x16x32_bf16 v[156:159], v[76:79], v[36:39], v[156:159]
    v_mfma_f32_16x16x32_bf16 v[172:175], v[76:79], v[40:43], v[172:175]
    v_mfma_f32_16x16x32_bf16 v[188:191], v[76:79], v[44:47], v[188:191]
    v_mfma_f32_16x16x32_bf16 v[192:195], v[120:123], v[32:35], v[192:195]
    v_mfma_f32_16x16x32_bf16 v[200:203], v[32:35], v[32:35], v[200:203]
    v_mfma_f32_16x16x32_bf16 v[208:211], v[64:67], v[120:123], v[208:211]
    v_mfma_f32_16x16x32_bf16 v[196:199], v[120:123], v[36:39], v[196:199]
    v_mfma_f32_16x16x32_bf16 v[204:207], v[36:39], v[36:39], v[204:207]
    v_mfma_f32_16x16x32_bf16 v[212:215], v[68:71], v[120:123], v[212:215]
    s_waitcnt lgkmcnt(0)
    s_barrier
    v_mfma_f32_16x16x32_bf16 v[128:131], v[80:83], v[48:51], v[128:131]
    v_add_u32 v14, 0x10000, v14
    v_add_u32 v15, 0x10000, v15
    v_mfma_f32_16x16x32_bf16 v[144:147], v[80:83], v[52:55], v[144:147]
    v_add_u32 v16, 0x10000, v16
    v_add_u32 v17, 0x10000, v17
    v_mfma_f32_16x16x32_bf16 v[160:163], v[80:83], v[56:59], v[160:163]
    v_add_u32 v22, 0x10000, v22
    v_add_u32 v23, 0x10000, v23
    v_mfma_f32_16x16x32_bf16 v[176:179], v[80:83], v[60:63], v[176:179]
    v_add_u32 v24, 0x10000, v24
    v_add_u32 v25, 0x10000, v25
    v_mfma_f32_16x16x32_bf16 v[132:135], v[84:87], v[48:51], v[132:135]
    ds_read_b128 v[32:35], v14 offset:0
    ds_read_b128 v[36:39], v14 offset:2048
    v_mfma_f32_16x16x32_bf16 v[148:151], v[84:87], v[52:55], v[148:151]
    ds_read_b128 v[40:43], v15 offset:4096
    ds_read_b128 v[44:47], v15 offset:6144
    v_mfma_f32_16x16x32_bf16 v[164:167], v[84:87], v[56:59], v[164:167]
    ds_read_b64_tr_b16 v[64:65], v22 offset:0
    ds_read_b64_tr_b16 v[66:67], v22 offset:1024
    v_mfma_f32_16x16x32_bf16 v[180:183], v[84:87], v[60:63], v[180:183]
    ds_read_b64_tr_b16 v[68:69], v23 offset:0
    ds_read_b64_tr_b16 v[70:71], v23 offset:1024
    v_mfma_f32_16x16x32_bf16 v[136:139], v[88:91], v[48:51], v[136:139]
    ds_read_b64_tr_b16 v[72:73], v24 offset:0
    ds_read_b64_tr_b16 v[74:75], v24 offset:1024
    v_mfma_f32_16x16x32_bf16 v[152:155], v[88:91], v[52:55], v[152:155]
    ds_read_b64_tr_b16 v[76:77], v25 offset:0
    ds_read_b64_tr_b16 v[78:79], v25 offset:1024
    v_mfma_f32_16x16x32_bf16 v[168:171], v[88:91], v[56:59], v[168:171]
    v_mfma_f32_16x16x32_bf16 v[184:187], v[88:91], v[60:63], v[184:187]
    v_mfma_f32_16x16x32_bf16 v[140:143], v[92:95], v[48:51], v[140:143]
    v_mfma_f32_16x16x32_bf16 v[156:159], v[92:95], v[52:55], v[156:159]
    v_mfma_f32_16x16x32_bf16 v[172:175], v[92:95], v[56:59], v[172:175]
    v_mfma_f32_16x16x32_bf16 v[188:191], v[92:95], v[60:63], v[188:191]
    v_mfma_f32_16x16x32_bf16 v[192:195], v[120:123], v[48:51], v[192:195]
    v_mfma_f32_16x16x32_bf16 v[200:203], v[48:51], v[48:51], v[200:203]
    v_mfma_f32_16x16x32_bf16 v[208:211], v[80:83], v[120:123], v[208:211]
    v_mfma_f32_16x16x32_bf16 v[196:199], v[120:123], v[52:55], v[196:199]
    v_mfma_f32_16x16x32_bf16 v[204:207], v[52:55], v[52:55], v[204:207]
    v_mfma_f32_16x16x32_bf16 v[212:215], v[84:87], v[120:123], v[212:215]
    s_waitcnt lgkmcnt(0)
    v_mfma_f32_16x16x32_bf16 v[128:131], v[64:67], v[32:35], v[128:131]
    ds_read_b128 v[48:51], v16 offset:0
    v_mfma_f32_16x16x32_bf16 v[144:147], v[64:67], v[36:39], v[144:147]
    ds_read_b128 v[52:55], v16 offset:2048
    v_mfma_f32_16x16x32_bf16 v[160:163], v[64:67], v[40:43], v[160:163]
    ds_read_b128 v[56:59], v17 offset:4096
    v_mfma_f32_16x16x32_bf16 v[176:179], v[64:67], v[44:47], v[176:179]
    ds_read_b128 v[60:63], v17 offset:6144
    v_mfma_f32_16x16x32_bf16 v[132:135], v[68:71], v[32:35], v[132:135]
    ds_read_b64_tr_b16 v[80:81], v22 offset:8192
    v_mfma_f32_16x16x32_bf16 v[148:151], v[68:71], v[36:39], v[148:151]
    ds_read_b64_tr_b16 v[82:83], v22 offset:9216
    v_mfma_f32_16x16x32_bf16 v[164:167], v[68:71], v[40:43], v[164:167]
    ds_read_b64_tr_b16 v[84:85], v23 offset:8192
    v_mfma_f32_16x16x32_bf16 v[180:183], v[68:71], v[44:47], v[180:183]
    ds_read_b64_tr_b16 v[86:87], v23 offset:9216
    v_mfma_f32_16x16x32_bf16 v[136:139], v[72:75], v[32:35], v[136:139]
    ds_read_b64_tr_b16 v[88:89], v24 offset:8192
    v_mfma_f32_16x16x32_bf16 v[152:155], v[72:75], v[36:39], v[152:155]
    ds_read_b64_tr_b16 v[90:91], v24 offset:9216
    v_mfma_f32_16x16x32_bf16 v[168:171], v[72:75], v[40:43], v[168:171]
    ds_read_b64_tr_b16 v[92:93], v25 offset:8192
    v_mfma_f32_16x16x32_bf16 v[184:187], v[72:75], v[44:47], v[184:187]
    ds_read_b64_tr_b16 v[94:95], v25 offset:9216
    v_mfma_f32_16x16x32_bf16 v[140:143], v[76:79], v[32:35], v[140:143]
    v_mfma_f32_16x16x32_bf16 v[156:159], v[76:79], v[36:39], v[156:159]
    v_mfma_f32_16x16x32_bf16 v[172:175], v[76:79], v[40:43], v[172:175]
    v_mfma_f32_16x16x32_bf16 v[188:191], v[76:79], v[44:47], v[188:191]
    v_mfma_f32_16x16x32_bf16 v[192:195], v[120:123], v[32:35], v[192:195]
    v_mfma_f32_16x16x32_bf16 v[200:203], v[32:35], v[32:35], v[200:203]
    v_mfma_f32_16x16x32_bf16 v[208:211], v[64:67], v[120:123], v[208:211]
    v_mfma_f32_16x16x32_bf16 v[196:199], v[120:123], v[36:39], v[196:199]
    v_mfma_f32_16x16x32_bf16 v[204:207], v[36:39], v[36:39], v[204:207]
    v_mfma_f32_16x16x32_bf16 v[212:215], v[68:71], v[120:123], v[212:215]
    s_waitcnt lgkmcnt(0)
    s_barrier
    v_mfma_f32_16x16x32_bf16 v[128:131], v[80:83], v[48:51], v[128:131]
    ds_read_b128 v[32:35], v14 offset:32768
    v_mfma_f32_16x16x32_bf16 v[144:147], v[80:83], v[52:55], v[144:147]
    ds_read_b128 v[36:39], v14 offset:34816
    v_mfma_f32_16x16x32_bf16 v[160:163], v[80:83], v[56:59], v[160:163]
    ds_read_b128 v[40:43], v15 offset:36864
    v_mfma_f32_16x16x32_bf16 v[176:179], v[80:83], v[60:63], v[176:179]
    ds_read_b128 v[44:47], v15 offset:38912
    v_mfma_f32_16x16x32_bf16 v[132:135], v[84:87], v[48:51], v[132:135]
    ds_read_b64_tr_b16 v[64:65], v22 offset:32768
    v_mfma_f32_16x16x32_bf16 v[148:151], v[84:87], v[52:55], v[148:151]
    ds_read_b64_tr_b16 v[66:67], v22 offset:33792
    v_mfma_f32_16x16x32_bf16 v[164:167], v[84:87], v[56:59], v[164:167]
    ds_read_b64_tr_b16 v[68:69], v23 offset:32768
    v_mfma_f32_16x16x32_bf16 v[180:183], v[84:87], v[60:63], v[180:183]
    ds_read_b64_tr_b16 v[70:71], v23 offset:33792
    v_mfma_f32_16x16x32_bf16 v[136:139], v[88:91], v[48:51], v[136:139]
    ds_read_b64_tr_b16 v[72:73], v24 offset:32768
    v_mfma_f32_16x16x32_bf16 v[152:155], v[88:91], v[52:55], v[152:155]
    ds_read_b64_tr_b16 v[74:75], v24 offset:33792
    v_mfma_f32_16x16x32_bf16 v[168:171], v[88:91], v[56:59], v[168:171]
    ds_read_b64_tr_b16 v[76:77], v25 offset:32768
    v_mfma_f32_16x16x32_bf16 v[184:187], v[88:91], v[60:63], v[184:187]
    ds_read_b64_tr_b16 v[78:79], v25 offset:33792
    v_mfma_f32_16x16x32_bf16 v[140:143], v[92:95], v[48:51], v[140:143]
    v_mfma_f32_16x16x32_bf16 v[156:159], v[92:95], v[52:55], v[156:159]
    v_mfma_f32_16x16x32_bf16 v[172:175], v[92:95], v[56:59], v[172:175]
    v_mfma_f32_16x16x32_bf16 v[188:191], v[92:95], v[60:63], v[188:191]
    v_mfma_f32_16x16x32_bf16 v[192:195], v[120:123], v[48:51], v[192:195]
    v_mfma_f32_16x16x32_bf16 v[200:203], v[48:51], v[48:51], v[200:203]
    v_mfma_f32_16x16x32_bf16 v[208:211], v[80:83], v[120:123], v[208:211]
    v_mfma_f32_16x16x32_bf16 v[196:199], v[120:123], v[52:55], v[196:199]
    v_mfma_f32_16x16x32_bf16 v[204:207], v[52:55], v[52:55], v[204:207]
    v_mfma_f32_16x16x32_bf16 v[212:215], v[84:87], v[120:123], v[212:215]
    s_waitcnt lgkmcnt(0)
    v_mfma_f32_16x16x32_bf16 v[128:131], v[64:67], v[32:35], v[128:131]
    ds_read_b128 v[48:51], v16 offset:32768
    v_mfma_f32_16x16x32_bf16 v[144:147], v[64:67], v[36:39], v[144:147]
    ds_read_b128 v[52:55], v16 offset:34816
    v_mfma_f32_16x16x32_bf16 v[160:163], v[64:67], v[40:43], v[160:163]
    ds_read_b128 v[56:59], v17 offset:36864
    v_mfma_f32_16x16x32_bf16 v[176:179], v[64:67], v[44:47], v[176:179]
    ds_read_b128 v[60:63], v17 offset:38912
    v_mfma_f32_16x16x32_bf16 v[132:135], v[68:71], v[32:35], v[132:135]
    ds_read_b64_tr_b16 v[80:81], v22 offset:40960
    v_mfma_f32_16x16x32_bf16 v[148:151], v[68:71], v[36:39], v[148:151]
    ds_read_b64_tr_b16 v[82:83], v22 offset:41984
    v_mfma_f32_16x16x32_bf16 v[164:167], v[68:71], v[40:43], v[164:167]
    ds_read_b64_tr_b16 v[84:85], v23 offset:40960
    v_mfma_f32_16x16x32_bf16 v[180:183], v[68:71], v[44:47], v[180:183]
    ds_read_b64_tr_b16 v[86:87], v23 offset:41984
    v_mfma_f32_16x16x32_bf16 v[136:139], v[72:75], v[32:35], v[136:139]
    ds_read_b64_tr_b16 v[88:89], v24 offset:40960
    v_mfma_f32_16x16x32_bf16 v[152:155], v[72:75], v[36:39], v[152:155]
    ds_read_b64_tr_b16 v[90:91], v24 offset:41984
    v_mfma_f32_16x16x32_bf16 v[168:171], v[72:75], v[40:43], v[168:171]
    ds_read_b64_tr_b16 v[92:93], v25 offset:40960
    v_mfma_f32_16x16x32_bf16 v[184:187], v[72:75], v[44:47], v[184:187]
    ds_read_b64_tr_b16 v[94:95], v25 offset:41984
    v_mfma_f32_16x16x32_bf16 v[140:143], v[76:79], v[32:35], v[140:143]
    v_mfma_f32_16x16x32_bf16 v[156:159], v[76:79], v[36:39], v[156:159]
    v_mfma_f32_16x16x32_bf16 v[172:175], v[76:79], v[40:43], v[172:175]
    v_mfma_f32_16x16x32_bf16 v[188:191], v[76:79], v[44:47], v[188:191]
    v_mfma_f32_16x16x32_bf16 v[192:195], v[120:123], v[32:35], v[192:195]
    v_mfma_f32_16x16x32_bf16 v[200:203], v[32:35], v[32:35], v[200:203]
    v_mfma_f32_16x16x32_bf16 v[208:211], v[64:67], v[120:123], v[208:211]
    v_mfma_f32_16x16x32_bf16 v[196:199], v[120:123], v[36:39], v[196:199]
    v_mfma_f32_16x16x32_bf16 v[204:207], v[36:39], v[36:39], v[204:207]
    v_mfma_f32_16x16x32_bf16 v[212:215], v[68:71], v[120:123], v[212:215]
    s_waitcnt lgkmcnt(0)
    s_barrier
    v_mfma_f32_16x16x32_bf16 v[128:131], v[80:83], v[48:51], v[128:131]
    v_add_u32 v14, 0xffff0000, v14
    v_add_u32 v15, 0xffff0000, v15
    v_mfma_f32_16x16x32_bf16 v[144:147], v[80:83], v[52:55], v[144:147]
    v_add_u32 v16, 0xffff0000, v16
    v_add_u32 v17, 0xffff0000, v17
    v_mfma_f32_16x16x32_bf16 v[160:163], v[80:83], v[56:59], v[160:163]
    v_add_u32 v22, 0xffff0000, v22
    v_add_u32 v23, 0xffff0000, v23
    v_mfma_f32_16x16x32_bf16 v[176:179], v[80:83], v[60:63], v[176:179]
    v_add_u32 v24, 0xffff0000, v24
    v_add_u32 v25, 0xffff0000, v25
    v_mfma_f32_16x16x32_bf16 v[132:135], v[84:87], v[48:51], v[132:135]
    ds_read_b128 v[32:35], v14 offset:0
    ds_read_b128 v[36:39], v14 offset:2048
    v_mfma_f32_16x16x32_bf16 v[148:151], v[84:87], v[52:55], v[148:151]
    ds_read_b128 v[40:43], v15 offset:4096
    ds_read_b128 v[44:47], v15 offset:6144
    v_mfma_f32_16x16x32_bf16 v[164:167], v[84:87], v[56:59], v[164:167]
    ds_read_b64_tr_b16 v[64:65], v22 offset:0
    ds_read_b64_tr_b16 v[66:67], v22 offset:1024
    v_mfma_f32_16x16x32_bf16 v[180:183], v[84:87], v[60:63], v[180:183]
    ds_read_b64_tr_b16 v[68:69], v23 offset:0
    ds_read_b64_tr_b16 v[70:71], v23 offset:1024
    v_mfma_f32_16x16x32_bf16 v[136:139], v[88:91], v[48:51], v[136:139]
    ds_read_b64_tr_b16 v[72:73], v24 offset:0
    ds_read_b64_tr_b16 v[74:75], v24 offset:1024
    v_mfma_f32_16x16x32_bf16 v[152:155], v[88:91], v[52:55], v[152:155]
    ds_read_b64_tr_b16 v[76:77], v25 offset:0
    ds_read_b64_tr_b16 v[78:79], v25 offset:1024
    v_mfma_f32_16x16x32_bf16 v[168:171], v[88:91], v[56:59], v[168:171]
    v_mfma_f32_16x16x32_bf16 v[184:187], v[88:91], v[60:63], v[184:187]
    v_mfma_f32_16x16x32_bf16 v[140:143], v[92:95], v[48:51], v[140:143]
    v_mfma_f32_16x16x32_bf16 v[156:159], v[92:95], v[52:55], v[156:159]
    v_mfma_f32_16x16x32_bf16 v[172:175], v[92:95], v[56:59], v[172:175]
    v_mfma_f32_16x16x32_bf16 v[188:191], v[92:95], v[60:63], v[188:191]
    v_mfma_f32_16x16x32_bf16 v[192:195], v[120:123], v[48:51], v[192:195]
    v_mfma_f32_16x16x32_bf16 v[200:203], v[48:51], v[48:51], v[200:203]
    v_mfma_f32_16x16x32_bf16 v[208:211], v[80:83], v[120:123], v[208:211]
    v_mfma_f32_16x16x32_bf16 v[196:199], v[120:123], v[52:55], v[196:199]
    v_mfma_f32_16x16x32_bf16 v[204:207], v[52:55], v[52:55], v[204:207]
    v_mfma_f32_16x16x32_bf16 v[212:215], v[84:87], v[120:123], v[212:215]
    s_waitcnt lgkmcnt(0)
    v_mfma_f32_16x16x32_bf16 v[128:131], v[64:67], v[32:35], v[128:131]
    ds_read_b128 v[48:51], v16 offset:0
    v_mfma_f32_16x16x32_bf16 v[144:147], v[64:67], v[36:39], v[144:147]
    ds_read_b128 v[52:55], v16 offset:2048
    v_mfma_f32_16x16x32_bf16 v[160:163], v[64:67], v[40:43], v[160:163]
    ds_read_b128 v[56:59], v17 offset:4096
    v_mfma_f32_16x16x32_bf16 v[176:179], v[64:67], v[44:47], v[176:179]
    ds_read_b128 v[60:63], v17 offset:6144
    v_mfma_f32_16x16x32_bf16 v[132:135], v[68:71], v[32:35], v[132:135]
    ds_read_b64_tr_b16 v[80:81], v22 offset:8192
    v_mfma_f32_16x16x32_bf16 v[148:151], v[68:71], v[36:39], v[148:151]
    ds_read_b64_tr_b16 v[82:83], v22 offset:9216
    v_mfma_f32_16x16x32_bf16 v[164:167], v[68:71], v[40:43], v[164:167]
    ds_read_b64_tr_b16 v[84:85], v23 offset:8192
    v_mfma_f32_16x16x32_bf16 v[180:183], v[68:71], v[44:47], v[180:183]
    ds_read_b64_tr_b16 v[86:87], v23 offset:9216
    v_mfma_f32_16x16x32_bf16 v[136:139], v[72:75], v[32:35], v[136:139]
    ds_read_b64_tr_b16 v[88:89], v24 offset:8192
    v_mfma_f32_16x16x32_bf16 v[152:155], v[72:75], v[36:39], v[152:155]
    ds_read_b64_tr_b16 v[90:91], v24 offset:9216
    v_mfma_f32_16x16x32_bf16 v[168:171], v[72:75], v[40:43], v[168:171]
    ds_read_b64_tr_b16 v[92:93], v25 offset:8192
    v_mfma_f32_16x16x32_bf16 v[184:187], v[72:75], v[44:47], v[184:187]
    ds_read_b64_tr_b16 v[94:95], v25 offset:9216
    v_mfma_f32_16x16x32_bf16 v[140:143], v[76:79], v[32:35], v[140:143]
    v_mfma_f32_16x16x32_bf16 v[156:159], v[76:79], v[36:39], v[156:159]
    v_mfma_f32_16x16x32_bf16 v[172:175], v[76:79], v[40:43], v[172:175]
    v_mfma_f32_16x16x32_bf16 v[188:191], v[76:79], v[44:47], v[188:191]
    v_mfma_f32_16x16x32_bf16 v[192:195], v[120:123], v[32:35], v[192:195]
    v_mfma_f32_16x16x32_bf16 v[200:203], v[32:35], v[32:35], v[200:203]
    v_mfma_f32_16x16x32_bf16 v[208:211], v[64:67], v[120:123], v[208:211]
    v_mfma_f32_16x16x32_bf16 v[196:199], v[120:123], v[36:39], v[196:199]
    v_mfma_f32_16x16x32_bf16 v[204:207], v[36:39], v[36:39], v[204:207]
    v_mfma_f32_16x16x32_bf16 v[212:215], v[68:71], v[120:123], v[212:215]
    s_waitcnt lgkmcnt(0)
    s_barrier
    v_mfma_f32_16x16x32_bf16 v[128:131], v[80:83], v[48:51], v[128:131]
    ds_read_b128 v[32:35], v14 offset:32768
    v_mfma_f32_16x16x32_bf16 v[144:147], v[80:83], v[52:55], v[144:147]
    ds_read_b128 v[36:39], v14 offset:34816
    v_mfma_f32_16x16x32_bf16 v[160:163], v[80:83], v[56:59], v[160:163]
    ds_read_b128 v[40:43], v15 offset:36864
    v_mfma_f32_16x16x32_bf16 v[176:179], v[80:83], v[60:63], v[176:179]
    ds_read_b128 v[44:47], v15 offset:38912
    v_mfma_f32_16x16x32_bf16 v[132:135], v[84:87], v[48:51], v[132:135]
    ds_read_b64_tr_b16 v[64:65], v22 offset:32768
    v_mfma_f32_16x16x32_bf16 v[148:151], v[84:87], v[52:55], v[148:151]
    ds_read_b64_tr_b16 v[66:67], v22 offset:33792
    v_mfma_f32_16x16x32_bf16 v[164:167], v[84:87], v[56:59], v[164:167]
    ds_read_b64_tr_b16 v[68:69], v23 offset:32768
    v_mfma_f32_16x16x32_bf16 v[180:183], v[84:87], v[60:63], v[180:183]
    ds_read_b64_tr_b16 v[70:71], v23 offset:33792
    v_mfma_f32_16x16x32_bf16 v[136:139], v[88:91], v[48:51], v[136:139]
    ds_read_b64_tr_b16 v[72:73], v24 offset:32768
    v_mfma_f32_16x16x32_bf16 v[152:155], v[88:91], v[52:55], v[152:155]
    ds_read_b64_tr_b16 v[74:75], v24 offset:33792
    v_mfma_f32_16x16x32_bf16 v[168:171], v[88:91], v[56:59], v[168:171]
    ds_read_b64_tr_b16 v[76:77], v25 offset:32768
    v_mfma_f32_16x16x32_bf16 v[184:187], v[88:91], v[60:63], v[184:187]
    ds_read_b64_tr_b16 v[78:79], v25 offset:33792
    v_mfma_f32_16x16x32_bf16 v[140:143], v[92:95], v[48:51], v[140:143]
    v_mfma_f32_16x16x32_bf16 v[156:159], v[92:95], v[52:55], v[156:159]
    v_mfma_f32_16x16x32_bf16 v[172:175], v[92:95], v[56:59], v[172:175]
    v_mfma_f32_16x16x32_bf16 v[188:191], v[92:95], v[60:63], v[188:191]
    v_mfma_f32_16x16x32_bf16 v[192:195], v[120:123], v[48:51], v[192:195]
    v_mfma_f32_16x16x32_bf16 v[200:203], v[48:51], v[48:51], v[200:203]
    v_mfma_f32_16x16x32_bf16 v[208:211], v[80:83], v[120:123], v[208:211]
    v_mfma_f32_16x16x32_bf16 v[196:199], v[120:123], v[52:55], v[196:199]
    v_mfma_f32_16x16x32_bf16 v[204:207], v[52:55], v[52:55], v[204:207]
    v_mfma_f32_16x16x32_bf16 v[212:215], v[84:87], v[120:123], v[212:215]
    s_waitcnt lgkmcnt(0)
    v_mfma_f32_16x16x32_bf16 v[128:131], v[64:67], v[32:35], v[128:131]
    ds_read_b128 v[48:51], v16 offset:32768
    v_mfma_f32_16x16x32_bf16 v[144:147], v[64:67], v[36:39], v[144:147]
    ds_read_b128 v[52:55], v16 offset:34816
    v_mfma_f32_16x16x32_bf16 v[160:163], v[64:67], v[40:43], v[160:163]
    ds_read_b128 v[56:59], v17 offset:36864
    v_mfma_f32_16x16x32_bf16 v[176:179], v[64:67], v[44:47], v[176:179]
    ds_read_b128 v[60:63], v17 offset:38912
    v_mfma_f32_16x16x32_bf16 v[132:135], v[68:71], v[32:35], v[132:135]
    ds_read_b64_tr_b16 v[80:81], v22 offset:40960
    v_mfma_f32_16x16x32_bf16 v[148:151], v[68:71], v[36:39], v[148:151]
    ds_read_b64_tr_b16 v[82:83], v22 offset:41984
    v_mfma_f32_16x16x32_bf16 v[164:167], v[68:71], v[40:43], v[164:167]
    ds_read_b64_tr_b16 v[84:85], v23 offset:40960
    v_mfma_f32_16x16x32_bf16 v[180:183], v[68:71], v[44:47], v[180:183]
    ds_read_b64_tr_b16 v[86:87], v23 offset:41984
    v_mfma_f32_16x16x32_bf16 v[136:139], v[72:75], v[32:35], v[136:139]
    ds_read_b64_tr_b16 v[88:89], v24 offset:40960
    v_mfma_f32_16x16x32_bf16 v[152:155], v[72:75], v[36:39], v[152:155]
    ds_read_b64_tr_b16 v[90:91], v24 offset:41984
    v_mfma_f32_16x16x32_bf16 v[168:171], v[72:75], v[40:43], v[168:171]
    ds_read_b64_tr_b16 v[92:93], v25 offset:40960
    v_mfma_f32_16x16x32_bf16 v[184:187], v[72:75], v[44:47], v[184:187]
    ds_read_b64_tr_b16 v[94:95], v25 offset:41984
    v_mfma_f32_16x16x32_bf16 v[140:143], v[76:79], v[32:35], v[140:143]
    v_mfma_f32_16x16x32_bf16 v[156:159], v[76:79], v[36:39], v[156:159]
    v_mfma_f32_16x16x32_bf16 v[172:175], v[76:79], v[40:43], v[172:175]
    v_mfma_f32_16x16x32_bf16 v[188:191], v[76:79], v[44:47], v[188:191]
    v_mfma_f32_16x16x32_bf16 v[192:195], v[120:123], v[32:35], v[192:195]
    v_mfma_f32_16x16x32_bf16 v[200:203], v[32:35], v[32:35], v[200:203]
    v_mfma_f32_16x16x32_bf16 v[208:211], v[64:67], v[120:123], v[208:211]
    v_mfma_f32_16x16x32_bf16 v[196:199], v[120:123], v[36:39], v[196:199]
    v_mfma_f32_16x16x32_bf16 v[204:207], v[36:39], v[36:39], v[204:207]
    v_mfma_f32_16x16x32_bf16 v[212:215], v[68:71], v[120:123], v[212:215]
    s_waitcnt lgkmcnt(0)
    s_barrier
    v_mfma_f32_16x16x32_bf16 v[128:131], v[80:83], v[48:51], v[128:131]
    v_add_u32 v14, 0x10000, v14
    v_add_u32 v15, 0x10000, v15
    v_mfma_f32_16x16x32_bf16 v[144:147], v[80:83], v[52:55], v[144:147]
    v_add_u32 v16, 0x10000, v16
    v_add_u32 v17, 0x10000, v17
    v_mfma_f32_16x16x32_bf16 v[160:163], v[80:83], v[56:59], v[160:163]
    v_add_u32 v22, 0x10000, v22
    v_add_u32 v23, 0x10000, v23
    v_mfma_f32_16x16x32_bf16 v[176:179], v[80:83], v[60:63], v[176:179]
    v_add_u32 v24, 0x10000, v24
    v_add_u32 v25, 0x10000, v25
    v_mfma_f32_16x16x32_bf16 v[132:135], v[84:87], v[48:51], v[132:135]
    ds_read_b128 v[32:35], v14 offset:0
    ds_read_b128 v[36:39], v14 offset:2048
    v_mfma_f32_16x16x32_bf16 v[148:151], v[84:87], v[52:55], v[148:151]
    ds_read_b128 v[40:43], v15 offset:4096
    ds_read_b128 v[44:47], v15 offset:6144
    v_mfma_f32_16x16x32_bf16 v[164:167], v[84:87], v[56:59], v[164:167]
    ds_read_b64_tr_b16 v[64:65], v22 offset:0
    ds_read_b64_tr_b16 v[66:67], v22 offset:1024
    v_mfma_f32_16x16x32_bf16 v[180:183], v[84:87], v[60:63], v[180:183]
    ds_read_b64_tr_b16 v[68:69], v23 offset:0
    ds_read_b64_tr_b16 v[70:71], v23 offset:1024
    v_mfma_f32_16x16x32_bf16 v[136:139], v[88:91], v[48:51], v[136:139]
    ds_read_b64_tr_b16 v[72:73], v24 offset:0
    ds_read_b64_tr_b16 v[74:75], v24 offset:1024
    v_mfma_f32_16x16x32_bf16 v[152:155], v[88:91], v[52:55], v[152:155]
    ds_read_b64_tr_b16 v[76:77], v25 offset:0
    ds_read_b64_tr_b16 v[78:79], v25 offset:1024
    v_mfma_f32_16x16x32_bf16 v[168:171], v[88:91], v[56:59], v[168:171]
    v_mfma_f32_16x16x32_bf16 v[184:187], v[88:91], v[60:63], v[184:187]
    v_mfma_f32_16x16x32_bf16 v[140:143], v[92:95], v[48:51], v[140:143]
    v_mfma_f32_16x16x32_bf16 v[156:159], v[92:95], v[52:55], v[156:159]
    v_mfma_f32_16x16x32_bf16 v[172:175], v[92:95], v[56:59], v[172:175]
    v_mfma_f32_16x16x32_bf16 v[188:191], v[92:95], v[60:63], v[188:191]
    v_mfma_f32_16x16x32_bf16 v[192:195], v[120:123], v[48:51], v[192:195]
    v_mfma_f32_16x16x32_bf16 v[200:203], v[48:51], v[48:51], v[200:203]
    v_mfma_f32_16x16x32_bf16 v[208:211], v[80:83], v[120:123], v[208:211]
    v_mfma_f32_16x16x32_bf16 v[196:199], v[120:123], v[52:55], v[196:199]
    v_mfma_f32_16x16x32_bf16 v[204:207], v[52:55], v[52:55], v[204:207]
    v_mfma_f32_16x16x32_bf16 v[212:215], v[84:87], v[120:123], v[212:215]
    s_waitcnt lgkmcnt(0)
    v_mfma_f32_16x16x32_bf16 v[128:131], v[64:67], v[32:35], v[128:131]
    ds_read_b128 v[48:51], v16 offset:0
    v_mfma_f32_16x16x32_bf16 v[144:147], v[64:67], v[36:39], v[144:147]
    ds_read_b128 v[52:55], v16 offset:2048
    v_mfma_f32_16x16x32_bf16 v[160:163], v[64:67], v[40:43], v[160:163]
    ds_read_b128 v[56:59], v17 offset:4096
    v_mfma_f32_16x16x32_bf16 v[176:179], v[64:67], v[44:47], v[176:179]
    ds_read_b128 v[60:63], v17 offset:6144
    v_mfma_f32_16x16x32_bf16 v[132:135], v[68:71], v[32:35], v[132:135]
    ds_read_b64_tr_b16 v[80:81], v22 offset:8192
    v_mfma_f32_16x16x32_bf16 v[148:151], v[68:71], v[36:39], v[148:151]
    ds_read_b64_tr_b16 v[82:83], v22 offset:9216
    v_mfma_f32_16x16x32_bf16 v[164:167], v[68:71], v[40:43], v[164:167]
    ds_read_b64_tr_b16 v[84:85], v23 offset:8192
    v_mfma_f32_16x16x32_bf16 v[180:183], v[68:71], v[44:47], v[180:183]
    ds_read_b64_tr_b16 v[86:87], v23 offset:9216
    v_mfma_f32_16x16x32_bf16 v[136:139], v[72:75], v[32:35], v[136:139]
    ds_read_b64_tr_b16 v[88:89], v24 offset:8192
    v_mfma_f32_16x16x32_bf16 v[152:155], v[72:75], v[36:39], v[152:155]
    ds_read_b64_tr_b16 v[90:91], v24 offset:9216
    v_mfma_f32_16x16x32_bf16 v[168:171], v[72:75], v[40:43], v[168:171]
    ds_read_b64_tr_b16 v[92:93], v25 offset:8192
    v_mfma_f32_16x16x32_bf16 v[184:187], v[72:75], v[44:47], v[184:187]
    ds_read_b64_tr_b16 v[94:95], v25 offset:9216
    v_mfma_f32_16x16x32_bf16 v[140:143], v[76:79], v[32:35], v[140:143]
    v_mfma_f32_16x16x32_bf16 v[156:159], v[76:79], v[36:39], v[156:159]
    v_mfma_f32_16x16x32_bf16 v[172:175], v[76:79], v[40:43], v[172:175]
    v_mfma_f32_16x16x32_bf16 v[188:191], v[76:79], v[44:47], v[188:191]
    v_mfma_f32_16x16x32_bf16 v[192:195], v[120:123], v[32:35], v[192:195]
    v_mfma_f32_16x16x32_bf16 v[200:203], v[32:35], v[32:35], v[200:203]
    v_mfma_f32_16x16x32_bf16 v[208:211], v[64:67], v[120:123], v[208:211]
    v_mfma_f32_16x16x32_bf16 v[196:199], v[120:123], v[36:39], v[196:199]
    v_mfma_f32_16x16x32_bf16 v[204:207], v[36:39], v[36:39], v[204:207]
    v_mfma_f32_16x16x32_bf16 v[212:215], v[68:71], v[120:123], v[212:215]
    s_waitcnt lgkmcnt(0)
    s_barrier
    v_mfma_f32_16x16x32_bf16 v[128:131], v[80:83], v[48:51], v[128:131]
    ds_read_b128 v[32:35], v14 offset:32768
    v_mfma_f32_16x16x32_bf16 v[144:147], v[80:83], v[52:55], v[144:147]
    ds_read_b128 v[36:39], v14 offset:34816
    v_mfma_f32_16x16x32_bf16 v[160:163], v[80:83], v[56:59], v[160:163]
    ds_read_b128 v[40:43], v15 offset:36864
    v_mfma_f32_16x16x32_bf16 v[176:179], v[80:83], v[60:63], v[176:179]
    ds_read_b128 v[44:47], v15 offset:38912
    v_mfma_f32_16x16x32_bf16 v[132:135], v[84:87], v[48:51], v[132:135]
    ds_read_b64_tr_b16 v[64:65], v22 offset:32768
    v_mfma_f32_16x16x32_bf16 v[148:151], v[84:87], v[52:55], v[148:151]
    ds_read_b64_tr_b16 v[66:67], v22 offset:33792
    v_mfma_f32_16x16x32_bf16 v[164:167], v[84:87], v[56:59], v[164:167]
    ds_read_b64_tr_b16 v[68:69], v23 offset:32768
    v_mfma_f32_16x16x32_bf16 v[180:183], v[84:87], v[60:63], v[180:183]
    ds_read_b64_tr_b16 v[70:71], v23 offset:33792
    v_mfma_f32_16x16x32_bf16 v[136:139], v[88:91], v[48:51], v[136:139]
    ds_read_b64_tr_b16 v[72:73], v24 offset:32768
    v_mfma_f32_16x16x32_bf16 v[152:155], v[88:91], v[52:55], v[152:155]
    ds_read_b64_tr_b16 v[74:75], v24 offset:33792
    v_mfma_f32_16x16x32_bf16 v[168:171], v[88:91], v[56:59], v[168:171]
    ds_read_b64_tr_b16 v[76:77], v25 offset:32768
    v_mfma_f32_16x16x32_bf16 v[184:187], v[88:91], v[60:63], v[184:187]
    ds_read_b64_tr_b16 v[78:79], v25 offset:33792
    v_mfma_f32_16x16x32_bf16 v[140:143], v[92:95], v[48:51], v[140:143]
    v_mfma_f32_16x16x32_bf16 v[156:159], v[92:95], v[52:55], v[156:159]
    v_mfma_f32_16x16x32_bf16 v[172:175], v[92:95], v[56:59], v[172:175]
    v_mfma_f32_16x16x32_bf16 v[188:191], v[92:95], v[60:63], v[188:191]
    v_mfma_f32_16x16x32_bf16 v[192:195], v[120:123], v[48:51], v[192:195]
    v_mfma_f32_16x16x32_bf16 v[200:203], v[48:51], v[48:51], v[200:203]
    v_mfma_f32_16x16x32_bf16 v[208:211], v[80:83], v[120:123], v[208:211]
    v_mfma_f32_16x16x32_bf16 v[196:199], v[120:123], v[52:55], v[196:199]
    v_mfma_f32_16x16x32_bf16 v[204:207], v[52:55], v[52:55], v[204:207]
    v_mfma_f32_16x16x32_bf16 v[212:215], v[84:87], v[120:123], v[212:215]
    s_waitcnt lgkmcnt(0)
    v_mfma_f32_16x16x32_bf16 v[128:131], v[64:67], v[32:35], v[128:131]
    ds_read_b128 v[48:51], v16 offset:32768
    v_mfma_f32_16x16x32_bf16 v[144:147], v[64:67], v[36:39], v[144:147]
    ds_read_b128 v[52:55], v16 offset:34816
    v_mfma_f32_16x16x32_bf16 v[160:163], v[64:67], v[40:43], v[160:163]
    ds_read_b128 v[56:59], v17 offset:36864
    v_mfma_f32_16x16x32_bf16 v[176:179], v[64:67], v[44:47], v[176:179]
    ds_read_b128 v[60:63], v17 offset:38912
    v_mfma_f32_16x16x32_bf16 v[132:135], v[68:71], v[32:35], v[132:135]
    ds_read_b64_tr_b16 v[80:81], v22 offset:40960
    v_mfma_f32_16x16x32_bf16 v[148:151], v[68:71], v[36:39], v[148:151]
    ds_read_b64_tr_b16 v[82:83], v22 offset:41984
    v_mfma_f32_16x16x32_bf16 v[164:167], v[68:71], v[40:43], v[164:167]
    ds_read_b64_tr_b16 v[84:85], v23 offset:40960
    v_mfma_f32_16x16x32_bf16 v[180:183], v[68:71], v[44:47], v[180:183]
    ds_read_b64_tr_b16 v[86:87], v23 offset:41984
    v_mfma_f32_16x16x32_bf16 v[136:139], v[72:75], v[32:35], v[136:139]
    ds_read_b64_tr_b16 v[88:89], v24 offset:40960
    v_mfma_f32_16x16x32_bf16 v[152:155], v[72:75], v[36:39], v[152:155]
    ds_read_b64_tr_b16 v[90:91], v24 offset:41984
    v_mfma_f32_16x16x32_bf16 v[168:171], v[72:75], v[40:43], v[168:171]
    ds_read_b64_tr_b16 v[92:93], v25 offset:40960
    v_mfma_f32_16x16x32_bf16 v[184:187], v[72:75], v[44:47], v[184:187]
    ds_read_b64_tr_b16 v[94:95], v25 offset:41984
    v_mfma_f32_16x16x32_bf16 v[140:143], v[76:79], v[32:35], v[140:143]
    v_mfma_f32_16x16x32_bf16 v[156:159], v[76:79], v[36:39], v[156:159]
    v_mfma_f32_16x16x32_bf16 v[172:175], v[76:79], v[40:43], v[172:175]
    v_mfma_f32_16x16x32_bf16 v[188:191], v[76:79], v[44:47], v[188:191]
    v_mfma_f32_16x16x32_bf16 v[192:195], v[120:123], v[32:35], v[192:195]
    v_mfma_f32_16x16x32_bf16 v[200:203], v[32:35], v[32:35], v[200:203]
    v_mfma_f32_16x16x32_bf16 v[208:211], v[64:67], v[120:123], v[208:211]
    v_mfma_f32_16x16x32_bf16 v[196:199], v[120:123], v[36:39], v[196:199]
    v_mfma_f32_16x16x32_bf16 v[204:207], v[36:39], v[36:39], v[204:207]
    v_mfma_f32_16x16x32_bf16 v[212:215], v[68:71], v[120:123], v[212:215]
    s_waitcnt lgkmcnt(0)
    v_mfma_f32_16x16x32_bf16 v[128:131], v[80:83], v[48:51], v[128:131]
    v_mfma_f32_16x16x32_bf16 v[144:147], v[80:83], v[52:55], v[144:147]
    v_mfma_f32_16x16x32_bf16 v[160:163], v[80:83], v[56:59], v[160:163]
    v_mfma_f32_16x16x32_bf16 v[176:179], v[80:83], v[60:63], v[176:179]
    v_mfma_f32_16x16x32_bf16 v[132:135], v[84:87], v[48:51], v[132:135]
    v_mfma_f32_16x16x32_bf16 v[148:151], v[84:87], v[52:55], v[148:151]
    v_mfma_f32_16x16x32_bf16 v[164:167], v[84:87], v[56:59], v[164:167]
    v_mfma_f32_16x16x32_bf16 v[180:183], v[84:87], v[60:63], v[180:183]
    v_mfma_f32_16x16x32_bf16 v[136:139], v[88:91], v[48:51], v[136:139]
    v_mfma_f32_16x16x32_bf16 v[152:155], v[88:91], v[52:55], v[152:155]
    v_mfma_f32_16x16x32_bf16 v[168:171], v[88:91], v[56:59], v[168:171]
    v_mfma_f32_16x16x32_bf16 v[184:187], v[88:91], v[60:63], v[184:187]
    v_mfma_f32_16x16x32_bf16 v[140:143], v[92:95], v[48:51], v[140:143]
    v_mfma_f32_16x16x32_bf16 v[156:159], v[92:95], v[52:55], v[156:159]
    v_mfma_f32_16x16x32_bf16 v[172:175], v[92:95], v[56:59], v[172:175]
    v_mfma_f32_16x16x32_bf16 v[188:191], v[92:95], v[60:63], v[188:191]
    v_mfma_f32_16x16x32_bf16 v[192:195], v[120:123], v[48:51], v[192:195]
    v_mfma_f32_16x16x32_bf16 v[200:203], v[48:51], v[48:51], v[200:203]
    v_mfma_f32_16x16x32_bf16 v[208:211], v[80:83], v[120:123], v[208:211]
    v_mfma_f32_16x16x32_bf16 v[196:199], v[120:123], v[52:55], v[196:199]
    v_mfma_f32_16x16x32_bf16 v[204:207], v[52:55], v[52:55], v[204:207]
    v_mfma_f32_16x16x32_bf16 v[212:215], v[84:87], v[120:123], v[212:215]
    s_nop 7
    v_and_b32 v28, 3, v2
    v_lshrrev_b32 v29, 2, v2
    v_mov_b32 v120, v192
    v_mov_b32 v121, v200
    v_cmp_eq_u32 vcc, 1, v28
    s_nop 1
    v_cndmask_b32 v121, v121, v201, vcc
    v_cmp_eq_u32 vcc, 2, v28
    s_nop 1
    v_cndmask_b32 v121, v121, v202, vcc
    v_cmp_eq_u32 vcc, 3, v28
    s_nop 1
    v_cndmask_b32 v121, v121, v203, vcc
    v_cmp_eq_u32 vcc, v29, v3
    v_mov_b32 v52, 0
    s_nop 1
    v_cndmask_b32 v121, v52, v121, vcc
    v_mov_b32 v30, v121
    v_mov_b32 v31, v121
    s_nop 1
    v_permlane16_swap_b32 v30, v31
    s_nop 1
    v_add_f32 v121, v30, v31
    s_nop 0
    v_mov_b32 v30, v121
    v_mov_b32 v31, v121
    s_nop 1
    v_permlane32_swap_b32 v30, v31
    s_nop 1
    v_add_f32 v121, v30, v31
    v_mov_b32 v122, v196
    v_mov_b32 v123, v204
    v_cmp_eq_u32 vcc, 1, v28
    s_nop 1
    v_cndmask_b32 v123, v123, v205, vcc
    v_cmp_eq_u32 vcc, 2, v28
    s_nop 1
    v_cndmask_b32 v123, v123, v206, vcc
    v_cmp_eq_u32 vcc, 3, v28
    s_nop 1
    v_cndmask_b32 v123, v123, v207, vcc
    v_cmp_eq_u32 vcc, v29, v3
    v_mov_b32 v52, 0
    s_nop 1
    v_cndmask_b32 v123, v52, v123, vcc
    v_mov_b32 v30, v123
    v_mov_b32 v31, v123
    s_nop 1
    v_permlane16_swap_b32 v30, v31
    s_nop 1
    v_add_f32 v123, v30, v31
    s_nop 0
    v_mov_b32 v30, v123
    v_mov_b32 v31, v123
    s_nop 1
    v_permlane32_swap_b32 v30, v31
    s_nop 1
    v_add_f32 v123, v30, v31
    s_lshl_b32 s34, s31, 6
    s_lshl_b32 s35, s32, 5
    s_add_u32 s34, s34, s35
    v_add_u32 v28, s34, v2
    v_lshlrev_b32 v28, 3, v28
    v_add_u32 v28, 0x20000, v28
    v_mul_f32 v32, 0x3b000000, v120
    v_mul_f32 v30, 0x3b000000, v121
    v_fma_f32 v30, -v32, v32, v30
    v_max_f32 v30, 0, v30
    v_add_f32 v30, 0x3727c5ac, v30
    v_rsq_f32 v33, v30
    s_nop 0
    ds_write_b64 v28, v[32:33] offset:0
    v_mul_f32 v34, 0x3b000000, v122
    v_mul_f32 v30, 0x3b000000, v123
    v_fma_f32 v30, -v34, v34, v30
    v_max_f32 v30, 0, v30
    v_add_f32 v30, 0x3727c5ac, v30
    v_rsq_f32 v35, v30
    s_nop 0
    ds_write_b64 v28, v[34:35] offset:128
    s_lshl_b32 s34, s32, 8
    s_lshl_b32 s35, s31, 7
    s_add_u32 s34, s34, s35
    v_lshlrev_b32 v29, 4, v3
    v_add_u32 v29, s34, v29
    v_add_u32 v29, 0x20400, v29
    ds_write_b128 v29, v[208:211] offset:0
    ds_write_b128 v29, v[212:215] offset:64
    s_waitcnt lgkmcnt(0)
    s_barrier
    s_lshl_b32 s34, s31, 6
    v_add_u32 v28, s34, v2
    v_lshlrev_b32 v28, 3, v28
    v_add_u32 v28, 0x20000, v28
    s_lshl_b32 s35, s32, 8
    v_add_u32 v30, s35, v28
    v_subrev_u32 v31, s35, v28
    ds_read_b64 v[96:97], v30 offset:0
    ds_read_b64 v[98:99], v30 offset:128
    ds_read_b64 v[100:101], v31 offset:256
    ds_read_b64 v[102:103], v31 offset:384
    s_lshl_b32 s34, s32, 8
    v_lshlrev_b32 v28, 4, v3
    v_add_u32 v28, s34, v28
    v_add_u32 v28, 0x20400, v28
    s_lshl_b32 s35, s31, 7
    v_add_u32 v30, s35, v28
    v_subrev_u32 v31, s35, v28
    ds_read_b128 v[64:67], v30 offset:0
    ds_read_b128 v[68:71], v30 offset:64
    ds_read_b128 v[72:75], v31 offset:128
    ds_read_b128 v[76:79], v31 offset:192
    s_lshl_b32 s34, s31, 6
    s_add_u32 s34, s34, s28
    s_lshl_b32 s35, s32, 5
    s_add_u32 s38, s34, s35
    s_add_u32 s38, s38, 0
    v_add_u32 v28, s38, v2
    v_lshlrev_b32 v28, 5, v28
    v_lshl_add_u32 v104, v3, 3, v28
    s_add_u32 s38, s34, s35
    s_add_u32 s38, s38, 16
    v_add_u32 v28, s38, v2
    v_lshlrev_b32 v28, 5, v28
    v_lshl_add_u32 v105, v3, 3, v28
    s_sub_u32 s38, s34, s35
    s_add_u32 s38, s38, 32
    v_add_u32 v28, s38, v2
    v_lshlrev_b32 v28, 5, v28
    v_lshl_add_u32 v106, v3, 3, v28
    s_sub_u32 s38, s34, s35
    s_add_u32 s38, s38, 48
    v_add_u32 v28, s38, v2
    v_lshlrev_b32 v28, 5, v28
    v_lshl_add_u32 v107, v3, 3, v28
    s_waitcnt vmcnt(0) lgkmcnt(0)
    s_lshl_b32 s34, s31, 1
    s_xor_b32 s34, s34, 0
    s_lshl_b32 s34, s34, 4
    s_lshl_b32 s35, s32, 6
    s_add_u32 s34, s34, s35
    s_add_u32 s34, s34, s29
    s_lshr_b32 s35, s34, 9
    s_bfe_u32 s36, s34, 0x50004
    s_lshl_b32 s37, s35, 21
    s_lshl_b32 s36, s36, 16
    s_add_u32 s37, s37, s36
    s_cmp_eq_u32 s35, 0
    s_cselect_b32 s39, 0x3eb8aa3b, 1.0
    v_mul_f32 v32, s39, v97
    v_mul_f32 v34, s39, v99
    v_mul_f32 v36, s39, v101
    v_mul_f32 v38, s39, v103
    v_pk_fma_f32 v[128:129], v[64:65], v[96:97], v[128:129] op_sel_hi:[1,0,1] neg_lo:[0,1,0] neg_hi:[0,1,0]
    v_pk_fma_f32 v[130:131], v[66:67], v[96:97], v[130:131] op_sel_hi:[1,0,1] neg_lo:[0,1,0] neg_hi:[0,1,0]
    v_pk_fma_f32 v[144:145], v[64:65], v[98:99], v[144:145] op_sel_hi:[1,0,1] neg_lo:[0,1,0] neg_hi:[0,1,0]
    v_pk_fma_f32 v[146:147], v[66:67], v[98:99], v[146:147] op_sel_hi:[1,0,1] neg_lo:[0,1,0] neg_hi:[0,1,0]
    v_pk_fma_f32 v[160:161], v[64:65], v[100:101], v[160:161] op_sel_hi:[1,0,1] neg_lo:[0,1,0] neg_hi:[0,1,0]
    v_pk_fma_f32 v[162:163], v[66:67], v[100:101], v[162:163] op_sel_hi:[1,0,1] neg_lo:[0,1,0] neg_hi:[0,1,0]
    v_pk_fma_f32 v[176:177], v[64:65], v[102:103], v[176:177] op_sel_hi:[1,0,1] neg_lo:[0,1,0] neg_hi:[0,1,0]
    v_pk_fma_f32 v[178:179], v[66:67], v[102:103], v[178:179] op_sel_hi:[1,0,1] neg_lo:[0,1,0] neg_hi:[0,1,0]
    v_pk_mul_f32 v[128:129], v[128:129], v[32:33] op_sel_hi:[1,0]
    v_pk_mul_f32 v[130:131], v[130:131], v[32:33] op_sel_hi:[1,0]
    v_pk_mul_f32 v[144:145], v[144:145], v[34:35] op_sel_hi:[1,0]
    v_pk_mul_f32 v[146:147], v[146:147], v[34:35] op_sel_hi:[1,0]
    v_pk_mul_f32 v[160:161], v[160:161], v[36:37] op_sel_hi:[1,0]
    v_pk_mul_f32 v[162:163], v[162:163], v[36:37] op_sel_hi:[1,0]
    v_pk_mul_f32 v[176:177], v[176:177], v[38:39] op_sel_hi:[1,0]
    v_pk_mul_f32 v[178:179], v[178:179], v[38:39] op_sel_hi:[1,0]
    v_cvt_pk_bf16_f32 v52, v128, v129
    v_cvt_pk_bf16_f32 v53, v130, v131
    v_cvt_pk_bf16_f32 v54, v144, v145
    v_cvt_pk_bf16_f32 v55, v146, v147
    v_cvt_pk_bf16_f32 v56, v160, v161
    v_cvt_pk_bf16_f32 v57, v162, v163
    v_cvt_pk_bf16_f32 v58, v176, v177
    v_cvt_pk_bf16_f32 v59, v178, v179
    buffer_store_dwordx2 v[52:53], v104, s[20:23], s37 offen sc1
    buffer_store_dwordx2 v[54:55], v105, s[20:23], s37 offen sc1
    buffer_store_dwordx2 v[56:57], v106, s[20:23], s37 offen sc1
    buffer_store_dwordx2 v[58:59], v107, s[20:23], s37 offen sc1
    s_lshl_b32 s34, s31, 1
    s_xor_b32 s34, s34, 1
    s_lshl_b32 s34, s34, 4
    s_lshl_b32 s35, s32, 6
    s_add_u32 s34, s34, s35
    s_add_u32 s34, s34, s29
    s_lshr_b32 s35, s34, 9
    s_bfe_u32 s36, s34, 0x50004
    s_lshl_b32 s37, s35, 21
    s_lshl_b32 s36, s36, 16
    s_add_u32 s37, s37, s36
    s_cmp_eq_u32 s35, 0
    s_cselect_b32 s39, 0x3eb8aa3b, 1.0
    v_mul_f32 v32, s39, v97
    v_mul_f32 v34, s39, v99
    v_mul_f32 v36, s39, v101
    v_mul_f32 v38, s39, v103
    v_pk_fma_f32 v[132:133], v[68:69], v[96:97], v[132:133] op_sel_hi:[1,0,1] neg_lo:[0,1,0] neg_hi:[0,1,0]
    v_pk_fma_f32 v[134:135], v[70:71], v[96:97], v[134:135] op_sel_hi:[1,0,1] neg_lo:[0,1,0] neg_hi:[0,1,0]
    v_pk_fma_f32 v[148:149], v[68:69], v[98:99], v[148:149] op_sel_hi:[1,0,1] neg_lo:[0,1,0] neg_hi:[0,1,0]
    v_pk_fma_f32 v[150:151], v[70:71], v[98:99], v[150:151] op_sel_hi:[1,0,1] neg_lo:[0,1,0] neg_hi:[0,1,0]
    v_pk_fma_f32 v[164:165], v[68:69], v[100:101], v[164:165] op_sel_hi:[1,0,1] neg_lo:[0,1,0] neg_hi:[0,1,0]
    v_pk_fma_f32 v[166:167], v[70:71], v[100:101], v[166:167] op_sel_hi:[1,0,1] neg_lo:[0,1,0] neg_hi:[0,1,0]
    v_pk_fma_f32 v[180:181], v[68:69], v[102:103], v[180:181] op_sel_hi:[1,0,1] neg_lo:[0,1,0] neg_hi:[0,1,0]
    v_pk_fma_f32 v[182:183], v[70:71], v[102:103], v[182:183] op_sel_hi:[1,0,1] neg_lo:[0,1,0] neg_hi:[0,1,0]
    v_pk_mul_f32 v[132:133], v[132:133], v[32:33] op_sel_hi:[1,0]
    v_pk_mul_f32 v[134:135], v[134:135], v[32:33] op_sel_hi:[1,0]
    v_pk_mul_f32 v[148:149], v[148:149], v[34:35] op_sel_hi:[1,0]
    v_pk_mul_f32 v[150:151], v[150:151], v[34:35] op_sel_hi:[1,0]
    v_pk_mul_f32 v[164:165], v[164:165], v[36:37] op_sel_hi:[1,0]
    v_pk_mul_f32 v[166:167], v[166:167], v[36:37] op_sel_hi:[1,0]
    v_pk_mul_f32 v[180:181], v[180:181], v[38:39] op_sel_hi:[1,0]
    v_pk_mul_f32 v[182:183], v[182:183], v[38:39] op_sel_hi:[1,0]
    v_cvt_pk_bf16_f32 v52, v132, v133
    v_cvt_pk_bf16_f32 v53, v134, v135
    v_cvt_pk_bf16_f32 v54, v148, v149
    v_cvt_pk_bf16_f32 v55, v150, v151
    v_cvt_pk_bf16_f32 v56, v164, v165
    v_cvt_pk_bf16_f32 v57, v166, v167
    v_cvt_pk_bf16_f32 v58, v180, v181
    v_cvt_pk_bf16_f32 v59, v182, v183
    buffer_store_dwordx2 v[52:53], v104, s[20:23], s37 offen sc1
    buffer_store_dwordx2 v[54:55], v105, s[20:23], s37 offen sc1
    buffer_store_dwordx2 v[56:57], v106, s[20:23], s37 offen sc1
    buffer_store_dwordx2 v[58:59], v107, s[20:23], s37 offen sc1
    s_lshl_b32 s34, s31, 1
    s_xor_b32 s34, s34, 2
    s_lshl_b32 s34, s34, 4
    s_lshl_b32 s35, s32, 6
    s_add_u32 s34, s34, s35
    s_add_u32 s34, s34, s29
    s_lshr_b32 s35, s34, 9
    s_bfe_u32 s36, s34, 0x50004
    s_lshl_b32 s37, s35, 21
    s_lshl_b32 s36, s36, 16
    s_add_u32 s37, s37, s36
    s_cmp_eq_u32 s35, 0
    s_cselect_b32 s39, 0x3eb8aa3b, 1.0
    v_mul_f32 v32, s39, v97
    v_mul_f32 v34, s39, v99
    v_mul_f32 v36, s39, v101
    v_mul_f32 v38, s39, v103
    v_pk_fma_f32 v[136:137], v[72:73], v[96:97], v[136:137] op_sel_hi:[1,0,1] neg_lo:[0,1,0] neg_hi:[0,1,0]
    v_pk_fma_f32 v[138:139], v[74:75], v[96:97], v[138:139] op_sel_hi:[1,0,1] neg_lo:[0,1,0] neg_hi:[0,1,0]
    v_pk_fma_f32 v[152:153], v[72:73], v[98:99], v[152:153] op_sel_hi:[1,0,1] neg_lo:[0,1,0] neg_hi:[0,1,0]
    v_pk_fma_f32 v[154:155], v[74:75], v[98:99], v[154:155] op_sel_hi:[1,0,1] neg_lo:[0,1,0] neg_hi:[0,1,0]
    v_pk_fma_f32 v[168:169], v[72:73], v[100:101], v[168:169] op_sel_hi:[1,0,1] neg_lo:[0,1,0] neg_hi:[0,1,0]
    v_pk_fma_f32 v[170:171], v[74:75], v[100:101], v[170:171] op_sel_hi:[1,0,1] neg_lo:[0,1,0] neg_hi:[0,1,0]
    v_pk_fma_f32 v[184:185], v[72:73], v[102:103], v[184:185] op_sel_hi:[1,0,1] neg_lo:[0,1,0] neg_hi:[0,1,0]
    v_pk_fma_f32 v[186:187], v[74:75], v[102:103], v[186:187] op_sel_hi:[1,0,1] neg_lo:[0,1,0] neg_hi:[0,1,0]
    v_pk_mul_f32 v[136:137], v[136:137], v[32:33] op_sel_hi:[1,0]
    v_pk_mul_f32 v[138:139], v[138:139], v[32:33] op_sel_hi:[1,0]
    v_pk_mul_f32 v[152:153], v[152:153], v[34:35] op_sel_hi:[1,0]
    v_pk_mul_f32 v[154:155], v[154:155], v[34:35] op_sel_hi:[1,0]
    v_pk_mul_f32 v[168:169], v[168:169], v[36:37] op_sel_hi:[1,0]
    v_pk_mul_f32 v[170:171], v[170:171], v[36:37] op_sel_hi:[1,0]
    v_pk_mul_f32 v[184:185], v[184:185], v[38:39] op_sel_hi:[1,0]
    v_pk_mul_f32 v[186:187], v[186:187], v[38:39] op_sel_hi:[1,0]
    v_cvt_pk_bf16_f32 v52, v136, v137
    v_cvt_pk_bf16_f32 v53, v138, v139
    v_cvt_pk_bf16_f32 v54, v152, v153
    v_cvt_pk_bf16_f32 v55, v154, v155
    v_cvt_pk_bf16_f32 v56, v168, v169
    v_cvt_pk_bf16_f32 v57, v170, v171
    v_cvt_pk_bf16_f32 v58, v184, v185
    v_cvt_pk_bf16_f32 v59, v186, v187
    buffer_store_dwordx2 v[52:53], v104, s[20:23], s37 offen sc1
    buffer_store_dwordx2 v[54:55], v105, s[20:23], s37 offen sc1
    buffer_store_dwordx2 v[56:57], v106, s[20:23], s37 offen sc1
    buffer_store_dwordx2 v[58:59], v107, s[20:23], s37 offen sc1
    s_lshl_b32 s34, s31, 1
    s_xor_b32 s34, s34, 3
    s_lshl_b32 s34, s34, 4
    s_lshl_b32 s35, s32, 6
    s_add_u32 s34, s34, s35
    s_add_u32 s34, s34, s29
    s_lshr_b32 s35, s34, 9
    s_bfe_u32 s36, s34, 0x50004
    s_lshl_b32 s37, s35, 21
    s_lshl_b32 s36, s36, 16
    s_add_u32 s37, s37, s36
    s_cmp_eq_u32 s35, 0
    s_cselect_b32 s39, 0x3eb8aa3b, 1.0
    v_mul_f32 v32, s39, v97
    v_mul_f32 v34, s39, v99
    v_mul_f32 v36, s39, v101
    v_mul_f32 v38, s39, v103
    v_pk_fma_f32 v[140:141], v[76:77], v[96:97], v[140:141] op_sel_hi:[1,0,1] neg_lo:[0,1,0] neg_hi:[0,1,0]
    v_pk_fma_f32 v[142:143], v[78:79], v[96:97], v[142:143] op_sel_hi:[1,0,1] neg_lo:[0,1,0] neg_hi:[0,1,0]
    v_pk_fma_f32 v[156:157], v[76:77], v[98:99], v[156:157] op_sel_hi:[1,0,1] neg_lo:[0,1,0] neg_hi:[0,1,0]
    v_pk_fma_f32 v[158:159], v[78:79], v[98:99], v[158:159] op_sel_hi:[1,0,1] neg_lo:[0,1,0] neg_hi:[0,1,0]
    v_pk_fma_f32 v[172:173], v[76:77], v[100:101], v[172:173] op_sel_hi:[1,0,1] neg_lo:[0,1,0] neg_hi:[0,1,0]
    v_pk_fma_f32 v[174:175], v[78:79], v[100:101], v[174:175] op_sel_hi:[1,0,1] neg_lo:[0,1,0] neg_hi:[0,1,0]
    v_pk_fma_f32 v[188:189], v[76:77], v[102:103], v[188:189] op_sel_hi:[1,0,1] neg_lo:[0,1,0] neg_hi:[0,1,0]
    v_pk_fma_f32 v[190:191], v[78:79], v[102:103], v[190:191] op_sel_hi:[1,0,1] neg_lo:[0,1,0] neg_hi:[0,1,0]
    v_pk_mul_f32 v[140:141], v[140:141], v[32:33] op_sel_hi:[1,0]
    v_pk_mul_f32 v[142:143], v[142:143], v[32:33] op_sel_hi:[1,0]
    v_pk_mul_f32 v[156:157], v[156:157], v[34:35] op_sel_hi:[1,0]
    v_pk_mul_f32 v[158:159], v[158:159], v[34:35] op_sel_hi:[1,0]
    v_pk_mul_f32 v[172:173], v[172:173], v[36:37] op_sel_hi:[1,0]
    v_pk_mul_f32 v[174:175], v[174:175], v[36:37] op_sel_hi:[1,0]
    v_pk_mul_f32 v[188:189], v[188:189], v[38:39] op_sel_hi:[1,0]
    v_pk_mul_f32 v[190:191], v[190:191], v[38:39] op_sel_hi:[1,0]
    v_cvt_pk_bf16_f32 v52, v140, v141
    v_cvt_pk_bf16_f32 v53, v142, v143
    v_cvt_pk_bf16_f32 v54, v156, v157
    v_cvt_pk_bf16_f32 v55, v158, v159
    v_cvt_pk_bf16_f32 v56, v172, v173
    v_cvt_pk_bf16_f32 v57, v174, v175
    v_cvt_pk_bf16_f32 v58, v188, v189
    v_cvt_pk_bf16_f32 v59, v190, v191
    buffer_store_dwordx2 v[52:53], v104, s[20:23], s37 offen sc1
    buffer_store_dwordx2 v[54:55], v105, s[20:23], s37 offen sc1
    buffer_store_dwordx2 v[56:57], v106, s[20:23], s37 offen sc1
    buffer_store_dwordx2 v[58:59], v107, s[20:23], s37 offen sc1
L_qkv1_kernel_end:
    s_endpgm
.p2align 8
.globl wo1_kernel
.type wo1_kernel,@function
wo1_kernel:
    s_cmp_ge_u32 s2, 256
    s_cbranch_scc1 L_wo1_kernel_end
    s_load_dwordx2 s[6:7], s[0:1], 16
    s_load_dwordx2 s[8:9], s[0:1], 80
    v_and_b32 v1, 63, v0
    v_and_b32 v2, 15, v0
    v_bfe_u32 v3, v0, 4, 2
    v_lshrrev_b32 v28, 6, v0
    s_nop 0
    v_readfirstlane_b32 s30, v28
    s_and_b32 s34, s2, 7
    s_lshr_b32 s35, s2, 3
    s_lshr_b32 s55, s30, 2
    s_and_b32 s30, s30, 3
    s_lshr_b32 s36, s35, 3
    s_lshl_b32 s34, s34, 2
    s_add_u32 s34, s34, s36
    s_and_b32 s35, s35, 7
    s_lshl_b32 s28, s34, 6
    s_lshl_b32 s29, s35, 6
    s_lshr_b32 s31, s30, 1
    s_and_b32 s32, s30, 1
    s_waitcnt lgkmcnt(0)
    s_add_u32 s12, s8, 0x600000
    s_addc_u32 s13, s9, 0
    s_and_b32 s13, s13, 0xffff
    s_mov_b32 s14, 0x200000
    s_mov_b32 s15, 0x20000
    s_mov_b32 s16, s6
    s_and_b32 s17, s7, 0xffff
    s_mov_b32 s18, 0x80000
    s_mov_b32 s19, 0x20000
    s_add_u32 s20, s8, 0x800000
    s_addc_u32 s21, s9, 0
    s_and_b32 s21, s21, 0xffff
    s_mov_b32 s22, 0x200000
    s_mov_b32 s23, 0x20000
    s_add_u32 s24, s8, 0x1200000
    s_addc_u32 s25, s9, 0
    s_and_b32 s25, s25, 0xffff
    s_mov_b32 s26, 0x200000
    s_mov_b32 s27, 0x20000
    v_xor_b32 v29, v2, v3
    v_mul_u32_u24 v28, 0x400, v3
    v_xor_b32 v30, 0, v29
    v_lshl_add_u32 v4, v30, 4, v28
    v_xor_b32 v30, 4, v29
    v_lshl_add_u32 v5, v30, 4, v28
    v_xor_b32 v30, 8, v29
    v_lshl_add_u32 v6, v30, 4, v28
    v_xor_b32 v30, 12, v29
    v_lshl_add_u32 v7, v30, 4, v28
    v_lshrrev_b32 v28, 3, v1
    v_bfe_u32 v29, v1, 4, 1
    v_bfe_u32 v30, v1, 1, 2
    v_xor_b32 v30, v30, v29
    v_and_b32 v31, 1, v1
    v_lshl_add_u32 v31, v30, 1, v31
    v_mul_u32_u24 v28, 0x400, v28
    v_lshl_add_u32 v8, v31, 4, v28
    v_xor_b32 v31, 4, v31
    v_lshl_add_u32 v9, v31, 4, v28
    s_mul_i32 s33, s30, 16
    s_add_u32 s34, s28, s33
    s_mul_i32 s50, s34, 1024
    s_mul_i32 s51, s33, 256
    s_mul_i32 s33, s30, 32
    s_mul_i32 s52, s33, 1024
    s_lshl_b32 s34, s29, 1
    s_add_u32 s52, s52, s34
    s_mul_i32 s53, s33, 128
    s_add_u32 s53, s53, 16384
    s_cmp_eq_u32 s55, 0
    s_cbranch_scc1 L_wo1_kernel_comp
    s_setprio 3
    s_add_u32 s34, s50, 0x0
    s_add_u32 m0, s51, 0x0
    s_nop 0
    buffer_load_dwordx4 v4, s[12:15], s34 offen lds
    s_add_u32 s34, s50, 0x1000
    s_add_u32 m0, s51, 0x400
    s_nop 0
    buffer_load_dwordx4 v5, s[12:15], s34 offen lds
    s_add_u32 s34, s50, 0x2000
    s_add_u32 m0, s51, 0x800
    s_nop 0
    buffer_load_dwordx4 v6, s[12:15], s34 offen lds
    s_add_u32 s34, s50, 0x3000
    s_add_u32 m0, s51, 0xc00
    s_nop 0
    buffer_load_dwordx4 v7, s[12:15], s34 offen lds
    s_add_u32 s34, s52, 0x0
    s_add_u32 m0, s53, 0x0
    s_nop 0
    buffer_load_dwordx4 v8, s[16:19], s34 offen lds
    s_add_u32 s34, s52, 0x2000
    s_add_u32 m0, s53, 0x400
    s_nop 0
    buffer_load_dwordx4 v9, s[16:19], s34 offen lds
    s_add_u32 s34, s52, 0x4000
    s_add_u32 m0, s53, 0x800
    s_nop 0
    buffer_load_dwordx4 v8, s[16:19], s34 offen lds
    s_add_u32 s34, s52, 0x6000
    s_add_u32 m0, s53, 0xc00
    s_nop 0
    buffer_load_dwordx4 v9, s[16:19], s34 offen lds
    s_add_u32 s34, s50, 0x100
    s_add_u32 m0, s51, 0x8000
    s_nop 0
    buffer_load_dwordx4 v4, s[12:15], s34 offen lds
    s_add_u32 s34, s50, 0x1100
    s_add_u32 m0, s51, 0x8400
    s_nop 0
    buffer_load_dwordx4 v5, s[12:15], s34 offen lds
    s_add_u32 s34, s50, 0x2100
    s_add_u32 m0, s51, 0x8800
    s_nop 0
    buffer_load_dwordx4 v6, s[12:15], s34 offen lds
    s_add_u32 s34, s50, 0x3100
    s_add_u32 m0, s51, 0x8c00
    s_nop 0
    buffer_load_dwordx4 v7, s[12:15], s34 offen lds
    s_add_u32 s34, s52, 0x20000
    s_add_u32 m0, s53, 0x8000
    s_nop 0
    buffer_load_dwordx4 v8, s[16:19], s34 offen lds
    s_add_u32 s34, s52, 0x22000
    s_add_u32 m0, s53, 0x8400
    s_nop 0
    buffer_load_dwordx4 v9, s[16:19], s34 offen lds
    s_add_u32 s34, s52, 0x24000
    s_add_u32 m0, s53, 0x8800
    s_nop 0
    buffer_load_dwordx4 v8, s[16:19], s34 offen lds
    s_add_u32 s34, s52, 0x26000
    s_add_u32 m0, s53, 0x8c00
    s_nop 0
    buffer_load_dwordx4 v9, s[16:19], s34 offen lds
    s_waitcnt vmcnt(8)
    s_barrier
    s_add_u32 s34, s50, 0x200
    s_add_u32 m0, s51, 0x10000
    s_nop 0
    buffer_load_dwordx4 v4, s[12:15], s34 offen lds
    s_add_u32 s34, s50, 0x1200
    s_add_u32 m0, s51, 0x10400
    s_nop 0
    buffer_load_dwordx4 v5, s[12:15], s34 offen lds
    s_add_u32 s34, s50, 0x2200
    s_add_u32 m0, s51, 0x10800
    s_nop 0
    buffer_load_dwordx4 v6, s[12:15], s34 offen lds
    s_add_u32 s34, s50, 0x3200
    s_add_u32 m0, s51, 0x10c00
    s_nop 0
    buffer_load_dwordx4 v7, s[12:15], s34 offen lds
    s_add_u32 s34, s52, 0x40000
    s_add_u32 m0, s53, 0x10000
    s_nop 0
    buffer_load_dwordx4 v8, s[16:19], s34 offen lds
    s_add_u32 s34, s52, 0x42000
    s_add_u32 m0, s53, 0x10400
    s_nop 0
    buffer_load_dwordx4 v9, s[16:19], s34 offen lds
    s_add_u32 s34, s52, 0x44000
    s_add_u32 m0, s53, 0x10800
    s_nop 0
    buffer_load_dwordx4 v8, s[16:19], s34 offen lds
    s_add_u32 s34, s52, 0x46000
    s_add_u32 m0, s53, 0x10c00
    s_nop 0
    buffer_load_dwordx4 v9, s[16:19], s34 offen lds
    s_add_u32 s34, s50, 0x300
    s_add_u32 m0, s51, 0x18000
    s_nop 0
    buffer_load_dwordx4 v4, s[12:15], s34 offen lds
    s_add_u32 s34, s50, 0x1300
    s_add_u32 m0, s51, 0x18400
    s_nop 0
    buffer_load_dwordx4 v5, s[12:15], s34 offen lds
    s_add_u32 s34, s50, 0x2300
    s_add_u32 m0, s51, 0x18800
    s_nop 0
    buffer_load_dwordx4 v6, s[12:15], s34 offen lds
    s_add_u32 s34, s50, 0x3300
    s_add_u32 m0, s51, 0x18c00
    s_nop 0
    buffer_load_dwordx4 v7, s[12:15], s34 offen lds
    s_add_u32 s34, s52, 0x60000
    s_add_u32 m0, s53, 0x18000
    s_nop 0
    buffer_load_dwordx4 v8, s[16:19], s34 offen lds
    s_add_u32 s34, s52, 0x62000
    s_add_u32 m0, s53, 0x18400
    s_nop 0
    buffer_load_dwordx4 v9, s[16:19], s34 offen lds
    s_add_u32 s34, s52, 0x64000
    s_add_u32 m0, s53, 0x18800
    s_nop 0
    buffer_load_dwordx4 v8, s[16:19], s34 offen lds
    s_add_u32 s34, s52, 0x66000
    s_add_u32 m0, s53, 0x18c00
    s_nop 0
    buffer_load_dwordx4 v9, s[16:19], s34 offen lds
    s_waitcnt vmcnt(16)
    s_barrier
    s_waitcnt vmcnt(8)
    s_barrier
    s_waitcnt vmcnt(0)
    s_barrier
    s_endpgm
L_wo1_kernel_comp:
    s_lshl_b32 s34, s31, 5
    s_add_u32 s34, s34, s28
    v_add_u32 v12, s34, v2
    v_lshlrev_b32 v12, 10, v12
    v_lshl_add_u32 v12, v3, 3, v12
    s_lshl_b32 s54, s29, 1
    s_lshl_b32 s34, s32, 6
    s_add_u32 s54, s54, s34
    v_add_u32 v13, 0x4000, v12
    buffer_load_dwordx2 v[96:97], v12, s[24:27], s54 offen offset:0
    buffer_load_dwordx2 v[98:99], v12, s[24:27], s54 offen offset:32
    buffer_load_dwordx2 v[100:101], v13, s[24:27], s54 offen offset:0
    buffer_load_dwordx2 v[102:103], v13, s[24:27], s54 offen offset:32
    s_mul_i32 s34, s31, 32
    v_add_u32 v28, s34, v2
    v_lshlrev_b32 v28, 8, v28
    v_xor_b32 v29, v2, v3
    v_xor_b32 v30, 0, v29
    v_lshl_add_u32 v30, v30, 4, v28
    v_mov_b32 v14, v30
    v_xor_b32 v30, 4, v29
    v_lshl_add_u32 v30, v30, 4, v28
    v_mov_b32 v15, v30
    v_xor_b32 v30, 8, v29
    v_lshl_add_u32 v30, v30, 4, v28
    v_mov_b32 v16, v30
    v_xor_b32 v30, 12, v29
    v_lshl_add_u32 v30, v30, 4, v28
    v_mov_b32 v17, v30
    v_bfe_u32 v28, v0, 2, 2
    v_lshl_add_u32 v29, v3, 3, v28
    v_lshlrev_b32 v29, 7, v29
    v_and_b32 v30, 3, v0
    v_lshl_add_u32 v29, v30, 3, v29
    v_add_u32 v29, 16384, v29
    v_and_b32 v30, 1, v3
    v_lshrrev_b32 v28, 1, v28
    v_lshl_add_u32 v28, v30, 1, v28
    s_mul_i32 s34, s32, 2
    s_add_u32 s34, s34, 0
    v_xor_b32 v30, s34, v28
    v_lshl_add_u32 v22, v30, 5, v29
    s_mul_i32 s34, s32, 2
    s_add_u32 s34, s34, 1
    v_xor_b32 v30, s34, v28
    v_lshl_add_u32 v23, v30, 5, v29
    s_barrier
    ds_read_b128 v[32:35], v14 offset:0
    ds_read_b128 v[36:39], v14 offset:4096
    ds_read_b64_tr_b16 v[64:65], v22 offset:0
    ds_read_b64_tr_b16 v[66:67], v22 offset:512
    ds_read_b64_tr_b16 v[68:69], v23 offset:0
    ds_read_b64_tr_b16 v[70:71], v23 offset:512
    s_waitcnt lgkmcnt(0)
    v_mfma_f32_16x16x32_bf16 v[128:131], v[64:67], v[32:35], 0
    ds_read_b128 v[48:51], v15 offset:0
    ds_read_b128 v[52:55], v15 offset:4096
    v_mfma_f32_16x16x32_bf16 v[136:139], v[64:67], v[36:39], 0
    ds_read_b64_tr_b16 v[80:81], v22 offset:4096
    ds_read_b64_tr_b16 v[82:83], v22 offset:4608
    v_mfma_f32_16x16x32_bf16 v[132:135], v[68:71], v[32:35], 0
    ds_read_b64_tr_b16 v[84:85], v23 offset:4096
    ds_read_b64_tr_b16 v[86:87], v23 offset:4608
    v_mfma_f32_16x16x32_bf16 v[140:143], v[68:71], v[36:39], 0
    s_waitcnt lgkmcnt(0)
    v_mfma_f32_16x16x32_bf16 v[128:131], v[80:83], v[48:51], v[128:131]
    ds_read_b128 v[32:35], v16 offset:0
    ds_read_b128 v[36:39], v16 offset:4096
    v_mfma_f32_16x16x32_bf16 v[136:139], v[80:83], v[52:55], v[136:139]
    ds_read_b64_tr_b16 v[64:65], v22 offset:8192
    ds_read_b64_tr_b16 v[66:67], v22 offset:8704
    v_mfma_f32_16x16x32_bf16 v[132:135], v[84:87], v[48:51], v[132:135]
    ds_read_b64_tr_b16 v[68:69], v23 offset:8192
    ds_read_b64_tr_b16 v[70:71], v23 offset:8704
    v_mfma_f32_16x16x32_bf16 v[140:143], v[84:87], v[52:55], v[140:143]
    s_waitcnt lgkmcnt(0)
    v_mfma_f32_16x16x32_bf16 v[128:131], v[64:67], v[32:35], v[128:131]
    ds_read_b128 v[48:51], v17 offset:0
    ds_read_b128 v[52:55], v17 offset:4096
    v_mfma_f32_16x16x32_bf16 v[136:139], v[64:67], v[36:39], v[136:139]
    ds_read_b64_tr_b16 v[80:81], v22 offset:12288
    ds_read_b64_tr_b16 v[82:83], v22 offset:12800
    v_mfma_f32_16x16x32_bf16 v[132:135], v[68:71], v[32:35], v[132:135]
    ds_read_b64_tr_b16 v[84:85], v23 offset:12288
    ds_read_b64_tr_b16 v[86:87], v23 offset:12800
    v_mfma_f32_16x16x32_bf16 v[140:143], v[68:71], v[36:39], v[140:143]
    s_waitcnt lgkmcnt(0)
    s_barrier
    v_mfma_f32_16x16x32_bf16 v[128:131], v[80:83], v[48:51], v[128:131]
    ds_read_b128 v[32:35], v14 offset:32768
    ds_read_b128 v[36:39], v14 offset:36864
    v_mfma_f32_16x16x32_bf16 v[136:139], v[80:83], v[52:55], v[136:139]
    ds_read_b64_tr_b16 v[64:65], v22 offset:32768
    ds_read_b64_tr_b16 v[66:67], v22 offset:33280
    v_mfma_f32_16x16x32_bf16 v[132:135], v[84:87], v[48:51], v[132:135]
    ds_read_b64_tr_b16 v[68:69], v23 offset:32768
    ds_read_b64_tr_b16 v[70:71], v23 offset:33280
    v_mfma_f32_16x16x32_bf16 v[140:143], v[84:87], v[52:55], v[140:143]
    s_waitcnt lgkmcnt(0)
    v_mfma_f32_16x16x32_bf16 v[128:131], v[64:67], v[32:35], v[128:131]
    ds_read_b128 v[48:51], v15 offset:32768
    ds_read_b128 v[52:55], v15 offset:36864
    v_mfma_f32_16x16x32_bf16 v[136:139], v[64:67], v[36:39], v[136:139]
    ds_read_b64_tr_b16 v[80:81], v22 offset:36864
    ds_read_b64_tr_b16 v[82:83], v22 offset:37376
    v_mfma_f32_16x16x32_bf16 v[132:135], v[68:71], v[32:35], v[132:135]
    ds_read_b64_tr_b16 v[84:85], v23 offset:36864
    ds_read_b64_tr_b16 v[86:87], v23 offset:37376
    v_mfma_f32_16x16x32_bf16 v[140:143], v[68:71], v[36:39], v[140:143]
    s_waitcnt lgkmcnt(0)
    v_mfma_f32_16x16x32_bf16 v[128:131], v[80:83], v[48:51], v[128:131]
    ds_read_b128 v[32:35], v16 offset:32768
    ds_read_b128 v[36:39], v16 offset:36864
    v_mfma_f32_16x16x32_bf16 v[136:139], v[80:83], v[52:55], v[136:139]
    ds_read_b64_tr_b16 v[64:65], v22 offset:40960
    ds_read_b64_tr_b16 v[66:67], v22 offset:41472
    v_mfma_f32_16x16x32_bf16 v[132:135], v[84:87], v[48:51], v[132:135]
    ds_read_b64_tr_b16 v[68:69], v23 offset:40960
    ds_read_b64_tr_b16 v[70:71], v23 offset:41472
    v_mfma_f32_16x16x32_bf16 v[140:143], v[84:87], v[52:55], v[140:143]
    s_waitcnt lgkmcnt(0)
    v_mfma_f32_16x16x32_bf16 v[128:131], v[64:67], v[32:35], v[128:131]
    ds_read_b128 v[48:51], v17 offset:32768
    ds_read_b128 v[52:55], v17 offset:36864
    v_mfma_f32_16x16x32_bf16 v[136:139], v[64:67], v[36:39], v[136:139]
    ds_read_b64_tr_b16 v[80:81], v22 offset:45056
    ds_read_b64_tr_b16 v[82:83], v22 offset:45568
    v_mfma_f32_16x16x32_bf16 v[132:135], v[68:71], v[32:35], v[132:135]
    ds_read_b64_tr_b16 v[84:85], v23 offset:45056
    ds_read_b64_tr_b16 v[86:87], v23 offset:45568
    v_mfma_f32_16x16x32_bf16 v[140:143], v[68:71], v[36:39], v[140:143]
    s_waitcnt lgkmcnt(0)
    s_barrier
    v_mfma_f32_16x16x32_bf16 v[128:131], v[80:83], v[48:51], v[128:131]
    v_add_u32 v14, 0x10000, v14
    v_add_u32 v15, 0x10000, v15
    v_add_u32 v16, 0x10000, v16
    v_add_u32 v17, 0x10000, v17
    v_mfma_f32_16x16x32_bf16 v[136:139], v[80:83], v[52:55], v[136:139]
    v_add_u32 v22, 0x10000, v22
    v_add_u32 v23, 0x10000, v23
    ds_read_b128 v[32:35], v14 offset:0
    ds_read_b128 v[36:39], v14 offset:4096
    v_mfma_f32_16x16x32_bf16 v[132:135], v[84:87], v[48:51], v[132:135]
    ds_read_b64_tr_b16 v[64:65], v22 offset:0
    ds_read_b64_tr_b16 v[66:67], v22 offset:512
    ds_read_b64_tr_b16 v[68:69], v23 offset:0
    ds_read_b64_tr_b16 v[70:71], v23 offset:512
    v_mfma_f32_16x16x32_bf16 v[140:143], v[84:87], v[52:55], v[140:143]
    s_waitcnt lgkmcnt(0)
    v_mfma_f32_16x16x32_bf16 v[128:131], v[64:67], v[32:35], v[128:131]
    ds_read_b128 v[48:51], v15 offset:0
    ds_read_b128 v[52:55], v15 offset:4096
    v_mfma_f32_16x16x32_bf16 v[136:139], v[64:67], v[36:39], v[136:139]
    ds_read_b64_tr_b16 v[80:81], v22 offset:4096
    ds_read_b64_tr_b16 v[82:83], v22 offset:4608
    v_mfma_f32_16x16x32_bf16 v[132:135], v[68:71], v[32:35], v[132:135]
    ds_read_b64_tr_b16 v[84:85], v23 offset:4096
    ds_read_b64_tr_b16 v[86:87], v23 offset:4608
    v_mfma_f32_16x16x32_bf16 v[140:143], v[68:71], v[36:39], v[140:143]
    s_waitcnt lgkmcnt(0)
    v_mfma_f32_16x16x32_bf16 v[128:131], v[80:83], v[48:51], v[128:131]
    ds_read_b128 v[32:35], v16 offset:0
    ds_read_b128 v[36:39], v16 offset:4096
    v_mfma_f32_16x16x32_bf16 v[136:139], v[80:83], v[52:55], v[136:139]
    ds_read_b64_tr_b16 v[64:65], v22 offset:8192
    ds_read_b64_tr_b16 v[66:67], v22 offset:8704
    v_mfma_f32_16x16x32_bf16 v[132:135], v[84:87], v[48:51], v[132:135]
    ds_read_b64_tr_b16 v[68:69], v23 offset:8192
    ds_read_b64_tr_b16 v[70:71], v23 offset:8704
    v_mfma_f32_16x16x32_bf16 v[140:143], v[84:87], v[52:55], v[140:143]
    s_waitcnt lgkmcnt(0)
    v_mfma_f32_16x16x32_bf16 v[128:131], v[64:67], v[32:35], v[128:131]
    ds_read_b128 v[48:51], v17 offset:0
    ds_read_b128 v[52:55], v17 offset:4096
    v_mfma_f32_16x16x32_bf16 v[136:139], v[64:67], v[36:39], v[136:139]
    ds_read_b64_tr_b16 v[80:81], v22 offset:12288
    ds_read_b64_tr_b16 v[82:83], v22 offset:12800
    v_mfma_f32_16x16x32_bf16 v[132:135], v[68:71], v[32:35], v[132:135]
    ds_read_b64_tr_b16 v[84:85], v23 offset:12288
    ds_read_b64_tr_b16 v[86:87], v23 offset:12800
    v_mfma_f32_16x16x32_bf16 v[140:143], v[68:71], v[36:39], v[140:143]
    s_waitcnt lgkmcnt(0)
    s_barrier
    v_mfma_f32_16x16x32_bf16 v[128:131], v[80:83], v[48:51], v[128:131]
    ds_read_b128 v[32:35], v14 offset:32768
    ds_read_b128 v[36:39], v14 offset:36864
    v_mfma_f32_16x16x32_bf16 v[136:139], v[80:83], v[52:55], v[136:139]
    ds_read_b64_tr_b16 v[64:65], v22 offset:32768
    ds_read_b64_tr_b16 v[66:67], v22 offset:33280
    v_mfma_f32_16x16x32_bf16 v[132:135], v[84:87], v[48:51], v[132:135]
    ds_read_b64_tr_b16 v[68:69], v23 offset:32768
    ds_read_b64_tr_b16 v[70:71], v23 offset:33280
    v_mfma_f32_16x16x32_bf16 v[140:143], v[84:87], v[52:55], v[140:143]
    s_waitcnt lgkmcnt(0)
    v_mfma_f32_16x16x32_bf16 v[128:131], v[64:67], v[32:35], v[128:131]
    ds_read_b128 v[48:51], v15 offset:32768
    ds_read_b128 v[52:55], v15 offset:36864
    v_mfma_f32_16x16x32_bf16 v[136:139], v[64:67], v[36:39], v[136:139]
    ds_read_b64_tr_b16 v[80:81], v22 offset:36864
    ds_read_b64_tr_b16 v[82:83], v22 offset:37376
    v_mfma_f32_16x16x32_bf16 v[132:135], v[68:71], v[32:35], v[132:135]
    ds_read_b64_tr_b16 v[84:85], v23 offset:36864
    ds_read_b64_tr_b16 v[86:87], v23 offset:37376
    v_mfma_f32_16x16x32_bf16 v[140:143], v[68:71], v[36:39], v[140:143]
    s_waitcnt lgkmcnt(0)
    v_mfma_f32_16x16x32_bf16 v[128:131], v[80:83], v[48:51], v[128:131]
    ds_read_b128 v[32:35], v16 offset:32768
    ds_read_b128 v[36:39], v16 offset:36864
    v_mfma_f32_16x16x32_bf16 v[136:139], v[80:83], v[52:55], v[136:139]
    ds_read_b64_tr_b16 v[64:65], v22 offset:40960
    ds_read_b64_tr_b16 v[66:67], v22 offset:41472
    v_mfma_f32_16x16x32_bf16 v[132:135], v[84:87], v[48:51], v[132:135]
    ds_read_b64_tr_b16 v[68:69], v23 offset:40960
    ds_read_b64_tr_b16 v[70:71], v23 offset:41472
    v_mfma_f32_16x16x32_bf16 v[140:143], v[84:87], v[52:55], v[140:143]
    s_waitcnt lgkmcnt(0)
    v_mfma_f32_16x16x32_bf16 v[128:131], v[64:67], v[32:35], v[128:131]
    ds_read_b128 v[48:51], v17 offset:32768
    ds_read_b128 v[52:55], v17 offset:36864
    v_mfma_f32_16x16x32_bf16 v[136:139], v[64:67], v[36:39], v[136:139]
    ds_read_b64_tr_b16 v[80:81], v22 offset:45056
    ds_read_b64_tr_b16 v[82:83], v22 offset:45568
    v_mfma_f32_16x16x32_bf16 v[132:135], v[68:71], v[32:35], v[132:135]
    ds_read_b64_tr_b16 v[84:85], v23 offset:45056
    ds_read_b64_tr_b16 v[86:87], v23 offset:45568
    v_mfma_f32_16x16x32_bf16 v[140:143], v[68:71], v[36:39], v[140:143]
    s_waitcnt lgkmcnt(0)
    v_mfma_f32_16x16x32_bf16 v[128:131], v[80:83], v[48:51], v[128:131]
    v_mfma_f32_16x16x32_bf16 v[136:139], v[80:83], v[52:55], v[136:139]
    v_mfma_f32_16x16x32_bf16 v[132:135], v[84:87], v[48:51], v[132:135]
    v_mfma_f32_16x16x32_bf16 v[140:143], v[84:87], v[52:55], v[140:143]
    s_nop 7
    s_waitcnt vmcnt(0)
    v_lshlrev_b32 v32, 16, v96
    v_and_b32 v33, 0xffff0000, v96
    v_lshlrev_b32 v34, 16, v97
    v_and_b32 v35, 0xffff0000, v97
    v_add_f32 v40, v128, v32
    v_add_f32 v41, v129, v33
    v_add_f32 v42, v130, v34
    v_add_f32 v43, v131, v35
    v_cvt_pk_bf16_f32 v48, v40, v41
    v_cvt_pk_bf16_f32 v49, v42, v43
    buffer_store_dwordx2 v[48:49], v12, s[20:23], s54 offen offset:0
    v_lshlrev_b32 v32, 16, v98
    v_and_b32 v33, 0xffff0000, v98
    v_lshlrev_b32 v34, 16, v99
    v_and_b32 v35, 0xffff0000, v99
    v_add_f32 v40, v132, v32
    v_add_f32 v41, v133, v33
    v_add_f32 v42, v134, v34
    v_add_f32 v43, v135, v35
    v_cvt_pk_bf16_f32 v50, v40, v41
    v_cvt_pk_bf16_f32 v51, v42, v43
    buffer_store_dwordx2 v[50:51], v12, s[20:23], s54 offen offset:32
    v_lshlrev_b32 v32, 16, v100
    v_and_b32 v33, 0xffff0000, v100
    v_lshlrev_b32 v34, 16, v101
    v_and_b32 v35, 0xffff0000, v101
    v_add_f32 v40, v136, v32
    v_add_f32 v41, v137, v33
    v_add_f32 v42, v138, v34
    v_add_f32 v43, v139, v35
    v_cvt_pk_bf16_f32 v52, v40, v41
    v_cvt_pk_bf16_f32 v53, v42, v43
    buffer_store_dwordx2 v[52:53], v13, s[20:23], s54 offen offset:0
    v_lshlrev_b32 v32, 16, v102
    v_and_b32 v33, 0xffff0000, v102
    v_lshlrev_b32 v34, 16, v103
    v_and_b32 v35, 0xffff0000, v103
    v_add_f32 v40, v140, v32
    v_add_f32 v41, v141, v33
    v_add_f32 v42, v142, v34
    v_add_f32 v43, v143, v35
    v_cvt_pk_bf16_f32 v54, v40, v41
    v_cvt_pk_bf16_f32 v55, v42, v43
    buffer_store_dwordx2 v[54:55], v13, s[20:23], s54 offen offset:32
L_wo1_kernel_end:
    s_endpgm
.p2align 8
.globl ffn2b_kernel
.type ffn2b_kernel,@function
ffn2b_kernel:
    s_cmp_ge_u32 s2, 256
    s_cbranch_scc1 L_ffn2b_kernel_end
    s_load_dwordx2 s[6:7], s[0:1], 48
    s_load_dwordx2 s[8:9], s[0:1], 80
    s_load_dwordx2 s[10:11], s[0:1], 56
    s_load_dwordx2 s[48:49], s[0:1], 64
    v_and_b32 v1, 63, v0
    v_and_b32 v2, 15, v0
    v_bfe_u32 v3, v0, 4, 2
    v_lshrrev_b32 v28, 6, v0
    s_nop 0
    v_readfirstlane_b32 s30, v28
    s_and_b32 s34, s2, 7
    s_lshr_b32 s35, s2, 3
    s_lshr_b32 s55, s30, 2
    s_and_b32 s30, s30, 3
    s_lshr_b32 s36, s35, 3
    s_lshl_b32 s34, s34, 2
    s_add_u32 s34, s34, s36
    s_and_b32 s35, s35, 7
    s_lshl_b32 s28, s34, 6
    s_lshl_b32 s29, s35, 6
    s_lshr_b32 s31, s30, 1
    s_and_b32 s32, s30, 1
    s_waitcnt lgkmcnt(0)
    s_add_u32 s12, s8, 0xa00000
    s_addc_u32 s13, s9, 0
    s_and_b32 s13, s13, 0xffff
    s_mov_b32 s14, 0x700000
    s_mov_b32 s15, 0x20000
    s_mov_b32 s16, s6
    s_and_b32 s17, s7, 0xffff
    s_mov_b32 s18, 0x1c0000
    s_mov_b32 s19, 0x20000
    s_mov_b32 s20, s48
    s_and_b32 s21, s49, 0xffff
    s_mov_b32 s22, 0x200000
    s_mov_b32 s23, 0x20000
    s_add_u32 s24, s8, 0x800000
    s_addc_u32 s25, s9, 0
    s_and_b32 s25, s25, 0xffff
    s_mov_b32 s26, 0x200000
    s_mov_b32 s27, 0x20000
    s_mov_b32 s44, s10
    s_and_b32 s45, s11, 0xffff
    s_mov_b32 s46, 0x400
    s_mov_b32 s47, 0x20000
    v_xor_b32 v29, v2, v3
    v_mul_u32_u24 v28, 0xe00, v3
    v_xor_b32 v30, 0, v29
    v_lshl_add_u32 v4, v30, 4, v28
    v_xor_b32 v30, 4, v29
    v_lshl_add_u32 v5, v30, 4, v28
    v_xor_b32 v30, 8, v29
    v_lshl_add_u32 v6, v30, 4, v28
    v_xor_b32 v30, 12, v29
    v_lshl_add_u32 v7, v30, 4, v28
    v_lshrrev_b32 v28, 3, v1
    v_bfe_u32 v29, v1, 4, 1
    v_bfe_u32 v30, v1, 1, 2
    v_xor_b32 v30, v30, v29
    v_and_b32 v31, 1, v1
    v_lshl_add_u32 v31, v30, 1, v31
    v_mul_u32_u24 v28, 0x400, v28
    v_lshl_add_u32 v8, v31, 4, v28
    v_xor_b32 v31, 4, v31
    v_lshl_add_u32 v9, v31, 4, v28
    s_mul_i32 s33, s30, 16
    s_add_u32 s34, s28, s33
    s_mul_i32 s50, s34, 3584
    s_mul_i32 s51, s33, 256
    s_mul_i32 s33, s30, 32
    s_mul_i32 s52, s33, 1024
    s_lshl_b32 s34, s29, 1
    s_add_u32 s52, s52, s34
    s_mul_i32 s53, s33, 128
    s_add_u32 s53, s53, 16384
    s_cmp_eq_u32 s55, 0
    s_cbranch_scc1 L_ffn2b_kernel_comp
    s_setprio 3
    s_add_u32 s34, s50, 0x0
    s_add_u32 m0, s51, 0x0
    s_nop 0
    buffer_load_dwordx4 v4, s[12:15], s34 offen lds
    s_add_u32 s34, s50, 0x3800
    s_add_u32 m0, s51, 0x400
    s_nop 0
    buffer_load_dwordx4 v5, s[12:15], s34 offen lds
    s_add_u32 s34, s50, 0x7000
    s_add_u32 m0, s51, 0x800
    s_nop 0
    buffer_load_dwordx4 v6, s[12:15], s34 offen lds
    s_add_u32 s34, s50, 0xa800
    s_add_u32 m0, s51, 0xc00
    s_nop 0
    buffer_load_dwordx4 v7, s[12:15], s34 offen lds
    s_add_u32 s34, s52, 0x0
    s_add_u32 m0, s53, 0x0
    s_nop 0
    buffer_load_dwordx4 v8, s[16:19], s34 offen lds
    s_add_u32 s34, s52, 0x2000
    s_add_u32 m0, s53, 0x400
    s_nop 0
    buffer_load_dwordx4 v9, s[16:19], s34 offen lds
    s_add_u32 s34, s52, 0x4000
    s_add_u32 m0, s53, 0x800
    s_nop 0
    buffer_load_dwordx4 v8, s[16:19], s34 offen lds
    s_add_u32 s34, s52, 0x6000
    s_add_u32 m0, s53, 0xc00
    s_nop 0
    buffer_load_dwordx4 v9, s[16:19], s34 offen lds
    s_add_u32 s34, s50, 0x100
    s_add_u32 m0, s51, 0x8000
    s_nop 0
    buffer_load_dwordx4 v4, s[12:15], s34 offen lds
    s_add_u32 s34, s50, 0x3900
    s_add_u32 m0, s51, 0x8400
    s_nop 0
    buffer_load_dwordx4 v5, s[12:15], s34 offen lds
    s_add_u32 s34, s50, 0x7100
    s_add_u32 m0, s51, 0x8800
    s_nop 0
    buffer_load_dwordx4 v6, s[12:15], s34 offen lds
    s_add_u32 s34, s50, 0xa900
    s_add_u32 m0, s51, 0x8c00
    s_nop 0
    buffer_load_dwordx4 v7, s[12:15], s34 offen lds
    s_add_u32 s34, s52, 0x20000
    s_add_u32 m0, s53, 0x8000
    s_nop 0
    buffer_load_dwordx4 v8, s[16:19], s34 offen lds
    s_add_u32 s34, s52, 0x22000
    s_add_u32 m0, s53, 0x8400
    s_nop 0
    buffer_load_dwordx4 v9, s[16:19], s34 offen lds
    s_add_u32 s34, s52, 0x24000
    s_add_u32 m0, s53, 0x8800
    s_nop 0
    buffer_load_dwordx4 v8, s[16:19], s34 offen lds
    s_add_u32 s34, s52, 0x26000
    s_add_u32 m0, s53, 0x8c00
    s_nop 0
    buffer_load_dwordx4 v9, s[16:19], s34 offen lds
    s_waitcnt vmcnt(8)
    s_barrier
    s_add_u32 s34, s50, 0x200
    s_add_u32 m0, s51, 0x10000
    s_nop 0
    buffer_load_dwordx4 v4, s[12:15], s34 offen lds
    s_add_u32 s34, s50, 0x3a00
    s_add_u32 m0, s51, 0x10400
    s_nop 0
    buffer_load_dwordx4 v5, s[12:15], s34 offen lds
    s_add_u32 s34, s50, 0x7200
    s_add_u32 m0, s51, 0x10800
    s_nop 0
    buffer_load_dwordx4 v6, s[12:15], s34 offen lds
    s_add_u32 s34, s50, 0xaa00
    s_add_u32 m0, s51, 0x10c00
    s_nop 0
    buffer_load_dwordx4 v7, s[12:15], s34 offen lds
    s_add_u32 s34, s52, 0x40000
    s_add_u32 m0, s53, 0x10000
    s_nop 0
    buffer_load_dwordx4 v8, s[16:19], s34 offen lds
    s_add_u32 s34, s52, 0x42000
    s_add_u32 m0, s53, 0x10400
    s_nop 0
    buffer_load_dwordx4 v9, s[16:19], s34 offen lds
    s_add_u32 s34, s52, 0x44000
    s_add_u32 m0, s53, 0x10800
    s_nop 0
    buffer_load_dwordx4 v8, s[16:19], s34 offen lds
    s_add_u32 s34, s52, 0x46000
    s_add_u32 m0, s53, 0x10c00
    s_nop 0
    buffer_load_dwordx4 v9, s[16:19], s34 offen lds
    s_add_u32 s34, s50, 0x300
    s_add_u32 m0, s51, 0x18000
    s_nop 0
    buffer_load_dwordx4 v4, s[12:15], s34 offen lds
    s_add_u32 s34, s50, 0x3b00
    s_add_u32 m0, s51, 0x18400
    s_nop 0
    buffer_load_dwordx4 v5, s[12:15], s34 offen lds
    s_add_u32 s34, s50, 0x7300
    s_add_u32 m0, s51, 0x18800
    s_nop 0
    buffer_load_dwordx4 v6, s[12:15], s34 offen lds
    s_add_u32 s34, s50, 0xab00
    s_add_u32 m0, s51, 0x18c00
    s_nop 0
    buffer_load_dwordx4 v7, s[12:15], s34 offen lds
    s_add_u32 s34, s52, 0x60000
    s_add_u32 m0, s53, 0x18000
    s_nop 0
    buffer_load_dwordx4 v8, s[16:19], s34 offen lds
    s_add_u32 s34, s52, 0x62000
    s_add_u32 m0, s53, 0x18400
    s_nop 0
    buffer_load_dwordx4 v9, s[16:19], s34 offen lds
    s_add_u32 s34, s52, 0x64000
    s_add_u32 m0, s53, 0x18800
    s_nop 0
    buffer_load_dwordx4 v8, s[16:19], s34 offen lds
    s_add_u32 s34, s52, 0x66000
    s_add_u32 m0, s53, 0x18c00
    s_nop 0
    buffer_load_dwordx4 v9, s[16:19], s34 offen lds
    s_waitcnt vmcnt(16)
    s_barrier
    s_add_u32 s34, s50, 0x400
    s_add_u32 m0, s51, 0x0
    s_nop 0
    buffer_load_dwordx4 v4, s[12:15], s34 offen lds
    s_add_u32 s34, s50, 0x3c00
    s_add_u32 m0, s51, 0x400
    s_nop 0
    buffer_load_dwordx4 v5, s[12:15], s34 offen lds
    s_add_u32 s34, s50, 0x7400
    s_add_u32 m0, s51, 0x800
    s_nop 0
    buffer_load_dwordx4 v6, s[12:15], s34 offen lds
    s_add_u32 s34, s50, 0xac00
    s_add_u32 m0, s51, 0xc00
    s_nop 0
    buffer_load_dwordx4 v7, s[12:15], s34 offen lds
    s_add_u32 s34, s52, 0x80000
    s_add_u32 m0, s53, 0x0
    s_nop 0
    buffer_load_dwordx4 v8, s[16:19], s34 offen lds
    s_add_u32 s34, s52, 0x82000
    s_add_u32 m0, s53, 0x400
    s_nop 0
    buffer_load_dwordx4 v9, s[16:19], s34 offen lds
    s_add_u32 s34, s52, 0x84000
    s_add_u32 m0, s53, 0x800
    s_nop 0
    buffer_load_dwordx4 v8, s[16:19], s34 offen lds
    s_add_u32 s34, s52, 0x86000
    s_add_u32 m0, s53, 0xc00
    s_nop 0
    buffer_load_dwordx4 v9, s[16:19], s34 offen lds
    s_waitcnt vmcnt(16)
    s_barrier
    s_add_u32 s34, s50, 0x500
    s_add_u32 m0, s51, 0x8000
    s_nop 0
    buffer_load_dwordx4 v4, s[12:15], s34 offen lds
    s_add_u32 s34, s50, 0x3d00
    s_add_u32 m0, s51, 0x8400
    s_nop 0
    buffer_load_dwordx4 v5, s[12:15], s34 offen lds
    s_add_u32 s34, s50, 0x7500
    s_add_u32 m0, s51, 0x8800
    s_nop 0
    buffer_load_dwordx4 v6, s[12:15], s34 offen lds
    s_add_u32 s34, s50, 0xad00
    s_add_u32 m0, s51, 0x8c00
    s_nop 0
    buffer_load_dwordx4 v7, s[12:15], s34 offen lds
    s_add_u32 s34, s52, 0xa0000
    s_add_u32 m0, s53, 0x8000
    s_nop 0
    buffer_load_dwordx4 v8, s[16:19], s34 offen lds
    s_add_u32 s34, s52, 0xa2000
    s_add_u32 m0, s53, 0x8400
    s_nop 0
    buffer_load_dwordx4 v9, s[16:19], s34 offen lds
    s_add_u32 s34, s52, 0xa4000
    s_add_u32 m0, s53, 0x8800
    s_nop 0
    buffer_load_dwordx4 v8, s[16:19], s34 offen lds
    s_add_u32 s34, s52, 0xa6000
    s_add_u32 m0, s53, 0x8c00
    s_nop 0
    buffer_load_dwordx4 v9, s[16:19], s34 offen lds
    s_waitcnt vmcnt(16)
    s_barrier
    s_add_u32 s34, s50, 0x600
    s_add_u32 m0, s51, 0x10000
    s_nop 0
    buffer_load_dwordx4 v4, s[12:15], s34 offen lds
    s_add_u32 s34, s50, 0x3e00
    s_add_u32 m0, s51, 0x10400
    s_nop 0
    buffer_load_dwordx4 v5, s[12:15], s34 offen lds
    s_add_u32 s34, s50, 0x7600
    s_add_u32 m0, s51, 0x10800
    s_nop 0
    buffer_load_dwordx4 v6, s[12:15], s34 offen lds
    s_add_u32 s34, s50, 0xae00
    s_add_u32 m0, s51, 0x10c00
    s_nop 0
    buffer_load_dwordx4 v7, s[12:15], s34 offen lds
    s_add_u32 s34, s52, 0xc0000
    s_add_u32 m0, s53, 0x10000
    s_nop 0
    buffer_load_dwordx4 v8, s[16:19], s34 offen lds
    s_add_u32 s34, s52, 0xc2000
    s_add_u32 m0, s53, 0x10400
    s_nop 0
    buffer_load_dwordx4 v9, s[16:19], s34 offen lds
    s_add_u32 s34, s52, 0xc4000
    s_add_u32 m0, s53, 0x10800
    s_nop 0
    buffer_load_dwordx4 v8, s[16:19], s34 offen lds
    s_add_u32 s34, s52, 0xc6000
    s_add_u32 m0, s53, 0x10c00
    s_nop 0
    buffer_load_dwordx4 v9, s[16:19], s34 offen lds
    s_waitcnt vmcnt(16)
    s_barrier
    s_add_u32 s34, s50, 0x700
    s_add_u32 m0, s51, 0x18000
    s_nop 0
    buffer_load_dwordx4 v4, s[12:15], s34 offen lds
    s_add_u32 s34, s50, 0x3f00
    s_add_u32 m0, s51, 0x18400
    s_nop 0
    buffer_load_dwordx4 v5, s[12:15], s34 offen lds
    s_add_u32 s34, s50, 0x7700
    s_add_u32 m0, s51, 0x18800
    s_nop 0
    buffer_load_dwordx4 v6, s[12:15], s34 offen lds
    s_add_u32 s34, s50, 0xaf00
    s_add_u32 m0, s51, 0x18c00
    s_nop 0
    buffer_load_dwordx4 v7, s[12:15], s34 offen lds
    s_add_u32 s34, s52, 0xe0000
    s_add_u32 m0, s53, 0x18000
    s_nop 0
    buffer_load_dwordx4 v8, s[16:19], s34 offen lds
    s_add_u32 s34, s52, 0xe2000
    s_add_u32 m0, s53, 0x18400
    s_nop 0
    buffer_load_dwordx4 v9, s[16:19], s34 offen lds
    s_add_u32 s34, s52, 0xe4000
    s_add_u32 m0, s53, 0x18800
    s_nop 0
    buffer_load_dwordx4 v8, s[16:19], s34 offen lds
    s_add_u32 s34, s52, 0xe6000
    s_add_u32 m0, s53, 0x18c00
    s_nop 0
    buffer_load_dwordx4 v9, s[16:19], s34 offen lds
    s_waitcnt vmcnt(16)
    s_barrier
    s_add_u32 s34, s50, 0x800
    s_add_u32 m0, s51, 0x0
    s_nop 0
    buffer_load_dwordx4 v4, s[12:15], s34 offen lds
    s_add_u32 s34, s50, 0x4000
    s_add_u32 m0, s51, 0x400
    s_nop 0
    buffer_load_dwordx4 v5, s[12:15], s34 offen lds
    s_add_u32 s34, s50, 0x7800
    s_add_u32 m0, s51, 0x800
    s_nop 0
    buffer_load_dwordx4 v6, s[12:15], s34 offen lds
    s_add_u32 s34, s50, 0xb000
    s_add_u32 m0, s51, 0xc00
    s_nop 0
    buffer_load_dwordx4 v7, s[12:15], s34 offen lds
    s_add_u32 s34, s52, 0x100000
    s_add_u32 m0, s53, 0x0
    s_nop 0
    buffer_load_dwordx4 v8, s[16:19], s34 offen lds
    s_add_u32 s34, s52, 0x102000
    s_add_u32 m0, s53, 0x400
    s_nop 0
    buffer_load_dwordx4 v9, s[16:19], s34 offen lds
    s_add_u32 s34, s52, 0x104000
    s_add_u32 m0, s53, 0x800
    s_nop 0
    buffer_load_dwordx4 v8, s[16:19], s34 offen lds
    s_add_u32 s34, s52, 0x106000
    s_add_u32 m0, s53, 0xc00
    s_nop 0
    buffer_load_dwordx4 v9, s[16:19], s34 offen lds
    s_waitcnt vmcnt(16)
    s_barrier
    s_add_u32 s34, s50, 0x900
    s_add_u32 m0, s51, 0x8000
    s_nop 0
    buffer_load_dwordx4 v4, s[12:15], s34 offen lds
    s_add_u32 s34, s50, 0x4100
    s_add_u32 m0, s51, 0x8400
    s_nop 0
    buffer_load_dwordx4 v5, s[12:15], s34 offen lds
    s_add_u32 s34, s50, 0x7900
    s_add_u32 m0, s51, 0x8800
    s_nop 0
    buffer_load_dwordx4 v6, s[12:15], s34 offen lds
    s_add_u32 s34, s50, 0xb100
    s_add_u32 m0, s51, 0x8c00
    s_nop 0
    buffer_load_dwordx4 v7, s[12:15], s34 offen lds
    s_add_u32 s34, s52, 0x120000
    s_add_u32 m0, s53, 0x8000
    s_nop 0
    buffer_load_dwordx4 v8, s[16:19], s34 offen lds
    s_add_u32 s34, s52, 0x122000
    s_add_u32 m0, s53, 0x8400
    s_nop 0
    buffer_load_dwordx4 v9, s[16:19], s34 offen lds
    s_add_u32 s34, s52, 0x124000
    s_add_u32 m0, s53, 0x8800
    s_nop 0
    buffer_load_dwordx4 v8, s[16:19], s34 offen lds
    s_add_u32 s34, s52, 0x126000
    s_add_u32 m0, s53, 0x8c00
    s_nop 0
    buffer_load_dwordx4 v9, s[16:19], s34 offen lds
    s_waitcnt vmcnt(16)
    s_barrier
    s_add_u32 s34, s50, 0xa00
    s_add_u32 m0, s51, 0x10000
    s_nop 0
    buffer_load_dwordx4 v4, s[12:15], s34 offen lds
    s_add_u32 s34, s50, 0x4200
    s_add_u32 m0, s51, 0x10400
    s_nop 0
    buffer_load_dwordx4 v5, s[12:15], s34 offen lds
    s_add_u32 s34, s50, 0x7a00
    s_add_u32 m0, s51, 0x10800
    s_nop 0
    buffer_load_dwordx4 v6, s[12:15], s34 offen lds
    s_add_u32 s34, s50, 0xb200
    s_add_u32 m0, s51, 0x10c00
    s_nop 0
    buffer_load_dwordx4 v7, s[12:15], s34 offen lds
    s_add_u32 s34, s52, 0x140000
    s_add_u32 m0, s53, 0x10000
    s_nop 0
    buffer_load_dwordx4 v8, s[16:19], s34 offen lds
    s_add_u32 s34, s52, 0x142000
    s_add_u32 m0, s53, 0x10400
    s_nop 0
    buffer_load_dwordx4 v9, s[16:19], s34 offen lds
    s_add_u32 s34, s52, 0x144000
    s_add_u32 m0, s53, 0x10800
    s_nop 0
    buffer_load_dwordx4 v8, s[16:19], s34 offen lds
    s_add_u32 s34, s52, 0x146000
    s_add_u32 m0, s53, 0x10c00
    s_nop 0
    buffer_load_dwordx4 v9, s[16:19], s34 offen lds
    s_waitcnt vmcnt(16)
    s_barrier
    s_add_u32 s34, s50, 0xb00
    s_add_u32 m0, s51, 0x18000
    s_nop 0
    buffer_load_dwordx4 v4, s[12:15], s34 offen lds
    s_add_u32 s34, s50, 0x4300
    s_add_u32 m0, s51, 0x18400
    s_nop 0
    buffer_load_dwordx4 v5, s[12:15], s34 offen lds
    s_add_u32 s34, s50, 0x7b00
    s_add_u32 m0, s51, 0x18800
    s_nop 0
    buffer_load_dwordx4 v6, s[12:15], s34 offen lds
    s_add_u32 s34, s50, 0xb300
    s_add_u32 m0, s51, 0x18c00
    s_nop 0
    buffer_load_dwordx4 v7, s[12:15], s34 offen lds
    s_add_u32 s34, s52, 0x160000
    s_add_u32 m0, s53, 0x18000
    s_nop 0
    buffer_load_dwordx4 v8, s[16:19], s34 offen lds
    s_add_u32 s34, s52, 0x162000
    s_add_u32 m0, s53, 0x18400
    s_nop 0
    buffer_load_dwordx4 v9, s[16:19], s34 offen lds
    s_add_u32 s34, s52, 0x164000
    s_add_u32 m0, s53, 0x18800
    s_nop 0
    buffer_load_dwordx4 v8, s[16:19], s34 offen lds
    s_add_u32 s34, s52, 0x166000
    s_add_u32 m0, s53, 0x18c00
    s_nop 0
    buffer_load_dwordx4 v9, s[16:19], s34 offen lds
    s_waitcnt vmcnt(16)
    s_barrier
    s_add_u32 s34, s50, 0xc00
    s_add_u32 m0, s51, 0x0
    s_nop 0
    buffer_load_dwordx4 v4, s[12:15], s34 offen lds
    s_add_u32 s34, s50, 0x4400
    s_add_u32 m0, s51, 0x400
    s_nop 0
    buffer_load_dwordx4 v5, s[12:15], s34 offen lds
    s_add_u32 s34, s50, 0x7c00
    s_add_u32 m0, s51, 0x800
    s_nop 0
    buffer_load_dwordx4 v6, s[12:15], s34 offen lds
    s_add_u32 s34, s50, 0xb400
    s_add_u32 m0, s51, 0xc00
    s_nop 0
    buffer_load_dwordx4 v7, s[12:15], s34 offen lds
    s_add_u32 s34, s52, 0x180000
    s_add_u32 m0, s53, 0x0
    s_nop 0
    buffer_load_dwordx4 v8, s[16:19], s34 offen lds
    s_add_u32 s34, s52, 0x182000
    s_add_u32 m0, s53, 0x400
    s_nop 0
    buffer_load_dwordx4 v9, s[16:19], s34 offen lds
    s_add_u32 s34, s52, 0x184000
    s_add_u32 m0, s53, 0x800
    s_nop 0
    buffer_load_dwordx4 v8, s[16:19], s34 offen lds
    s_add_u32 s34, s52, 0x186000
    s_add_u32 m0, s53, 0xc00
    s_nop 0
    buffer_load_dwordx4 v9, s[16:19], s34 offen lds
    s_waitcnt vmcnt(16)
    s_barrier
    s_add_u32 s34, s50, 0xd00
    s_add_u32 m0, s51, 0x8000
    s_nop 0
    buffer_load_dwordx4 v4, s[12:15], s34 offen lds
    s_add_u32 s34, s50, 0x4500
    s_add_u32 m0, s51, 0x8400
    s_nop 0
    buffer_load_dwordx4 v5, s[12:15], s34 offen lds
    s_add_u32 s34, s50, 0x7d00
    s_add_u32 m0, s51, 0x8800
    s_nop 0
    buffer_load_dwordx4 v6, s[12:15], s34 offen lds
    s_add_u32 s34, s50, 0xb500
    s_add_u32 m0, s51, 0x8c00
    s_nop 0
    buffer_load_dwordx4 v7, s[12:15], s34 offen lds
    s_add_u32 s34, s52, 0x1a0000
    s_add_u32 m0, s53, 0x8000
    s_nop 0
    buffer_load_dwordx4 v8, s[16:19], s34 offen lds
    s_add_u32 s34, s52, 0x1a2000
    s_add_u32 m0, s53, 0x8400
    s_nop 0
    buffer_load_dwordx4 v9, s[16:19], s34 offen lds
    s_add_u32 s34, s52, 0x1a4000
    s_add_u32 m0, s53, 0x8800
    s_nop 0
    buffer_load_dwordx4 v8, s[16:19], s34 offen lds
    s_add_u32 s34, s52, 0x1a6000
    s_add_u32 m0, s53, 0x8c00
    s_nop 0
    buffer_load_dwordx4 v9, s[16:19], s34 offen lds
    s_waitcnt vmcnt(16)
    s_barrier
    s_waitcnt vmcnt(8)
    s_barrier
    s_waitcnt vmcnt(0)
    s_barrier
    s_endpgm
L_ffn2b_kernel_comp:
    s_lshl_b32 s34, s31, 5
    s_add_u32 s34, s34, s28
    v_add_u32 v12, s34, v2
    v_lshlrev_b32 v12, 10, v12
    v_lshl_add_u32 v12, v3, 3, v12
    s_lshl_b32 s54, s29, 1
    s_lshl_b32 s34, s32, 6
    s_add_u32 s54, s54, s34
    v_add_u32 v13, 0x4000, v12
    buffer_load_dwordx2 v[96:97], v12, s[24:27], s54 offen offset:0
    buffer_load_dwordx2 v[98:99], v12, s[24:27], s54 offen offset:32
    buffer_load_dwordx2 v[100:101], v13, s[24:27], s54 offen offset:0
    buffer_load_dwordx2 v[102:103], v13, s[24:27], s54 offen offset:32
    v_lshlrev_b32 v28, 3, v3
    buffer_load_dwordx2 v[112:113], v28, s[44:47], s54 offen offset:0
    buffer_load_dwordx2 v[114:115], v28, s[44:47], s54 offen offset:32
    s_mul_i32 s34, s31, 32
    v_add_u32 v28, s34, v2
    v_lshlrev_b32 v28, 8, v28
    v_xor_b32 v29, v2, v3
    v_xor_b32 v30, 0, v29
    v_lshl_add_u32 v30, v30, 4, v28
    v_mov_b32 v14, v30
    v_xor_b32 v30, 4, v29
    v_lshl_add_u32 v30, v30, 4, v28
    v_mov_b32 v15, v30
    v_xor_b32 v30, 8, v29
    v_lshl_add_u32 v30, v30, 4, v28
    v_mov_b32 v16, v30
    v_xor_b32 v30, 12, v29
    v_lshl_add_u32 v30, v30, 4, v28
    v_mov_b32 v17, v30
    v_bfe_u32 v28, v0, 2, 2
    v_lshl_add_u32 v29, v3, 3, v28
    v_lshlrev_b32 v29, 7, v29
    v_and_b32 v30, 3, v0
    v_lshl_add_u32 v29, v30, 3, v29
    v_add_u32 v29, 16384, v29
    v_and_b32 v30, 1, v3
    v_lshrrev_b32 v28, 1, v28
    v_lshl_add_u32 v28, v30, 1, v28
    s_mul_i32 s34, s32, 2
    s_add_u32 s34, s34, 0
    v_xor_b32 v30, s34, v28
    v_lshl_add_u32 v22, v30, 5, v29
    s_mul_i32 s34, s32, 2
    s_add_u32 s34, s34, 1
    v_xor_b32 v30, s34, v28
    v_lshl_add_u32 v23, v30, 5, v29
    s_barrier
    ds_read_b128 v[32:35], v14 offset:0
    ds_read_b128 v[36:39], v14 offset:4096
    ds_read_b64_tr_b16 v[64:65], v22 offset:0
    ds_read_b64_tr_b16 v[66:67], v22 offset:512
    ds_read_b64_tr_b16 v[68:69], v23 offset:0
    ds_read_b64_tr_b16 v[70:71], v23 offset:512
    s_waitcnt lgkmcnt(0)
    v_mfma_f32_16x16x32_bf16 v[128:131], v[64:67], v[32:35], 0
    ds_read_b128 v[48:51], v15 offset:0
    ds_read_b128 v[52:55], v15 offset:4096
    v_mfma_f32_16x16x32_bf16 v[136:139], v[64:67], v[36:39], 0
    ds_read_b64_tr_b16 v[80:81], v22 offset:4096
    ds_read_b64_tr_b16 v[82:83], v22 offset:4608
    v_mfma_f32_16x16x32_bf16 v[132:135], v[68:71], v[32:35], 0
    ds_read_b64_tr_b16 v[84:85], v23 offset:4096
    ds_read_b64_tr_b16 v[86:87], v23 offset:4608
    v_mfma_f32_16x16x32_bf16 v[140:143], v[68:71], v[36:39], 0
    s_waitcnt lgkmcnt(0)
    v_mfma_f32_16x16x32_bf16 v[128:131], v[80:83], v[48:51], v[128:131]
    ds_read_b128 v[32:35], v16 offset:0
    ds_read_b128 v[36:39], v16 offset:4096
    v_mfma_f32_16x16x32_bf16 v[136:139], v[80:83], v[52:55], v[136:139]
    ds_read_b64_tr_b16 v[64:65], v22 offset:8192
    ds_read_b64_tr_b16 v[66:67], v22 offset:8704
    v_mfma_f32_16x16x32_bf16 v[132:135], v[84:87], v[48:51], v[132:135]
    ds_read_b64_tr_b16 v[68:69], v23 offset:8192
    ds_read_b64_tr_b16 v[70:71], v23 offset:8704
    v_mfma_f32_16x16x32_bf16 v[140:143], v[84:87], v[52:55], v[140:143]
    s_waitcnt lgkmcnt(0)
    v_mfma_f32_16x16x32_bf16 v[128:131], v[64:67], v[32:35], v[128:131]
    ds_read_b128 v[48:51], v17 offset:0
    ds_read_b128 v[52:55], v17 offset:4096
    v_mfma_f32_16x16x32_bf16 v[136:139], v[64:67], v[36:39], v[136:139]
    ds_read_b64_tr_b16 v[80:81], v22 offset:12288
    ds_read_b64_tr_b16 v[82:83], v22 offset:12800
    v_mfma_f32_16x16x32_bf16 v[132:135], v[68:71], v[32:35], v[132:135]
    ds_read_b64_tr_b16 v[84:85], v23 offset:12288
    ds_read_b64_tr_b16 v[86:87], v23 offset:12800
    v_mfma_f32_16x16x32_bf16 v[140:143], v[68:71], v[36:39], v[140:143]
    s_waitcnt lgkmcnt(0)
    s_barrier
    v_mfma_f32_16x16x32_bf16 v[128:131], v[80:83], v[48:51], v[128:131]
    ds_read_b128 v[32:35], v14 offset:32768
    ds_read_b128 v[36:39], v14 offset:36864
    v_mfma_f32_16x16x32_bf16 v[136:139], v[80:83], v[52:55], v[136:139]
    ds_read_b64_tr_b16 v[64:65], v22 offset:32768
    ds_read_b64_tr_b16 v[66:67], v22 offset:33280
    v_mfma_f32_16x16x32_bf16 v[132:135], v[84:87], v[48:51], v[132:135]
    ds_read_b64_tr_b16 v[68:69], v23 offset:32768
    ds_read_b64_tr_b16 v[70:71], v23 offset:33280
    v_mfma_f32_16x16x32_bf16 v[140:143], v[84:87], v[52:55], v[140:143]
    s_waitcnt lgkmcnt(0)
    v_mfma_f32_16x16x32_bf16 v[128:131], v[64:67], v[32:35], v[128:131]
    ds_read_b128 v[48:51], v15 offset:32768
    ds_read_b128 v[52:55], v15 offset:36864
    v_mfma_f32_16x16x32_bf16 v[136:139], v[64:67], v[36:39], v[136:139]
    ds_read_b64_tr_b16 v[80:81], v22 offset:36864
    ds_read_b64_tr_b16 v[82:83], v22 offset:37376
    v_mfma_f32_16x16x32_bf16 v[132:135], v[68:71], v[32:35], v[132:135]
    ds_read_b64_tr_b16 v[84:85], v23 offset:36864
    ds_read_b64_tr_b16 v[86:87], v23 offset:37376
    v_mfma_f32_16x16x32_bf16 v[140:143], v[68:71], v[36:39], v[140:143]
    s_waitcnt lgkmcnt(0)
    v_mfma_f32_16x16x32_bf16 v[128:131], v[80:83], v[48:51], v[128:131]
    ds_read_b128 v[32:35], v16 offset:32768
    ds_read_b128 v[36:39], v16 offset:36864
    v_mfma_f32_16x16x32_bf16 v[136:139], v[80:83], v[52:55], v[136:139]
    ds_read_b64_tr_b16 v[64:65], v22 offset:40960
    ds_read_b64_tr_b16 v[66:67], v22 offset:41472
    v_mfma_f32_16x16x32_bf16 v[132:135], v[84:87], v[48:51], v[132:135]
    ds_read_b64_tr_b16 v[68:69], v23 offset:40960
    ds_read_b64_tr_b16 v[70:71], v23 offset:41472
    v_mfma_f32_16x16x32_bf16 v[140:143], v[84:87], v[52:55], v[140:143]
    s_waitcnt lgkmcnt(0)
    v_mfma_f32_16x16x32_bf16 v[128:131], v[64:67], v[32:35], v[128:131]
    ds_read_b128 v[48:51], v17 offset:32768
    ds_read_b128 v[52:55], v17 offset:36864
    v_mfma_f32_16x16x32_bf16 v[136:139], v[64:67], v[36:39], v[136:139]
    ds_read_b64_tr_b16 v[80:81], v22 offset:45056
    ds_read_b64_tr_b16 v[82:83], v22 offset:45568
    v_mfma_f32_16x16x32_bf16 v[132:135], v[68:71], v[32:35], v[132:135]
    ds_read_b64_tr_b16 v[84:85], v23 offset:45056
    ds_read_b64_tr_b16 v[86:87], v23 offset:45568
    v_mfma_f32_16x16x32_bf16 v[140:143], v[68:71], v[36:39], v[140:143]
    s_waitcnt lgkmcnt(0)
    s_barrier
    v_mfma_f32_16x16x32_bf16 v[128:131], v[80:83], v[48:51], v[128:131]
    v_add_u32 v14, 0x10000, v14
    v_add_u32 v15, 0x10000, v15
    v_add_u32 v16, 0x10000, v16
    v_add_u32 v17, 0x10000, v17
    v_mfma_f32_16x16x32_bf16 v[136:139], v[80:83], v[52:55], v[136:139]
    v_add_u32 v22, 0x10000, v22
    v_add_u32 v23, 0x10000, v23
    ds_read_b128 v[32:35], v14 offset:0
    ds_read_b128 v[36:39], v14 offset:4096
    v_mfma_f32_16x16x32_bf16 v[132:135], v[84:87], v[48:51], v[132:135]
    ds_read_b64_tr_b16 v[64:65], v22 offset:0
    ds_read_b64_tr_b16 v[66:67], v22 offset:512
    ds_read_b64_tr_b16 v[68:69], v23 offset:0
    ds_read_b64_tr_b16 v[70:71], v23 offset:512
    v_mfma_f32_16x16x32_bf16 v[140:143], v[84:87], v[52:55], v[140:143]
    s_waitcnt lgkmcnt(0)
    v_mfma_f32_16x16x32_bf16 v[128:131], v[64:67], v[32:35], v[128:131]
    ds_read_b128 v[48:51], v15 offset:0
    ds_read_b128 v[52:55], v15 offset:4096
    v_mfma_f32_16x16x32_bf16 v[136:139], v[64:67], v[36:39], v[136:139]
    ds_read_b64_tr_b16 v[80:81], v22 offset:4096
    ds_read_b64_tr_b16 v[82:83], v22 offset:4608
    v_mfma_f32_16x16x32_bf16 v[132:135], v[68:71], v[32:35], v[132:135]
    ds_read_b64_tr_b16 v[84:85], v23 offset:4096
    ds_read_b64_tr_b16 v[86:87], v23 offset:4608
    v_mfma_f32_16x16x32_bf16 v[140:143], v[68:71], v[36:39], v[140:143]
    s_waitcnt lgkmcnt(0)
    v_mfma_f32_16x16x32_bf16 v[128:131], v[80:83], v[48:51], v[128:131]
    ds_read_b128 v[32:35], v16 offset:0
    ds_read_b128 v[36:39], v16 offset:4096
    v_mfma_f32_16x16x32_bf16 v[136:139], v[80:83], v[52:55], v[136:139]
    ds_read_b64_tr_b16 v[64:65], v22 offset:8192
    ds_read_b64_tr_b16 v[66:67], v22 offset:8704
    v_mfma_f32_16x16x32_bf16 v[132:135], v[84:87], v[48:51], v[132:135]
    ds_read_b64_tr_b16 v[68:69], v23 offset:8192
    ds_read_b64_tr_b16 v[70:71], v23 offset:8704
    v_mfma_f32_16x16x32_bf16 v[140:143], v[84:87], v[52:55], v[140:143]
    s_waitcnt lgkmcnt(0)
    v_mfma_f32_16x16x32_bf16 v[128:131], v[64:67], v[32:35], v[128:131]
    ds_read_b128 v[48:51], v17 offset:0
    ds_read_b128 v[52:55], v17 offset:4096
    v_mfma_f32_16x16x32_bf16 v[136:139], v[64:67], v[36:39], v[136:139]
    ds_read_b64_tr_b16 v[80:81], v22 offset:12288
    ds_read_b64_tr_b16 v[82:83], v22 offset:12800
    v_mfma_f32_16x16x32_bf16 v[132:135], v[68:71], v[32:35], v[132:135]
    ds_read_b64_tr_b16 v[84:85], v23 offset:12288
    ds_read_b64_tr_b16 v[86:87], v23 offset:12800
    v_mfma_f32_16x16x32_bf16 v[140:143], v[68:71], v[36:39], v[140:143]
    s_waitcnt lgkmcnt(0)
    s_barrier
    v_mfma_f32_16x16x32_bf16 v[128:131], v[80:83], v[48:51], v[128:131]
    ds_read_b128 v[32:35], v14 offset:32768
    ds_read_b128 v[36:39], v14 offset:36864
    v_mfma_f32_16x16x32_bf16 v[136:139], v[80:83], v[52:55], v[136:139]
    ds_read_b64_tr_b16 v[64:65], v22 offset:32768
    ds_read_b64_tr_b16 v[66:67], v22 offset:33280
    v_mfma_f32_16x16x32_bf16 v[132:135], v[84:87], v[48:51], v[132:135]
    ds_read_b64_tr_b16 v[68:69], v23 offset:32768
    ds_read_b64_tr_b16 v[70:71], v23 offset:33280
    v_mfma_f32_16x16x32_bf16 v[140:143], v[84:87], v[52:55], v[140:143]
    s_waitcnt lgkmcnt(0)
    v_mfma_f32_16x16x32_bf16 v[128:131], v[64:67], v[32:35], v[128:131]
    ds_read_b128 v[48:51], v15 offset:32768
    ds_read_b128 v[52:55], v15 offset:36864
    v_mfma_f32_16x16x32_bf16 v[136:139], v[64:67], v[36:39], v[136:139]
    ds_read_b64_tr_b16 v[80:81], v22 offset:36864
    ds_read_b64_tr_b16 v[82:83], v22 offset:37376
    v_mfma_f32_16x16x32_bf16 v[132:135], v[68:71], v[32:35], v[132:135]
    ds_read_b64_tr_b16 v[84:85], v23 offset:36864
    ds_read_b64_tr_b16 v[86:87], v23 offset:37376
    v_mfma_f32_16x16x32_bf16 v[140:143], v[68:71], v[36:39], v[140:143]
    s_waitcnt lgkmcnt(0)
    v_mfma_f32_16x16x32_bf16 v[128:131], v[80:83], v[48:51], v[128:131]
    ds_read_b128 v[32:35], v16 offset:32768
    ds_read_b128 v[36:39], v16 offset:36864
    v_mfma_f32_16x16x32_bf16 v[136:139], v[80:83], v[52:55], v[136:139]
    ds_read_b64_tr_b16 v[64:65], v22 offset:40960
    ds_read_b64_tr_b16 v[66:67], v22 offset:41472
    v_mfma_f32_16x16x32_bf16 v[132:135], v[84:87], v[48:51], v[132:135]
    ds_read_b64_tr_b16 v[68:69], v23 offset:40960
    ds_read_b64_tr_b16 v[70:71], v23 offset:41472
    v_mfma_f32_16x16x32_bf16 v[140:143], v[84:87], v[52:55], v[140:143]
    s_waitcnt lgkmcnt(0)
    v_mfma_f32_16x16x32_bf16 v[128:131], v[64:67], v[32:35], v[128:131]
    ds_read_b128 v[48:51], v17 offset:32768
    ds_read_b128 v[52:55], v17 offset:36864
    v_mfma_f32_16x16x32_bf16 v[136:139], v[64:67], v[36:39], v[136:139]
    ds_read_b64_tr_b16 v[80:81], v22 offset:45056
    ds_read_b64_tr_b16 v[82:83], v22 offset:45568
    v_mfma_f32_16x16x32_bf16 v[132:135], v[68:71], v[32:35], v[132:135]
    ds_read_b64_tr_b16 v[84:85], v23 offset:45056
    ds_read_b64_tr_b16 v[86:87], v23 offset:45568
    v_mfma_f32_16x16x32_bf16 v[140:143], v[68:71], v[36:39], v[140:143]
    s_waitcnt lgkmcnt(0)
    s_barrier
    v_mfma_f32_16x16x32_bf16 v[128:131], v[80:83], v[48:51], v[128:131]
    v_add_u32 v14, 0xffff0000, v14
    v_add_u32 v15, 0xffff0000, v15
    v_add_u32 v16, 0xffff0000, v16
    v_add_u32 v17, 0xffff0000, v17
    v_mfma_f32_16x16x32_bf16 v[136:139], v[80:83], v[52:55], v[136:139]
    v_add_u32 v22, 0xffff0000, v22
    v_add_u32 v23, 0xffff0000, v23
    ds_read_b128 v[32:35], v14 offset:0
    ds_read_b128 v[36:39], v14 offset:4096
    v_mfma_f32_16x16x32_bf16 v[132:135], v[84:87], v[48:51], v[132:135]
    ds_read_b64_tr_b16 v[64:65], v22 offset:0
    ds_read_b64_tr_b16 v[66:67], v22 offset:512
    ds_read_b64_tr_b16 v[68:69], v23 offset:0
    ds_read_b64_tr_b16 v[70:71], v23 offset:512
    v_mfma_f32_16x16x32_bf16 v[140:143], v[84:87], v[52:55], v[140:143]
    s_waitcnt lgkmcnt(0)
    v_mfma_f32_16x16x32_bf16 v[128:131], v[64:67], v[32:35], v[128:131]
    ds_read_b128 v[48:51], v15 offset:0
    ds_read_b128 v[52:55], v15 offset:4096
    v_mfma_f32_16x16x32_bf16 v[136:139], v[64:67], v[36:39], v[136:139]
    ds_read_b64_tr_b16 v[80:81], v22 offset:4096
    ds_read_b64_tr_b16 v[82:83], v22 offset:4608
    v_mfma_f32_16x16x32_bf16 v[132:135], v[68:71], v[32:35], v[132:135]
    ds_read_b64_tr_b16 v[84:85], v23 offset:4096
    ds_read_b64_tr_b16 v[86:87], v23 offset:4608
    v_mfma_f32_16x16x32_bf16 v[140:143], v[68:71], v[36:39], v[140:143]
    s_waitcnt lgkmcnt(0)
    v_mfma_f32_16x16x32_bf16 v[128:131], v[80:83], v[48:51], v[128:131]
    ds_read_b128 v[32:35], v16 offset:0
    ds_read_b128 v[36:39], v16 offset:4096
    v_mfma_f32_16x16x32_bf16 v[136:139], v[80:83], v[52:55], v[136:139]
    ds_read_b64_tr_b16 v[64:65], v22 offset:8192
    ds_read_b64_tr_b16 v[66:67], v22 offset:8704
    v_mfma_f32_16x16x32_bf16 v[132:135], v[84:87], v[48:51], v[132:135]
    ds_read_b64_tr_b16 v[68:69], v23 offset:8192
    ds_read_b64_tr_b16 v[70:71], v23 offset:8704
    v_mfma_f32_16x16x32_bf16 v[140:143], v[84:87], v[52:55], v[140:143]
    s_waitcnt lgkmcnt(0)
    v_mfma_f32_16x16x32_bf16 v[128:131], v[64:67], v[32:35], v[128:131]
    ds_read_b128 v[48:51], v17 offset:0
    ds_read_b128 v[52:55], v17 offset:4096
    v_mfma_f32_16x16x32_bf16 v[136:139], v[64:67], v[36:39], v[136:139]
    ds_read_b64_tr_b16 v[80:81], v22 offset:12288
    ds_read_b64_tr_b16 v[82:83], v22 offset:12800
    v_mfma_f32_16x16x32_bf16 v[132:135], v[68:71], v[32:35], v[132:135]
    ds_read_b64_tr_b16 v[84:85], v23 offset:12288
    ds_read_b64_tr_b16 v[86:87], v23 offset:12800
    v_mfma_f32_16x16x32_bf16 v[140:143], v[68:71], v[36:39], v[140:143]
    s_waitcnt lgkmcnt(0)
    s_barrier
    v_mfma_f32_16x16x32_bf16 v[128:131], v[80:83], v[48:51], v[128:131]
    ds_read_b128 v[32:35], v14 offset:32768
    ds_read_b128 v[36:39], v14 offset:36864
    v_mfma_f32_16x16x32_bf16 v[136:139], v[80:83], v[52:55], v[136:139]
    ds_read_b64_tr_b16 v[64:65], v22 offset:32768
    ds_read_b64_tr_b16 v[66:67], v22 offset:33280
    v_mfma_f32_16x16x32_bf16 v[132:135], v[84:87], v[48:51], v[132:135]
    ds_read_b64_tr_b16 v[68:69], v23 offset:32768
    ds_read_b64_tr_b16 v[70:71], v23 offset:33280
    v_mfma_f32_16x16x32_bf16 v[140:143], v[84:87], v[52:55], v[140:143]
    s_waitcnt lgkmcnt(0)
    v_mfma_f32_16x16x32_bf16 v[128:131], v[64:67], v[32:35], v[128:131]
    ds_read_b128 v[48:51], v15 offset:32768
    ds_read_b128 v[52:55], v15 offset:36864
    v_mfma_f32_16x16x32_bf16 v[136:139], v[64:67], v[36:39], v[136:139]
    ds_read_b64_tr_b16 v[80:81], v22 offset:36864
    ds_read_b64_tr_b16 v[82:83], v22 offset:37376
    v_mfma_f32_16x16x32_bf16 v[132:135], v[68:71], v[32:35], v[132:135]
    ds_read_b64_tr_b16 v[84:85], v23 offset:36864
    ds_read_b64_tr_b16 v[86:87], v23 offset:37376
    v_mfma_f32_16x16x32_bf16 v[140:143], v[68:71], v[36:39], v[140:143]
    s_waitcnt lgkmcnt(0)
    v_mfma_f32_16x16x32_bf16 v[128:131], v[80:83], v[48:51], v[128:131]
    ds_read_b128 v[32:35], v16 offset:32768
    ds_read_b128 v[36:39], v16 offset:36864
    v_mfma_f32_16x16x32_bf16 v[136:139], v[80:83], v[52:55], v[136:139]
    ds_read_b64_tr_b16 v[64:65], v22 offset:40960
    ds_read_b64_tr_b16 v[66:67], v22 offset:41472
    v_mfma_f32_16x16x32_bf16 v[132:135], v[84:87], v[48:51], v[132:135]
    ds_read_b64_tr_b16 v[68:69], v23 offset:40960
    ds_read_b64_tr_b16 v[70:71], v23 offset:41472
    v_mfma_f32_16x16x32_bf16 v[140:143], v[84:87], v[52:55], v[140:143]
    s_waitcnt lgkmcnt(0)
    v_mfma_f32_16x16x32_bf16 v[128:131], v[64:67], v[32:35], v[128:131]
    ds_read_b128 v[48:51], v17 offset:32768
    ds_read_b128 v[52:55], v17 offset:36864
    v_mfma_f32_16x16x32_bf16 v[136:139], v[64:67], v[36:39], v[136:139]
    ds_read_b64_tr_b16 v[80:81], v22 offset:45056
    ds_read_b64_tr_b16 v[82:83], v22 offset:45568
    v_mfma_f32_16x16x32_bf16 v[132:135], v[68:71], v[32:35], v[132:135]
    ds_read_b64_tr_b16 v[84:85], v23 offset:45056
    ds_read_b64_tr_b16 v[86:87], v23 offset:45568
    v_mfma_f32_16x16x32_bf16 v[140:143], v[68:71], v[36:39], v[140:143]
    s_waitcnt lgkmcnt(0)
    s_barrier
    v_mfma_f32_16x16x32_bf16 v[128:131], v[80:83], v[48:51], v[128:131]
    v_add_u32 v14, 0x10000, v14
    v_add_u32 v15, 0x10000, v15
    v_add_u32 v16, 0x10000, v16
    v_add_u32 v17, 0x10000, v17
    v_mfma_f32_16x16x32_bf16 v[136:139], v[80:83], v[52:55], v[136:139]
    v_add_u32 v22, 0x10000, v22
    v_add_u32 v23, 0x10000, v23
    ds_read_b128 v[32:35], v14 offset:0
    ds_read_b128 v[36:39], v14 offset:4096
    v_mfma_f32_16x16x32_bf16 v[132:135], v[84:87], v[48:51], v[132:135]
    ds_read_b64_tr_b16 v[64:65], v22 offset:0
    ds_read_b64_tr_b16 v[66:67], v22 offset:512
    ds_read_b64_tr_b16 v[68:69], v23 offset:0
    ds_read_b64_tr_b16 v[70:71], v23 offset:512
    v_mfma_f32_16x16x32_bf16 v[140:143], v[84:87], v[52:55], v[140:143]
    s_waitcnt lgkmcnt(0)
    v_mfma_f32_16x16x32_bf16 v[128:131], v[64:67], v[32:35], v[128:131]
    ds_read_b128 v[48:51], v15 offset:0
    ds_read_b128 v[52:55], v15 offset:4096
    v_mfma_f32_16x16x32_bf16 v[136:139], v[64:67], v[36:39], v[136:139]
    ds_read_b64_tr_b16 v[80:81], v22 offset:4096
    ds_read_b64_tr_b16 v[82:83], v22 offset:4608
    v_mfma_f32_16x16x32_bf16 v[132:135], v[68:71], v[32:35], v[132:135]
    ds_read_b64_tr_b16 v[84:85], v23 offset:4096
    ds_read_b64_tr_b16 v[86:87], v23 offset:4608
    v_mfma_f32_16x16x32_bf16 v[140:143], v[68:71], v[36:39], v[140:143]
    s_waitcnt lgkmcnt(0)
    v_mfma_f32_16x16x32_bf16 v[128:131], v[80:83], v[48:51], v[128:131]
    ds_read_b128 v[32:35], v16 offset:0
    ds_read_b128 v[36:39], v16 offset:4096
    v_mfma_f32_16x16x32_bf16 v[136:139], v[80:83], v[52:55], v[136:139]
    ds_read_b64_tr_b16 v[64:65], v22 offset:8192
    ds_read_b64_tr_b16 v[66:67], v22 offset:8704
    v_mfma_f32_16x16x32_bf16 v[132:135], v[84:87], v[48:51], v[132:135]
    ds_read_b64_tr_b16 v[68:69], v23 offset:8192
    ds_read_b64_tr_b16 v[70:71], v23 offset:8704
    v_mfma_f32_16x16x32_bf16 v[140:143], v[84:87], v[52:55], v[140:143]
    s_waitcnt lgkmcnt(0)
    v_mfma_f32_16x16x32_bf16 v[128:131], v[64:67], v[32:35], v[128:131]
    ds_read_b128 v[48:51], v17 offset:0
    ds_read_b128 v[52:55], v17 offset:4096
    v_mfma_f32_16x16x32_bf16 v[136:139], v[64:67], v[36:39], v[136:139]
    ds_read_b64_tr_b16 v[80:81], v22 offset:12288
    ds_read_b64_tr_b16 v[82:83], v22 offset:12800
    v_mfma_f32_16x16x32_bf16 v[132:135], v[68:71], v[32:35], v[132:135]
    ds_read_b64_tr_b16 v[84:85], v23 offset:12288
    ds_read_b64_tr_b16 v[86:87], v23 offset:12800
    v_mfma_f32_16x16x32_bf16 v[140:143], v[68:71], v[36:39], v[140:143]
    s_waitcnt lgkmcnt(0)
    s_barrier
    v_mfma_f32_16x16x32_bf16 v[128:131], v[80:83], v[48:51], v[128:131]
    ds_read_b128 v[32:35], v14 offset:32768
    ds_read_b128 v[36:39], v14 offset:36864
    v_mfma_f32_16x16x32_bf16 v[136:139], v[80:83], v[52:55], v[136:139]
    ds_read_b64_tr_b16 v[64:65], v22 offset:32768
    ds_read_b64_tr_b16 v[66:67], v22 offset:33280
    v_mfma_f32_16x16x32_bf16 v[132:135], v[84:87], v[48:51], v[132:135]
    ds_read_b64_tr_b16 v[68:69], v23 offset:32768
    ds_read_b64_tr_b16 v[70:71], v23 offset:33280
    v_mfma_f32_16x16x32_bf16 v[140:143], v[84:87], v[52:55], v[140:143]
    s_waitcnt lgkmcnt(0)
    v_mfma_f32_16x16x32_bf16 v[128:131], v[64:67], v[32:35], v[128:131]
    ds_read_b128 v[48:51], v15 offset:32768
    ds_read_b128 v[52:55], v15 offset:36864
    v_mfma_f32_16x16x32_bf16 v[136:139], v[64:67], v[36:39], v[136:139]
    ds_read_b64_tr_b16 v[80:81], v22 offset:36864
    ds_read_b64_tr_b16 v[82:83], v22 offset:37376
    v_mfma_f32_16x16x32_bf16 v[132:135], v[68:71], v[32:35], v[132:135]
    ds_read_b64_tr_b16 v[84:85], v23 offset:36864
    ds_read_b64_tr_b16 v[86:87], v23 offset:37376
    v_mfma_f32_16x16x32_bf16 v[140:143], v[68:71], v[36:39], v[140:143]
    s_waitcnt lgkmcnt(0)
    v_mfma_f32_16x16x32_bf16 v[128:131], v[80:83], v[48:51], v[128:131]
    ds_read_b128 v[32:35], v16 offset:32768
    ds_read_b128 v[36:39], v16 offset:36864
    v_mfma_f32_16x16x32_bf16 v[136:139], v[80:83], v[52:55], v[136:139]
    ds_read_b64_tr_b16 v[64:65], v22 offset:40960
    ds_read_b64_tr_b16 v[66:67], v22 offset:41472
    v_mfma_f32_16x16x32_bf16 v[132:135], v[84:87], v[48:51], v[132:135]
    ds_read_b64_tr_b16 v[68:69], v23 offset:40960
    ds_read_b64_tr_b16 v[70:71], v23 offset:41472
    v_mfma_f32_16x16x32_bf16 v[140:143], v[84:87], v[52:55], v[140:143]
    s_waitcnt lgkmcnt(0)
    v_mfma_f32_16x16x32_bf16 v[128:131], v[64:67], v[32:35], v[128:131]
    ds_read_b128 v[48:51], v17 offset:32768
    ds_read_b128 v[52:55], v17 offset:36864
    v_mfma_f32_16x16x32_bf16 v[136:139], v[64:67], v[36:39], v[136:139]
    ds_read_b64_tr_b16 v[80:81], v22 offset:45056
    ds_read_b64_tr_b16 v[82:83], v22 offset:45568
    v_mfma_f32_16x16x32_bf16 v[132:135], v[68:71], v[32:35], v[132:135]
    ds_read_b64_tr_b16 v[84:85], v23 offset:45056
    ds_read_b64_tr_b16 v[86:87], v23 offset:45568
    v_mfma_f32_16x16x32_bf16 v[140:143], v[68:71], v[36:39], v[140:143]
    s_waitcnt lgkmcnt(0)
    s_barrier
    v_mfma_f32_16x16x32_bf16 v[128:131], v[80:83], v[48:51], v[128:131]
    v_add_u32 v14, 0xffff0000, v14
    v_add_u32 v15, 0xffff0000, v15
    v_add_u32 v16, 0xffff0000, v16
    v_add_u32 v17, 0xffff0000, v17
    v_mfma_f32_16x16x32_bf16 v[136:139], v[80:83], v[52:55], v[136:139]
    v_add_u32 v22, 0xffff0000, v22
    v_add_u32 v23, 0xffff0000, v23
    ds_read_b128 v[32:35], v14 offset:0
    ds_read_b128 v[36:39], v14 offset:4096
    v_mfma_f32_16x16x32_bf16 v[132:135], v[84:87], v[48:51], v[132:135]
    ds_read_b64_tr_b16 v[64:65], v22 offset:0
    ds_read_b64_tr_b16 v[66:67], v22 offset:512
    ds_read_b64_tr_b16 v[68:69], v23 offset:0
    ds_read_b64_tr_b16 v[70:71], v23 offset:512
    v_mfma_f32_16x16x32_bf16 v[140:143], v[84:87], v[52:55], v[140:143]
    s_waitcnt lgkmcnt(0)
    v_mfma_f32_16x16x32_bf16 v[128:131], v[64:67], v[32:35], v[128:131]
    ds_read_b128 v[48:51], v15 offset:0
    ds_read_b128 v[52:55], v15 offset:4096
    v_mfma_f32_16x16x32_bf16 v[136:139], v[64:67], v[36:39], v[136:139]
    ds_read_b64_tr_b16 v[80:81], v22 offset:4096
    ds_read_b64_tr_b16 v[82:83], v22 offset:4608
    v_mfma_f32_16x16x32_bf16 v[132:135], v[68:71], v[32:35], v[132:135]
    ds_read_b64_tr_b16 v[84:85], v23 offset:4096
    ds_read_b64_tr_b16 v[86:87], v23 offset:4608
    v_mfma_f32_16x16x32_bf16 v[140:143], v[68:71], v[36:39], v[140:143]
    s_waitcnt lgkmcnt(0)
    v_mfma_f32_16x16x32_bf16 v[128:131], v[80:83], v[48:51], v[128:131]
    ds_read_b128 v[32:35], v16 offset:0
    ds_read_b128 v[36:39], v16 offset:4096
    v_mfma_f32_16x16x32_bf16 v[136:139], v[80:83], v[52:55], v[136:139]
    ds_read_b64_tr_b16 v[64:65], v22 offset:8192
    ds_read_b64_tr_b16 v[66:67], v22 offset:8704
    v_mfma_f32_16x16x32_bf16 v[132:135], v[84:87], v[48:51], v[132:135]
    ds_read_b64_tr_b16 v[68:69], v23 offset:8192
    ds_read_b64_tr_b16 v[70:71], v23 offset:8704
    v_mfma_f32_16x16x32_bf16 v[140:143], v[84:87], v[52:55], v[140:143]
    s_waitcnt lgkmcnt(0)
    v_mfma_f32_16x16x32_bf16 v[128:131], v[64:67], v[32:35], v[128:131]
    ds_read_b128 v[48:51], v17 offset:0
    ds_read_b128 v[52:55], v17 offset:4096
    v_mfma_f32_16x16x32_bf16 v[136:139], v[64:67], v[36:39], v[136:139]
    ds_read_b64_tr_b16 v[80:81], v22 offset:12288
    ds_read_b64_tr_b16 v[82:83], v22 offset:12800
    v_mfma_f32_16x16x32_bf16 v[132:135], v[68:71], v[32:35], v[132:135]
    ds_read_b64_tr_b16 v[84:85], v23 offset:12288
    ds_read_b64_tr_b16 v[86:87], v23 offset:12800
    v_mfma_f32_16x16x32_bf16 v[140:143], v[68:71], v[36:39], v[140:143]
    s_waitcnt lgkmcnt(0)
    s_barrier
    v_mfma_f32_16x16x32_bf16 v[128:131], v[80:83], v[48:51], v[128:131]
    ds_read_b128 v[32:35], v14 offset:32768
    ds_read_b128 v[36:39], v14 offset:36864
    v_mfma_f32_16x16x32_bf16 v[136:139], v[80:83], v[52:55], v[136:139]
    ds_read_b64_tr_b16 v[64:65], v22 offset:32768
    ds_read_b64_tr_b16 v[66:67], v22 offset:33280
    v_mfma_f32_16x16x32_bf16 v[132:135], v[84:87], v[48:51], v[132:135]
    ds_read_b64_tr_b16 v[68:69], v23 offset:32768
    ds_read_b64_tr_b16 v[70:71], v23 offset:33280
    v_mfma_f32_16x16x32_bf16 v[140:143], v[84:87], v[52:55], v[140:143]
    s_waitcnt lgkmcnt(0)
    v_mfma_f32_16x16x32_bf16 v[128:131], v[64:67], v[32:35], v[128:131]
    ds_read_b128 v[48:51], v15 offset:32768
    ds_read_b128 v[52:55], v15 offset:36864
    v_mfma_f32_16x16x32_bf16 v[136:139], v[64:67], v[36:39], v[136:139]
    ds_read_b64_tr_b16 v[80:81], v22 offset:36864
    ds_read_b64_tr_b16 v[82:83], v22 offset:37376
    v_mfma_f32_16x16x32_bf16 v[132:135], v[68:71], v[32:35], v[132:135]
    ds_read_b64_tr_b16 v[84:85], v23 offset:36864
    ds_read_b64_tr_b16 v[86:87], v23 offset:37376
    v_mfma_f32_16x16x32_bf16 v[140:143], v[68:71], v[36:39], v[140:143]
    s_waitcnt lgkmcnt(0)
    v_mfma_f32_16x16x32_bf16 v[128:131], v[80:83], v[48:51], v[128:131]
    ds_read_b128 v[32:35], v16 offset:32768
    ds_read_b128 v[36:39], v16 offset:36864
    v_mfma_f32_16x16x32_bf16 v[136:139], v[80:83], v[52:55], v[136:139]
    ds_read_b64_tr_b16 v[64:65], v22 offset:40960
    ds_read_b64_tr_b16 v[66:67], v22 offset:41472
    v_mfma_f32_16x16x32_bf16 v[132:135], v[84:87], v[48:51], v[132:135]
    ds_read_b64_tr_b16 v[68:69], v23 offset:40960
    ds_read_b64_tr_b16 v[70:71], v23 offset:41472
    v_mfma_f32_16x16x32_bf16 v[140:143], v[84:87], v[52:55], v[140:143]
    s_waitcnt lgkmcnt(0)
    v_mfma_f32_16x16x32_bf16 v[128:131], v[64:67], v[32:35], v[128:131]
    ds_read_b128 v[48:51], v17 offset:32768
    ds_read_b128 v[52:55], v17 offset:36864
    v_mfma_f32_16x16x32_bf16 v[136:139], v[64:67], v[36:39], v[136:139]
    ds_read_b64_tr_b16 v[80:81], v22 offset:45056
    ds_read_b64_tr_b16 v[82:83], v22 offset:45568
    v_mfma_f32_16x16x32_bf16 v[132:135], v[68:71], v[32:35], v[132:135]
    ds_read_b64_tr_b16 v[84:85], v23 offset:45056
    ds_read_b64_tr_b16 v[86:87], v23 offset:45568
    v_mfma_f32_16x16x32_bf16 v[140:143], v[68:71], v[36:39], v[140:143]
    s_waitcnt lgkmcnt(0)
    s_barrier
    v_mfma_f32_16x16x32_bf16 v[128:131], v[80:83], v[48:51], v[128:131]
    v_add_u32 v14, 0x10000, v14
    v_add_u32 v15, 0x10000, v15
    v_add_u32 v16, 0x10000, v16
    v_add_u32 v17, 0x10000, v17
    v_mfma_f32_16x16x32_bf16 v[136:139], v[80:83], v[52:55], v[136:139]
    v_add_u32 v22, 0x10000, v22
    v_add_u32 v23, 0x10000, v23
    ds_read_b128 v[32:35], v14 offset:0
    ds_read_b128 v[36:39], v14 offset:4096
    v_mfma_f32_16x16x32_bf16 v[132:135], v[84:87], v[48:51], v[132:135]
    ds_read_b64_tr_b16 v[64:65], v22 offset:0
    ds_read_b64_tr_b16 v[66:67], v22 offset:512
    ds_read_b64_tr_b16 v[68:69], v23 offset:0
    ds_read_b64_tr_b16 v[70:71], v23 offset:512
    v_mfma_f32_16x16x32_bf16 v[140:143], v[84:87], v[52:55], v[140:143]
    s_waitcnt lgkmcnt(0)
    v_mfma_f32_16x16x32_bf16 v[128:131], v[64:67], v[32:35], v[128:131]
    ds_read_b128 v[48:51], v15 offset:0
    ds_read_b128 v[52:55], v15 offset:4096
    v_mfma_f32_16x16x32_bf16 v[136:139], v[64:67], v[36:39], v[136:139]
    ds_read_b64_tr_b16 v[80:81], v22 offset:4096
    ds_read_b64_tr_b16 v[82:83], v22 offset:4608
    v_mfma_f32_16x16x32_bf16 v[132:135], v[68:71], v[32:35], v[132:135]
    ds_read_b64_tr_b16 v[84:85], v23 offset:4096
    ds_read_b64_tr_b16 v[86:87], v23 offset:4608
    v_mfma_f32_16x16x32_bf16 v[140:143], v[68:71], v[36:39], v[140:143]
    s_waitcnt lgkmcnt(0)
    v_mfma_f32_16x16x32_bf16 v[128:131], v[80:83], v[48:51], v[128:131]
    ds_read_b128 v[32:35], v16 offset:0
    ds_read_b128 v[36:39], v16 offset:4096
    v_mfma_f32_16x16x32_bf16 v[136:139], v[80:83], v[52:55], v[136:139]
    ds_read_b64_tr_b16 v[64:65], v22 offset:8192
    ds_read_b64_tr_b16 v[66:67], v22 offset:8704
    v_mfma_f32_16x16x32_bf16 v[132:135], v[84:87], v[48:51], v[132:135]
    ds_read_b64_tr_b16 v[68:69], v23 offset:8192
    ds_read_b64_tr_b16 v[70:71], v23 offset:8704
    v_mfma_f32_16x16x32_bf16 v[140:143], v[84:87], v[52:55], v[140:143]
    s_waitcnt lgkmcnt(0)
    v_mfma_f32_16x16x32_bf16 v[128:131], v[64:67], v[32:35], v[128:131]
    ds_read_b128 v[48:51], v17 offset:0
    ds_read_b128 v[52:55], v17 offset:4096
    v_mfma_f32_16x16x32_bf16 v[136:139], v[64:67], v[36:39], v[136:139]
    ds_read_b64_tr_b16 v[80:81], v22 offset:12288
    ds_read_b64_tr_b16 v[82:83], v22 offset:12800
    v_mfma_f32_16x16x32_bf16 v[132:135], v[68:71], v[32:35], v[132:135]
    ds_read_b64_tr_b16 v[84:85], v23 offset:12288
    ds_read_b64_tr_b16 v[86:87], v23 offset:12800
    v_mfma_f32_16x16x32_bf16 v[140:143], v[68:71], v[36:39], v[140:143]
    s_waitcnt lgkmcnt(0)
    s_barrier
    v_mfma_f32_16x16x32_bf16 v[128:131], v[80:83], v[48:51], v[128:131]
    ds_read_b128 v[32:35], v14 offset:32768
    ds_read_b128 v[36:39], v14 offset:36864
    v_mfma_f32_16x16x32_bf16 v[136:139], v[80:83], v[52:55], v[136:139]
    ds_read_b64_tr_b16 v[64:65], v22 offset:32768
    ds_read_b64_tr_b16 v[66:67], v22 offset:33280
    v_mfma_f32_16x16x32_bf16 v[132:135], v[84:87], v[48:51], v[132:135]
    ds_read_b64_tr_b16 v[68:69], v23 offset:32768
    ds_read_b64_tr_b16 v[70:71], v23 offset:33280
    v_mfma_f32_16x16x32_bf16 v[140:143], v[84:87], v[52:55], v[140:143]
    s_waitcnt lgkmcnt(0)
    v_mfma_f32_16x16x32_bf16 v[128:131], v[64:67], v[32:35], v[128:131]
    ds_read_b128 v[48:51], v15 offset:32768
    ds_read_b128 v[52:55], v15 offset:36864
    v_mfma_f32_16x16x32_bf16 v[136:139], v[64:67], v[36:39], v[136:139]
    ds_read_b64_tr_b16 v[80:81], v22 offset:36864
    ds_read_b64_tr_b16 v[82:83], v22 offset:37376
    v_mfma_f32_16x16x32_bf16 v[132:135], v[68:71], v[32:35], v[132:135]
    ds_read_b64_tr_b16 v[84:85], v23 offset:36864
    ds_read_b64_tr_b16 v[86:87], v23 offset:37376
    v_mfma_f32_16x16x32_bf16 v[140:143], v[68:71], v[36:39], v[140:143]
    s_waitcnt lgkmcnt(0)
    v_mfma_f32_16x16x32_bf16 v[128:131], v[80:83], v[48:51], v[128:131]
    ds_read_b128 v[32:35], v16 offset:32768
    ds_read_b128 v[36:39], v16 offset:36864
    v_mfma_f32_16x16x32_bf16 v[136:139], v[80:83], v[52:55], v[136:139]
    ds_read_b64_tr_b16 v[64:65], v22 offset:40960
    ds_read_b64_tr_b16 v[66:67], v22 offset:41472
    v_mfma_f32_16x16x32_bf16 v[132:135], v[84:87], v[48:51], v[132:135]
    ds_read_b64_tr_b16 v[68:69], v23 offset:40960
    ds_read_b64_tr_b16 v[70:71], v23 offset:41472
    v_mfma_f32_16x16x32_bf16 v[140:143], v[84:87], v[52:55], v[140:143]
    s_waitcnt lgkmcnt(0)
    v_mfma_f32_16x16x32_bf16 v[128:131], v[64:67], v[32:35], v[128:131]
    ds_read_b128 v[48:51], v17 offset:32768
    ds_read_b128 v[52:55], v17 offset:36864
    v_mfma_f32_16x16x32_bf16 v[136:139], v[64:67], v[36:39], v[136:139]
    ds_read_b64_tr_b16 v[80:81], v22 offset:45056
    ds_read_b64_tr_b16 v[82:83], v22 offset:45568
    v_mfma_f32_16x16x32_bf16 v[132:135], v[68:71], v[32:35], v[132:135]
    ds_read_b64_tr_b16 v[84:85], v23 offset:45056
    ds_read_b64_tr_b16 v[86:87], v23 offset:45568
    v_mfma_f32_16x16x32_bf16 v[140:143], v[68:71], v[36:39], v[140:143]
    s_waitcnt lgkmcnt(0)
    s_barrier
    v_mfma_f32_16x16x32_bf16 v[128:131], v[80:83], v[48:51], v[128:131]
    v_add_u32 v14, 0xffff0000, v14
    v_add_u32 v15, 0xffff0000, v15
    v_add_u32 v16, 0xffff0000, v16
    v_add_u32 v17, 0xffff0000, v17
    v_mfma_f32_16x16x32_bf16 v[136:139], v[80:83], v[52:55], v[136:139]
    v_add_u32 v22, 0xffff0000, v22
    v_add_u32 v23, 0xffff0000, v23
    ds_read_b128 v[32:35], v14 offset:0
    ds_read_b128 v[36:39], v14 offset:4096
    v_mfma_f32_16x16x32_bf16 v[132:135], v[84:87], v[48:51], v[132:135]
    ds_read_b64_tr_b16 v[64:65], v22 offset:0
    ds_read_b64_tr_b16 v[66:67], v22 offset:512
    ds_read_b64_tr_b16 v[68:69], v23 offset:0
    ds_read_b64_tr_b16 v[70:71], v23 offset:512
    v_mfma_f32_16x16x32_bf16 v[140:143], v[84:87], v[52:55], v[140:143]
    s_waitcnt lgkmcnt(0)
    v_mfma_f32_16x16x32_bf16 v[128:131], v[64:67], v[32:35], v[128:131]
    ds_read_b128 v[48:51], v15 offset:0
    ds_read_b128 v[52:55], v15 offset:4096
    v_mfma_f32_16x16x32_bf16 v[136:139], v[64:67], v[36:39], v[136:139]
    ds_read_b64_tr_b16 v[80:81], v22 offset:4096
    ds_read_b64_tr_b16 v[82:83], v22 offset:4608
    v_mfma_f32_16x16x32_bf16 v[132:135], v[68:71], v[32:35], v[132:135]
    ds_read_b64_tr_b16 v[84:85], v23 offset:4096
    ds_read_b64_tr_b16 v[86:87], v23 offset:4608
    v_mfma_f32_16x16x32_bf16 v[140:143], v[68:71], v[36:39], v[140:143]
    s_waitcnt lgkmcnt(0)
    v_mfma_f32_16x16x32_bf16 v[128:131], v[80:83], v[48:51], v[128:131]
    ds_read_b128 v[32:35], v16 offset:0
    ds_read_b128 v[36:39], v16 offset:4096
    v_mfma_f32_16x16x32_bf16 v[136:139], v[80:83], v[52:55], v[136:139]
    ds_read_b64_tr_b16 v[64:65], v22 offset:8192
    ds_read_b64_tr_b16 v[66:67], v22 offset:8704
    v_mfma_f32_16x16x32_bf16 v[132:135], v[84:87], v[48:51], v[132:135]
    ds_read_b64_tr_b16 v[68:69], v23 offset:8192
    ds_read_b64_tr_b16 v[70:71], v23 offset:8704
    v_mfma_f32_16x16x32_bf16 v[140:143], v[84:87], v[52:55], v[140:143]
    s_waitcnt lgkmcnt(0)
    v_mfma_f32_16x16x32_bf16 v[128:131], v[64:67], v[32:35], v[128:131]
    ds_read_b128 v[48:51], v17 offset:0
    ds_read_b128 v[52:55], v17 offset:4096
    v_mfma_f32_16x16x32_bf16 v[136:139], v[64:67], v[36:39], v[136:139]
    ds_read_b64_tr_b16 v[80:81], v22 offset:12288
    ds_read_b64_tr_b16 v[82:83], v22 offset:12800
    v_mfma_f32_16x16x32_bf16 v[132:135], v[68:71], v[32:35], v[132:135]
    ds_read_b64_tr_b16 v[84:85], v23 offset:12288
    ds_read_b64_tr_b16 v[86:87], v23 offset:12800
    v_mfma_f32_16x16x32_bf16 v[140:143], v[68:71], v[36:39], v[140:143]
    s_waitcnt lgkmcnt(0)
    s_barrier
    v_mfma_f32_16x16x32_bf16 v[128:131], v[80:83], v[48:51], v[128:131]
    ds_read_b128 v[32:35], v14 offset:32768
    ds_read_b128 v[36:39], v14 offset:36864
    v_mfma_f32_16x16x32_bf16 v[136:139], v[80:83], v[52:55], v[136:139]
    ds_read_b64_tr_b16 v[64:65], v22 offset:32768
    ds_read_b64_tr_b16 v[66:67], v22 offset:33280
    v_mfma_f32_16x16x32_bf16 v[132:135], v[84:87], v[48:51], v[132:135]
    ds_read_b64_tr_b16 v[68:69], v23 offset:32768
    ds_read_b64_tr_b16 v[70:71], v23 offset:33280
    v_mfma_f32_16x16x32_bf16 v[140:143], v[84:87], v[52:55], v[140:143]
    s_waitcnt lgkmcnt(0)
    v_mfma_f32_16x16x32_bf16 v[128:131], v[64:67], v[32:35], v[128:131]
    ds_read_b128 v[48:51], v15 offset:32768
    ds_read_b128 v[52:55], v15 offset:36864
    v_mfma_f32_16x16x32_bf16 v[136:139], v[64:67], v[36:39], v[136:139]
    ds_read_b64_tr_b16 v[80:81], v22 offset:36864
    ds_read_b64_tr_b16 v[82:83], v22 offset:37376
    v_mfma_f32_16x16x32_bf16 v[132:135], v[68:71], v[32:35], v[132:135]
    ds_read_b64_tr_b16 v[84:85], v23 offset:36864
    ds_read_b64_tr_b16 v[86:87], v23 offset:37376
    v_mfma_f32_16x16x32_bf16 v[140:143], v[68:71], v[36:39], v[140:143]
    s_waitcnt lgkmcnt(0)
    v_mfma_f32_16x16x32_bf16 v[128:131], v[80:83], v[48:51], v[128:131]
    ds_read_b128 v[32:35], v16 offset:32768
    ds_read_b128 v[36:39], v16 offset:36864
    v_mfma_f32_16x16x32_bf16 v[136:139], v[80:83], v[52:55], v[136:139]
    ds_read_b64_tr_b16 v[64:65], v22 offset:40960
    ds_read_b64_tr_b16 v[66:67], v22 offset:41472
    v_mfma_f32_16x16x32_bf16 v[132:135], v[84:87], v[48:51], v[132:135]
    ds_read_b64_tr_b16 v[68:69], v23 offset:40960
    ds_read_b64_tr_b16 v[70:71], v23 offset:41472
    v_mfma_f32_16x16x32_bf16 v[140:143], v[84:87], v[52:55], v[140:143]
    s_waitcnt lgkmcnt(0)
    v_mfma_f32_16x16x32_bf16 v[128:131], v[64:67], v[32:35], v[128:131]
    ds_read_b128 v[48:51], v17 offset:32768
    ds_read_b128 v[52:55], v17 offset:36864
    v_mfma_f32_16x16x32_bf16 v[136:139], v[64:67], v[36:39], v[136:139]
    ds_read_b64_tr_b16 v[80:81], v22 offset:45056
    ds_read_b64_tr_b16 v[82:83], v22 offset:45568
    v_mfma_f32_16x16x32_bf16 v[132:135], v[68:71], v[32:35], v[132:135]
    ds_read_b64_tr_b16 v[84:85], v23 offset:45056
    ds_read_b64_tr_b16 v[86:87], v23 offset:45568
    v_mfma_f32_16x16x32_bf16 v[140:143], v[68:71], v[36:39], v[140:143]
    s_waitcnt lgkmcnt(0)
    v_mfma_f32_16x16x32_bf16 v[128:131], v[80:83], v[48:51], v[128:131]
    v_mfma_f32_16x16x32_bf16 v[136:139], v[80:83], v[52:55], v[136:139]
    v_mfma_f32_16x16x32_bf16 v[132:135], v[84:87], v[48:51], v[132:135]
    v_mfma_f32_16x16x32_bf16 v[140:143], v[84:87], v[52:55], v[140:143]
    s_nop 7
    s_waitcnt vmcnt(0)
    v_lshlrev_b32 v32, 16, v96
    v_and_b32 v33, 0xffff0000, v96
    v_lshlrev_b32 v34, 16, v97
    v_and_b32 v35, 0xffff0000, v97
    v_add_f32 v40, v128, v32
    v_add_f32 v41, v129, v33
    v_add_f32 v42, v130, v34
    v_add_f32 v43, v131, v35
    v_lshlrev_b32 v32, 16, v112
    v_and_b32 v33, 0xffff0000, v112
    v_lshlrev_b32 v34, 16, v113
    v_and_b32 v35, 0xffff0000, v113
    v_add_f32 v40, v40, v32
    v_add_f32 v41, v41, v33
    v_add_f32 v42, v42, v34
    v_add_f32 v43, v43, v35
    v_cvt_pk_bf16_f32 v48, v40, v41
    v_cvt_pk_bf16_f32 v49, v42, v43
    buffer_store_dwordx2 v[48:49], v12, s[20:23], s54 offen offset:0
    v_lshlrev_b32 v32, 16, v98
    v_and_b32 v33, 0xffff0000, v98
    v_lshlrev_b32 v34, 16, v99
    v_and_b32 v35, 0xffff0000, v99
    v_add_f32 v40, v132, v32
    v_add_f32 v41, v133, v33
    v_add_f32 v42, v134, v34
    v_add_f32 v43, v135, v35
    v_lshlrev_b32 v32, 16, v114
    v_and_b32 v33, 0xffff0000, v114
    v_lshlrev_b32 v34, 16, v115
    v_and_b32 v35, 0xffff0000, v115
    v_add_f32 v40, v40, v32
    v_add_f32 v41, v41, v33
    v_add_f32 v42, v42, v34
    v_add_f32 v43, v43, v35
    v_cvt_pk_bf16_f32 v50, v40, v41
    v_cvt_pk_bf16_f32 v51, v42, v43
    buffer_store_dwordx2 v[50:51], v12, s[20:23], s54 offen offset:32
    v_lshlrev_b32 v32, 16, v100
    v_and_b32 v33, 0xffff0000, v100
    v_lshlrev_b32 v34, 16, v101
    v_and_b32 v35, 0xffff0000, v101
    v_add_f32 v40, v136, v32
    v_add_f32 v41, v137, v33
    v_add_f32 v42, v138, v34
    v_add_f32 v43, v139, v35
    v_lshlrev_b32 v32, 16, v112
    v_and_b32 v33, 0xffff0000, v112
    v_lshlrev_b32 v34, 16, v113
    v_and_b32 v35, 0xffff0000, v113
    v_add_f32 v40, v40, v32
    v_add_f32 v41, v41, v33
    v_add_f32 v42, v42, v34
    v_add_f32 v43, v43, v35
    v_cvt_pk_bf16_f32 v52, v40, v41
    v_cvt_pk_bf16_f32 v53, v42, v43
    buffer_store_dwordx2 v[52:53], v13, s[20:23], s54 offen offset:0
    v_lshlrev_b32 v32, 16, v102
    v_and_b32 v33, 0xffff0000, v102
    v_lshlrev_b32 v34, 16, v103
    v_and_b32 v35, 0xffff0000, v103
    v_add_f32 v40, v140, v32
    v_add_f32 v41, v141, v33
    v_add_f32 v42, v142, v34
    v_add_f32 v43, v143, v35
    v_lshlrev_b32 v32, 16, v114
    v_and_b32 v33, 0xffff0000, v114
    v_lshlrev_b32 v34, 16, v115
    v_and_b32 v35, 0xffff0000, v115
    v_add_f32 v40, v40, v32
    v_add_f32 v41, v41, v33
    v_add_f32 v42, v42, v34
    v_add_f32 v43, v43, v35
    v_cvt_pk_bf16_f32 v54, v40, v41
    v_cvt_pk_bf16_f32 v55, v42, v43
    buffer_store_dwordx2 v[54:55], v13, s[20:23], s54 offen offset:32
L_ffn2b_kernel_end:
    s_endpgm
.section .rodata,"a"
.p2align 6
.amdhsa_kernel qkv0_kernel
  .amdhsa_next_free_vgpr 216
  .amdhsa_next_free_sgpr 102
  .amdhsa_accum_offset 216
  .amdhsa_group_segment_fixed_size 0
  .amdhsa_kernarg_size 88
  .amdhsa_user_sgpr_count 2
  .amdhsa_user_sgpr_kernarg_segment_ptr 1
  .amdhsa_system_sgpr_workgroup_id_x 1
.end_amdhsa_kernel

.p2align 6
.amdhsa_kernel attn_kernel
  .amdhsa_next_free_vgpr 128
  .amdhsa_next_free_sgpr 102
  .amdhsa_accum_offset 128
  .amdhsa_group_segment_fixed_size 0
  .amdhsa_kernarg_size 88
  .amdhsa_user_sgpr_count 2
  .amdhsa_user_sgpr_kernarg_segment_ptr 1
  .amdhsa_system_sgpr_workgroup_id_x 1
.end_amdhsa_kernel

.p2align 6
.amdhsa_kernel wo0_kernel
  .amdhsa_next_free_vgpr 144
  .amdhsa_next_free_sgpr 102
  .amdhsa_accum_offset 144
  .amdhsa_group_segment_fixed_size 0
  .amdhsa_kernarg_size 88
  .amdhsa_user_sgpr_count 2
  .amdhsa_user_sgpr_kernarg_segment_ptr 1
  .amdhsa_system_sgpr_workgroup_id_x 1
.end_amdhsa_kernel

.p2align 6
.amdhsa_kernel ffn1_kernel
  .amdhsa_next_free_vgpr 216
  .amdhsa_next_free_sgpr 102
  .amdhsa_accum_offset 216
  .amdhsa_group_segment_fixed_size 0
  .amdhsa_kernarg_size 88
  .amdhsa_user_sgpr_count 2
  .amdhsa_user_sgpr_kernarg_segment_ptr 1
  .amdhsa_system_sgpr_workgroup_id_x 1
.end_amdhsa_kernel

.p2align 6
.amdhsa_kernel ffn2a_kernel
  .amdhsa_next_free_vgpr 144
  .amdhsa_next_free_sgpr 102
  .amdhsa_accum_offset 144
  .amdhsa_group_segment_fixed_size 0
  .amdhsa_kernarg_size 88
  .amdhsa_user_sgpr_count 2
  .amdhsa_user_sgpr_kernarg_segment_ptr 1
  .amdhsa_system_sgpr_workgroup_id_x 1
.end_amdhsa_kernel

.p2align 6
.amdhsa_kernel qkv1_kernel
  .amdhsa_next_free_vgpr 216
  .amdhsa_next_free_sgpr 102
  .amdhsa_accum_offset 216
  .amdhsa_group_segment_fixed_size 0
  .amdhsa_kernarg_size 88
  .amdhsa_user_sgpr_count 2
  .amdhsa_user_sgpr_kernarg_segment_ptr 1
  .amdhsa_system_sgpr_workgroup_id_x 1
.end_amdhsa_kernel

.p2align 6
.amdhsa_kernel wo1_kernel
  .amdhsa_next_free_vgpr 144
  .amdhsa_next_free_sgpr 102
  .amdhsa_accum_offset 144
  .amdhsa_group_segment_fixed_size 0
  .amdhsa_kernarg_size 88
  .amdhsa_user_sgpr_count 2
  .amdhsa_user_sgpr_kernarg_segment_ptr 1
  .amdhsa_system_sgpr_workgroup_id_x 1
.end_amdhsa_kernel

.p2align 6
.amdhsa_kernel ffn2b_kernel
  .amdhsa_next_free_vgpr 144
  .amdhsa_next_free_sgpr 102
  .amdhsa_accum_offset 144
  .amdhsa_group_segment_fixed_size 0
  .amdhsa_kernarg_size 88
  .amdhsa_user_sgpr_count 2
  .amdhsa_user_sgpr_kernarg_segment_ptr 1
  .amdhsa_system_sgpr_workgroup_id_x 1
.end_amdhsa_kernel
```
